```python
import torch

def _softmax(x, axis=-1):
    return torch.softmax(x, dim=axis)

def _gelu(x):
    return torch.nn.functional.gelu(x, approximate='tanh')

def _silu(x):
    return torch.nn.functional.silu(x)

def _sigmoid(x):
    return torch.sigmoid(x)

def _layernorm(x, axis=-1, eps=1e-05):
    m = x.mean(dim=axis, keepdim=True)
    v = x.var(dim=axis, keepdim=True, unbiased=False)
    return (x - m) / torch.sqrt(v + eps)

def _scatter_add(tgt, idx, src, axis=0):
    return tgt.clone().index_add_(axis, idx, src)

def _segment_sum(src, seg, n):
    out = torch.zeros((n,) + src.shape[1:], dtype=src.dtype)
    return out.index_add_(0, seg, src)

def _pad(x, pw):
    flat = tuple((v for pair in reversed(pw) for v in pair))
    return torch.nn.functional.pad(x, flat)
kernel_name = 'sequential_preLN__sliding_local_dilated__mixer_gmlp__prompt'

def setup_inputs():

    _w = lambda a: (lambda t: t.to(torch.bfloat16) if t.is_floating_point() else t)(torch.as_tensor(a))

    def _A_setup():
        B, S, D = (1, 2048, 1024)
        return {'x': _w((lambda *s: torch.randn(*s, dtype=torch.bfloat16) * 0.05)(B, S, D)), 'wqkv': _w((lambda *s: torch.randn(*s, dtype=torch.bfloat16) * 0.05)(D, 3 * D)), 'wo': _w((lambda *s: torch.randn(*s, dtype=torch.bfloat16) * 0.05)(D, D))}
    _A_in = _A_setup()

    def _B_setup():
        B, S, D, F = (1, 2048, 1024, 3584)
        Fh = F // 2
        return {'x': _w((lambda *s: torch.randn(*s, dtype=torch.bfloat16) * 0.05)(B, S, D)), 'w_in': _w((lambda *s: torch.randn(*s, dtype=torch.bfloat16) * 0.4)(D, 2 * Fh)), 'w_sp': _w(0.01 * (lambda *s: torch.randn(*s, dtype=torch.bfloat16) * 0.4)(S, S)), 'b_sp': _w(1.0 + 0.01 * (lambda *s: torch.randn(*s, dtype=torch.bfloat16) * 0.05)(S)), 'w_out': _w((lambda *s: torch.randn(*s, dtype=torch.bfloat16) * 0.05)(Fh, D))}
    _B_in = _B_setup()
    return {'A_x': _A_in['x'], 'A_wqkv': _A_in['wqkv'], 'A_wo': _A_in['wo'], 'B_x': _B_in['x'], 'B_w_in': _B_in['w_in'], 'B_w_sp': _B_in['w_sp'], 'B_b_sp': _B_in['b_sp'], 'B_w_out': _B_in['w_out']}

def reference(A_x, A_wqkv, A_wo, B_x, B_w_in, B_w_sp, B_b_sp, B_w_out):

    def _A_ref(x, wqkv, wo):
        B, S, D = x.shape
        H = 32
        Dh = D // H
        W, dil = (8, 2)
        qkv = (lambda x, *d: x.permute(*d))((x @ wqkv).reshape(B, S, 3, H, Dh), 2, 0, 3, 1, 4)
        q, k, v = (qkv[0], qkv[1], qkv[2])
        scale = Dh ** (-0.5)
        pos = torch.arange(S)
        off = torch.arange(W) * dil
        idx = pos[:, None] - off[None, :]
        mask = idx >= 0
        idx_c = torch.where(mask, idx, 0).reshape(-1)
        kg = k[:, :, idx_c, :].reshape(B, H, S, W, Dh)
        vg = v[:, :, idx_c, :].reshape(B, H, S, W, Dh)
        logits = torch.einsum('bhsd,bhswd->bhsw', q, kg) * scale
        logits = torch.where(mask[None, None, :, :], logits, -1000000000.0)
        attn = _softmax(logits, axis=-1)
        o = torch.einsum('bhsw,bhswd->bhsd', attn, vg)
        return (lambda x, *d: x.permute(*d))(o, 0, 2, 1, 3).reshape(B, S, D) @ wo

    def _B_ref(x, w_in, w_sp, b_sp, w_out):
        B, S, D = x.shape
        F = w_in.shape[-1]
        Fh = F // 2
        z = _gelu(torch.einsum('bsd,df->bsf', x, w_in))
        z1 = z[..., :Fh].clone()
        z2 = _layernorm(z[..., Fh:], axis=-1)
        g = torch.einsum('ts,bsf->btf', w_sp, z2) + b_sp[None, :, None]
        return torch.einsum('bsf,fd->bsd', z1 * g, w_out)
    x = A_x
    h = x + _A_ref(_layernorm(x, axis=-1), A_wqkv, A_wo)
    h2 = h + _B_ref(_layernorm(h, axis=-1), B_w_in, B_w_sp, B_b_sp, B_w_out)
    return h2
```

```asm
; @launch grid=(256,1,1) block=(512,1,1) lds=163840
.amdgcn_target "amdgcn-amd-amdhsa--gfx950"
.text
.p2align 8
.globl sequential_preLN__sliding_local_dilated__mixer_gmlp__prompt_kernel
.type sequential_preLN__sliding_local_dilated__mixer_gmlp__prompt_kernel,@function
sequential_preLN__sliding_local_dilated__mixer_gmlp__prompt_kernel:
  s_getpc_b64 s[96:97]
  s_cmp_ge_u32 s2, 256
  s_cbranch_scc1 mk_end
  s_load_dwordx4 s[72:75], s[0:1], 0
  s_load_dwordx2 s[10:11], s[0:1], 16
  s_load_dwordx4 s[12:15], s[0:1], 32
  s_load_dwordx4 s[16:19], s[0:1], 48
  s_load_dwordx2 s[20:21], s[0:1], 64
  s_load_dwordx2 s[4:5], s[0:1], 80
  s_and_b32 s47, s2, 7
  s_lshr_b32 s48, s2, 3
  s_and_b32 s57, s47, 1
  s_lshl_b32 s57, s57, 3
  s_and_b32 s49, s48, 7
  s_add_u32 s57, s57, s49
  s_lshr_b32 s58, s47, 1
  s_lshl_b32 s58, s58, 2
  s_lshr_b32 s49, s48, 3
  s_add_u32 s58, s58, s49
  s_and_b32 s47, s2, 7
  s_lshr_b32 s48, s2, 3
  s_and_b32 s59, s47, 3
  s_lshl_b32 s59, s59, 2
  s_and_b32 s49, s48, 3
  s_add_u32 s59, s59, s49
  s_lshr_b32 s60, s47, 2
  s_lshl_b32 s60, s60, 3
  s_lshr_b32 s49, s48, 2
  s_add_u32 s60, s60, s49
  v_lshrrev_b32 v1, 6, v0
  s_nop 0
  v_readfirstlane_b32 s46, v1
  v_and_b32 v0, 63, v0
  s_cmp_lt_u32 s46, 4
  s_cbranch_scc1 mk_common
  s_cmp_eq_u32 s46, 7
  s_cbranch_scc1 mk_common
  s_cmp_eq_u32 s46, 5
  s_cbranch_scc1 mk_ld1
  s_cmp_eq_u32 s46, 6
  s_cbranch_scc1 mk_ld2
mk_ld0:
  s_mov_b32 s44, s57
  s_mov_b32 s45, s58
  v_lshrrev_b32 v1, 3, v0
  v_and_b32 v2, 7, v0
  v_and_b32 v3, 6, v1
  v_xor_b32 v3, v2, v3
  v_lshlrev_b32 v3, 4, v3
  s_mov_b32 s47, 2048
  v_mul_lo_u32 v8, v1, s47
  v_add_u32 v8, v8, v3
  v_and_b32 v3, 2, v1
  v_xor_b32 v3, v2, v3
  v_lshlrev_b32 v3, 4, v3
  s_mov_b32 s47, 6144
  v_mul_lo_u32 v9, v1, s47
  v_add_u32 v9, v9, v3
  v_and_b32 v10, 0x7f, v8
  s_lshl_b32 s49, s44, 18
  s_sub_u32 s49, s49, 32768
  v_add_u32 v8, s49, v8
  s_lshl_b32 s49, s45, 7
  v_add_u32 v9, s49, v9
  v_add_u32 v16, 0, v8
  v_max_i32 v16, v16, v10
  v_add_u32 v17, 49152, v8
  v_add_u32 v18, 98304, v8
  v_add_u32 v19, 147456, v8
  v_add_u32 v20, 196608, v8
  v_add_u32 v21, 245760, v8
  v_add_u32 v22, 0, v9
  v_add_u32 v23, 147456, v9
  v_xor_b32 v23, 64, v23
  v_add_u32 v24, 294912, v9
  v_add_u32 v25, 51200, v9
  v_xor_b32 v25, 64, v25
  v_add_u32 v26, 198656, v9
  v_add_u32 v27, 346112, v9
  v_xor_b32 v27, 64, v27
  v_add_u32 v28, 102400, v9
  v_add_u32 v29, 249856, v9
  v_xor_b32 v29, 64, v29
  s_waitcnt lgkmcnt(0)
  s_mov_b32 s24, s72
  s_mov_b32 s25, s73
  s_mov_b32 s26, 0x400000
  s_mov_b32 s27, 0x20000
  s_mov_b32 s28, s74
  s_mov_b32 s29, s75
  s_mov_b32 s30, 0x600000
  s_mov_b32 s31, 0x20000
  s_mov_b32 s55, 0
  s_mov_b32 s56, 0
  s_mov_b32 s90, 0
  s_mov_b32 s91, 0
  s_mul_i32 s55, s44, 128
  s_mul_i32 s56, s44, 393216
  s_add_u32 m0, s90, 0
  s_mov_b32 exec_lo, 0xffffff00
  buffer_load_dwordx4 v16, s[24:27], s55 offen  lds
  s_mov_b64 exec, -1
  s_add_u32 m0, s90, 3072
  s_nop 0
  buffer_load_dwordx4 v17, s[24:27], s55 offen  lds
  s_add_u32 m0, s90, 6144
  s_nop 0
  buffer_load_dwordx4 v18, s[24:27], s55 offen  lds
  s_add_u32 m0, s90, 9216
  s_nop 0
  buffer_load_dwordx4 v19, s[24:27], s55 offen  lds
  s_add_u32 m0, s90, 12288
  s_nop 0
  buffer_load_dwordx4 v20, s[24:27], s55 offen  lds
  s_add_u32 m0, s90, 15360
  s_nop 0
  buffer_load_dwordx4 v21, s[24:27], s55 offen  lds
  s_add_u32 s55, s55, 128
  s_add_u32 s90, s90, 43008
  s_cmp_eq_u32 s90, 129024
  s_cselect_b32 s90, 0, s90
  s_cmp_eq_u32 s55, 2048
  s_cselect_b32 s55, 0, s55
  s_add_u32 m0, s91, 18432
  s_nop 0
  buffer_load_dwordx4 v22, s[28:31], s56 offen  lds
  s_add_u32 m0, s91, 21504
  s_nop 0
  buffer_load_dwordx4 v23, s[28:31], s56 offen  lds
  s_add_u32 m0, s91, 24576
  s_nop 0
  buffer_load_dwordx4 v24, s[28:31], s56 offen  lds
  s_add_u32 m0, s91, 27648
  s_nop 0
  buffer_load_dwordx4 v25, s[28:31], s56 offen  lds
  s_add_u32 m0, s91, 30720
  s_nop 0
  buffer_load_dwordx4 v26, s[28:31], s56 offen  lds
  s_add_u32 m0, s91, 33792
  s_nop 0
  buffer_load_dwordx4 v27, s[28:31], s56 offen  lds
  s_add_u32 m0, s91, 36864
  s_nop 0
  buffer_load_dwordx4 v28, s[28:31], s56 offen  lds
  s_add_u32 m0, s91, 39936
  s_nop 0
  buffer_load_dwordx4 v29, s[28:31], s56 offen  lds
  s_add_u32 s56, s56, 393216
  s_add_u32 s91, s91, 43008
  s_cmp_eq_u32 s91, 129024
  s_cselect_b32 s91, 0, s91
  s_cmp_eq_u32 s56, 6291456
  s_cselect_b32 s56, 0, s56
  s_add_u32 m0, s90, 0
  s_mov_b32 exec_lo, 0xffffff00
  buffer_load_dwordx4 v16, s[24:27], s55 offen  lds
  s_mov_b64 exec, -1
  s_add_u32 m0, s90, 3072
  s_nop 0
  buffer_load_dwordx4 v17, s[24:27], s55 offen  lds
  s_add_u32 m0, s90, 6144
  s_nop 0
  buffer_load_dwordx4 v18, s[24:27], s55 offen  lds
  s_add_u32 m0, s90, 9216
  s_nop 0
  buffer_load_dwordx4 v19, s[24:27], s55 offen  lds
  s_add_u32 m0, s90, 12288
  s_nop 0
  buffer_load_dwordx4 v20, s[24:27], s55 offen  lds
  s_add_u32 m0, s90, 15360
  s_nop 0
  buffer_load_dwordx4 v21, s[24:27], s55 offen  lds
  s_add_u32 s55, s55, 128
  s_add_u32 s90, s90, 43008
  s_cmp_eq_u32 s90, 129024
  s_cselect_b32 s90, 0, s90
  s_cmp_eq_u32 s55, 2048
  s_cselect_b32 s55, 0, s55
  s_add_u32 m0, s91, 18432
  s_nop 0
  buffer_load_dwordx4 v22, s[28:31], s56 offen  lds
  s_add_u32 m0, s91, 21504
  s_nop 0
  buffer_load_dwordx4 v23, s[28:31], s56 offen  lds
  s_add_u32 m0, s91, 24576
  s_nop 0
  buffer_load_dwordx4 v24, s[28:31], s56 offen  lds
  s_add_u32 m0, s91, 27648
  s_nop 0
  buffer_load_dwordx4 v25, s[28:31], s56 offen  lds
  s_add_u32 m0, s91, 30720
  s_nop 0
  buffer_load_dwordx4 v26, s[28:31], s56 offen  lds
  s_add_u32 m0, s91, 33792
  s_nop 0
  buffer_load_dwordx4 v27, s[28:31], s56 offen  lds
  s_add_u32 m0, s91, 36864
  s_nop 0
  buffer_load_dwordx4 v28, s[28:31], s56 offen  lds
  s_add_u32 m0, s91, 39936
  s_nop 0
  buffer_load_dwordx4 v29, s[28:31], s56 offen  lds
  s_add_u32 s56, s56, 393216
  s_add_u32 s91, s91, 43008
  s_cmp_eq_u32 s91, 129024
  s_cselect_b32 s91, 0, s91
  s_cmp_eq_u32 s56, 6291456
  s_cselect_b32 s56, 0, s56
  s_add_u32 m0, s90, 0
  s_mov_b32 exec_lo, 0xffffff00
  buffer_load_dwordx4 v16, s[24:27], s55 offen  lds
  s_mov_b64 exec, -1
  s_add_u32 m0, s90, 3072
  s_nop 0
  buffer_load_dwordx4 v17, s[24:27], s55 offen  lds
  s_add_u32 m0, s90, 6144
  s_nop 0
  buffer_load_dwordx4 v18, s[24:27], s55 offen  lds
  s_add_u32 m0, s90, 9216
  s_nop 0
  buffer_load_dwordx4 v19, s[24:27], s55 offen  lds
  s_add_u32 m0, s90, 12288
  s_nop 0
  buffer_load_dwordx4 v20, s[24:27], s55 offen  lds
  s_add_u32 m0, s90, 15360
  s_nop 0
  buffer_load_dwordx4 v21, s[24:27], s55 offen  lds
  s_add_u32 s55, s55, 128
  s_add_u32 s90, s90, 43008
  s_cmp_eq_u32 s90, 129024
  s_cselect_b32 s90, 0, s90
  s_cmp_eq_u32 s55, 2048
  s_cselect_b32 s55, 0, s55
  s_add_u32 m0, s91, 18432
  s_nop 0
  buffer_load_dwordx4 v22, s[28:31], s56 offen  lds
  s_add_u32 m0, s91, 21504
  s_nop 0
  buffer_load_dwordx4 v23, s[28:31], s56 offen  lds
  s_add_u32 m0, s91, 24576
  s_nop 0
  buffer_load_dwordx4 v24, s[28:31], s56 offen  lds
  s_add_u32 m0, s91, 27648
  s_nop 0
  buffer_load_dwordx4 v25, s[28:31], s56 offen  lds
  s_add_u32 m0, s91, 30720
  s_nop 0
  buffer_load_dwordx4 v26, s[28:31], s56 offen  lds
  s_add_u32 m0, s91, 33792
  s_nop 0
  buffer_load_dwordx4 v27, s[28:31], s56 offen  lds
  s_add_u32 m0, s91, 36864
  s_nop 0
  buffer_load_dwordx4 v28, s[28:31], s56 offen  lds
  s_add_u32 m0, s91, 39936
  s_nop 0
  buffer_load_dwordx4 v29, s[28:31], s56 offen  lds
  s_add_u32 s56, s56, 393216
  s_add_u32 s91, s91, 43008
  s_cmp_eq_u32 s91, 129024
  s_cselect_b32 s91, 0, s91
  s_cmp_eq_u32 s56, 6291456
  s_cselect_b32 s56, 0, s56
  s_waitcnt vmcnt(28)
  s_barrier
  s_mov_b32 s52, 13
p1_l0_0:
  s_waitcnt vmcnt(14)
  s_barrier
  s_add_u32 m0, s90, 0
  s_mov_b32 exec_lo, 0xffffff00
  buffer_load_dwordx4 v16, s[24:27], s55 offen  lds
  s_mov_b64 exec, -1
  s_add_u32 m0, s90, 3072
  s_nop 0
  buffer_load_dwordx4 v17, s[24:27], s55 offen  lds
  s_add_u32 m0, s90, 6144
  s_nop 0
  buffer_load_dwordx4 v18, s[24:27], s55 offen  lds
  s_add_u32 m0, s90, 9216
  s_nop 0
  buffer_load_dwordx4 v19, s[24:27], s55 offen  lds
  s_add_u32 m0, s90, 12288
  s_nop 0
  buffer_load_dwordx4 v20, s[24:27], s55 offen  lds
  s_add_u32 m0, s90, 15360
  s_nop 0
  buffer_load_dwordx4 v21, s[24:27], s55 offen  lds
  s_add_u32 s55, s55, 128
  s_add_u32 s90, s90, 43008
  s_cmp_eq_u32 s90, 129024
  s_cselect_b32 s90, 0, s90
  s_cmp_eq_u32 s55, 2048
  s_cselect_b32 s55, 0, s55
  s_add_u32 m0, s91, 18432
  s_nop 0
  buffer_load_dwordx4 v22, s[28:31], s56 offen  lds
  s_add_u32 m0, s91, 21504
  s_nop 0
  buffer_load_dwordx4 v23, s[28:31], s56 offen  lds
  s_add_u32 m0, s91, 24576
  s_nop 0
  buffer_load_dwordx4 v24, s[28:31], s56 offen  lds
  s_add_u32 m0, s91, 27648
  s_nop 0
  buffer_load_dwordx4 v25, s[28:31], s56 offen  lds
  s_add_u32 m0, s91, 30720
  s_nop 0
  buffer_load_dwordx4 v26, s[28:31], s56 offen  lds
  s_add_u32 m0, s91, 33792
  s_nop 0
  buffer_load_dwordx4 v27, s[28:31], s56 offen  lds
  s_add_u32 m0, s91, 36864
  s_nop 0
  buffer_load_dwordx4 v28, s[28:31], s56 offen  lds
  s_add_u32 m0, s91, 39936
  s_nop 0
  buffer_load_dwordx4 v29, s[28:31], s56 offen  lds
  s_add_u32 s56, s56, 393216
  s_add_u32 s91, s91, 43008
  s_cmp_eq_u32 s91, 129024
  s_cselect_b32 s91, 0, s91
  s_cmp_eq_u32 s56, 6291456
  s_cselect_b32 s56, 0, s56
  s_sub_u32 s52, s52, 1
  s_cmp_lg_u32 s52, 0
  s_cbranch_scc1 p1_l0_0
  s_waitcnt vmcnt(14)
  s_barrier
  s_waitcnt vmcnt(0)
  s_barrier
  s_barrier
  s_barrier
  s_mov_b32 s40, s12
  s_mov_b32 s41, s13
  s_mov_b32 s42, 0x700000
  s_mov_b32 s43, 0x20000
  s_mul_i32 s50, s2, 28672
  s_add_u32 s50, s50, 0
  v_min_u32 v60, 55, v0
  v_lshlrev_b32 v60, 7, v60
  buffer_load_dword v61, v60, s[40:43], s50 offen
  s_barrier
  s_call_b64 s[84:85], attn_sub
  s_barrier
  s_mov_b32 s44, s59
  s_mov_b32 s45, s60
  s_add_u32 s24, s4, 0x400000
  s_addc_u32 s25, s5, 0x0
  s_mov_b32 s26, 0x400000
  s_mov_b32 s27, 0x20000
  s_mov_b32 s28, s10
  s_mov_b32 s29, s11
  s_mov_b32 s30, 0x200000
  s_mov_b32 s31, 0x20000
  v_lshrrev_b32 v1, 3, v0
  v_and_b32 v2, 7, v0
  v_and_b32 v3, 2, v1
  v_xor_b32 v3, v2, v3
  v_lshlrev_b32 v3, 4, v3
  s_mov_b32 s47, 2048
  v_mul_lo_u32 v9, v1, s47
  v_add_u32 v9, v9, v3
  v_lshrrev_b32 v1, 3, v0
  v_and_b32 v2, 7, v0
  v_and_b32 v3, 6, v1
  v_xor_b32 v2, v2, v3
  v_lshrrev_b32 v3, 2, v2
  v_lshlrev_b32 v8, 13, v3
  v_and_b32 v3, 1, v1
  v_lshl_add_u32 v8, v3, 12, v8
  v_lshrrev_b32 v3, 4, v0
  v_lshl_add_u32 v8, v3, 6, v8
  v_and_b32 v3, 3, v2
  v_lshl_add_u32 v8, v3, 4, v8
  s_mul_i32 s49, s44, 262144
  v_add_u32 v8, s49, v8
  s_lshl_b32 s49, s45, 7
  v_add_u32 v9, s49, v9
  v_add_u32 v16, 0, v8
  v_add_u32 v17, 768, v8
  v_add_u32 v18, 1536, v8
  v_add_u32 v19, 2304, v8
  v_add_u32 v20, 3072, v8
  v_add_u32 v21, 3840, v8
  v_add_u32 v22, 32768, v9
  v_add_u32 v23, 81920, v9
  v_xor_b32 v23, 64, v23
  s_mov_b32 s55, 0
  s_mov_b32 s56, 0
  s_mov_b32 s90, 0
  s_mov_b32 s91, 0
  s_add_u32 m0, s91, 18432
  s_nop 0
  buffer_load_dwordx4 v22, s[28:31], s56 offen  lds
  s_add_u32 m0, s91, 21504
  s_nop 0
  buffer_load_dwordx4 v23, s[28:31], s56 offen  lds
  s_add_u32 s56, s56, 131072
  s_add_u32 s91, s91, 24576
  s_cmp_eq_u32 s91, 147456
  s_cselect_b32 s91, 0, s91
  s_add_u32 m0, s91, 18432
  s_nop 0
  buffer_load_dwordx4 v22, s[28:31], s56 offen  lds
  s_add_u32 m0, s91, 21504
  s_nop 0
  buffer_load_dwordx4 v23, s[28:31], s56 offen  lds
  s_add_u32 s56, s56, 131072
  s_add_u32 s91, s91, 24576
  s_cmp_eq_u32 s91, 147456
  s_cselect_b32 s91, 0, s91
  s_add_u32 m0, s91, 18432
  s_nop 0
  buffer_load_dwordx4 v22, s[28:31], s56 offen  lds
  s_add_u32 m0, s91, 21504
  s_nop 0
  buffer_load_dwordx4 v23, s[28:31], s56 offen  lds
  s_add_u32 s56, s56, 131072
  s_add_u32 s91, s91, 24576
  s_cmp_eq_u32 s91, 147456
  s_cselect_b32 s91, 0, s91
  s_add_u32 m0, s91, 18432
  s_nop 0
  buffer_load_dwordx4 v22, s[28:31], s56 offen  lds
  s_add_u32 m0, s91, 21504
  s_nop 0
  buffer_load_dwordx4 v23, s[28:31], s56 offen  lds
  s_add_u32 s56, s56, 131072
  s_add_u32 s91, s91, 24576
  s_cmp_eq_u32 s91, 147456
  s_cselect_b32 s91, 0, s91
  s_add_u32 m0, s91, 18432
  s_nop 0
  buffer_load_dwordx4 v22, s[28:31], s56 offen  lds
  s_add_u32 m0, s91, 21504
  s_nop 0
  buffer_load_dwordx4 v23, s[28:31], s56 offen  lds
  s_add_u32 s56, s56, 131072
  s_add_u32 s91, s91, 24576
  s_cmp_eq_u32 s91, 147456
  s_cselect_b32 s91, 0, s91
  s_add_u32 m0, s91, 18432
  s_nop 0
  buffer_load_dwordx4 v22, s[28:31], s56 offen  lds
  s_add_u32 m0, s91, 21504
  s_nop 0
  buffer_load_dwordx4 v23, s[28:31], s56 offen  lds
  s_add_u32 s56, s56, 131072
  s_add_u32 s91, s91, 24576
  s_cmp_eq_u32 s91, 147456
  s_cselect_b32 s91, 0, s91
  s_waitcnt vmcnt(12)
  s_barrier
  s_barrier
  s_add_u32 m0, s90, 0
  s_nop 0
  buffer_load_dwordx4 v16, s[24:27], s55 offen sc1 lds
  s_add_u32 m0, s90, 3072
  s_nop 0
  buffer_load_dwordx4 v17, s[24:27], s55 offen sc1 lds
  s_add_u32 m0, s90, 6144
  s_nop 0
  buffer_load_dwordx4 v18, s[24:27], s55 offen sc1 lds
  s_add_u32 m0, s90, 9216
  s_nop 0
  buffer_load_dwordx4 v19, s[24:27], s55 offen sc1 lds
  s_add_u32 m0, s90, 12288
  s_nop 0
  buffer_load_dwordx4 v20, s[24:27], s55 offen sc1 lds
  s_add_u32 m0, s90, 15360
  s_nop 0
  buffer_load_dwordx4 v21, s[24:27], s55 offen sc1 lds
  s_add_u32 s55, s55, 16384
  s_add_u32 s90, s90, 24576
  s_cmp_eq_u32 s90, 147456
  s_cselect_b32 s90, 0, s90
  s_add_u32 m0, s90, 0
  s_nop 0
  buffer_load_dwordx4 v16, s[24:27], s55 offen sc1 lds
  s_add_u32 m0, s90, 3072
  s_nop 0
  buffer_load_dwordx4 v17, s[24:27], s55 offen sc1 lds
  s_add_u32 m0, s90, 6144
  s_nop 0
  buffer_load_dwordx4 v18, s[24:27], s55 offen sc1 lds
  s_add_u32 m0, s90, 9216
  s_nop 0
  buffer_load_dwordx4 v19, s[24:27], s55 offen sc1 lds
  s_add_u32 m0, s90, 12288
  s_nop 0
  buffer_load_dwordx4 v20, s[24:27], s55 offen sc1 lds
  s_add_u32 m0, s90, 15360
  s_nop 0
  buffer_load_dwordx4 v21, s[24:27], s55 offen sc1 lds
  s_add_u32 s55, s55, 16384
  s_add_u32 s90, s90, 24576
  s_cmp_eq_u32 s90, 147456
  s_cselect_b32 s90, 0, s90
  s_add_u32 m0, s90, 0
  s_nop 0
  buffer_load_dwordx4 v16, s[24:27], s55 offen sc1 lds
  s_add_u32 m0, s90, 3072
  s_nop 0
  buffer_load_dwordx4 v17, s[24:27], s55 offen sc1 lds
  s_add_u32 m0, s90, 6144
  s_nop 0
  buffer_load_dwordx4 v18, s[24:27], s55 offen sc1 lds
  s_add_u32 m0, s90, 9216
  s_nop 0
  buffer_load_dwordx4 v19, s[24:27], s55 offen sc1 lds
  s_add_u32 m0, s90, 12288
  s_nop 0
  buffer_load_dwordx4 v20, s[24:27], s55 offen sc1 lds
  s_add_u32 m0, s90, 15360
  s_nop 0
  buffer_load_dwordx4 v21, s[24:27], s55 offen sc1 lds
  s_add_u32 s55, s55, 16384
  s_add_u32 s90, s90, 24576
  s_cmp_eq_u32 s90, 147456
  s_cselect_b32 s90, 0, s90
  s_add_u32 m0, s90, 0
  s_nop 0
  buffer_load_dwordx4 v16, s[24:27], s55 offen sc1 lds
  s_add_u32 m0, s90, 3072
  s_nop 0
  buffer_load_dwordx4 v17, s[24:27], s55 offen sc1 lds
  s_add_u32 m0, s90, 6144
  s_nop 0
  buffer_load_dwordx4 v18, s[24:27], s55 offen sc1 lds
  s_add_u32 m0, s90, 9216
  s_nop 0
  buffer_load_dwordx4 v19, s[24:27], s55 offen sc1 lds
  s_add_u32 m0, s90, 12288
  s_nop 0
  buffer_load_dwordx4 v20, s[24:27], s55 offen sc1 lds
  s_add_u32 m0, s90, 15360
  s_nop 0
  buffer_load_dwordx4 v21, s[24:27], s55 offen sc1 lds
  s_add_u32 s55, s55, 16384
  s_add_u32 s90, s90, 24576
  s_cmp_eq_u32 s90, 147456
  s_cselect_b32 s90, 0, s90
  s_add_u32 m0, s90, 0
  s_nop 0
  buffer_load_dwordx4 v16, s[24:27], s55 offen sc1 lds
  s_add_u32 m0, s90, 3072
  s_nop 0
  buffer_load_dwordx4 v17, s[24:27], s55 offen sc1 lds
  s_add_u32 m0, s90, 6144
  s_nop 0
  buffer_load_dwordx4 v18, s[24:27], s55 offen sc1 lds
  s_add_u32 m0, s90, 9216
  s_nop 0
  buffer_load_dwordx4 v19, s[24:27], s55 offen sc1 lds
  s_add_u32 m0, s90, 12288
  s_nop 0
  buffer_load_dwordx4 v20, s[24:27], s55 offen sc1 lds
  s_add_u32 m0, s90, 15360
  s_nop 0
  buffer_load_dwordx4 v21, s[24:27], s55 offen sc1 lds
  s_add_u32 s55, s55, 16384
  s_add_u32 s90, s90, 24576
  s_cmp_eq_u32 s90, 147456
  s_cselect_b32 s90, 0, s90
  s_add_u32 m0, s90, 0
  s_nop 0
  buffer_load_dwordx4 v16, s[24:27], s55 offen sc1 lds
  s_add_u32 m0, s90, 3072
  s_nop 0
  buffer_load_dwordx4 v17, s[24:27], s55 offen sc1 lds
  s_add_u32 m0, s90, 6144
  s_nop 0
  buffer_load_dwordx4 v18, s[24:27], s55 offen sc1 lds
  s_add_u32 m0, s90, 9216
  s_nop 0
  buffer_load_dwordx4 v19, s[24:27], s55 offen sc1 lds
  s_add_u32 m0, s90, 12288
  s_nop 0
  buffer_load_dwordx4 v20, s[24:27], s55 offen sc1 lds
  s_add_u32 m0, s90, 15360
  s_nop 0
  buffer_load_dwordx4 v21, s[24:27], s55 offen sc1 lds
  s_add_u32 s55, s55, 16384
  s_add_u32 s90, s90, 24576
  s_cmp_eq_u32 s90, 147456
  s_cselect_b32 s90, 0, s90
  s_waitcnt vmcnt(30)
  s_barrier
  s_waitcnt vmcnt(24)
  s_barrier
  s_add_u32 m0, s90, 0
  s_nop 0
  buffer_load_dwordx4 v16, s[24:27], s55 offen sc1 lds
  s_add_u32 m0, s90, 3072
  s_nop 0
  buffer_load_dwordx4 v17, s[24:27], s55 offen sc1 lds
  s_add_u32 m0, s90, 6144
  s_nop 0
  buffer_load_dwordx4 v18, s[24:27], s55 offen sc1 lds
  s_add_u32 m0, s90, 9216
  s_nop 0
  buffer_load_dwordx4 v19, s[24:27], s55 offen sc1 lds
  s_add_u32 m0, s90, 12288
  s_nop 0
  buffer_load_dwordx4 v20, s[24:27], s55 offen sc1 lds
  s_add_u32 m0, s90, 15360
  s_nop 0
  buffer_load_dwordx4 v21, s[24:27], s55 offen sc1 lds
  s_add_u32 s55, s55, 16384
  s_add_u32 s90, s90, 24576
  s_cmp_eq_u32 s90, 147456
  s_cselect_b32 s90, 0, s90
  s_add_u32 m0, s91, 18432
  s_nop 0
  buffer_load_dwordx4 v22, s[28:31], s56 offen  lds
  s_add_u32 m0, s91, 21504
  s_nop 0
  buffer_load_dwordx4 v23, s[28:31], s56 offen  lds
  s_add_u32 s56, s56, 131072
  s_add_u32 s91, s91, 24576
  s_cmp_eq_u32 s91, 147456
  s_cselect_b32 s91, 0, s91
  s_waitcnt vmcnt(26)
  s_barrier
  s_add_u32 m0, s90, 0
  s_nop 0
  buffer_load_dwordx4 v16, s[24:27], s55 offen sc1 lds
  s_add_u32 m0, s90, 3072
  s_nop 0
  buffer_load_dwordx4 v17, s[24:27], s55 offen sc1 lds
  s_add_u32 m0, s90, 6144
  s_nop 0
  buffer_load_dwordx4 v18, s[24:27], s55 offen sc1 lds
  s_add_u32 m0, s90, 9216
  s_nop 0
  buffer_load_dwordx4 v19, s[24:27], s55 offen sc1 lds
  s_add_u32 m0, s90, 12288
  s_nop 0
  buffer_load_dwordx4 v20, s[24:27], s55 offen sc1 lds
  s_add_u32 m0, s90, 15360
  s_nop 0
  buffer_load_dwordx4 v21, s[24:27], s55 offen sc1 lds
  s_add_u32 s55, s55, 16384
  s_add_u32 s90, s90, 24576
  s_cmp_eq_u32 s90, 147456
  s_cselect_b32 s90, 0, s90
  s_add_u32 m0, s91, 18432
  s_nop 0
  buffer_load_dwordx4 v22, s[28:31], s56 offen  lds
  s_add_u32 m0, s91, 21504
  s_nop 0
  buffer_load_dwordx4 v23, s[28:31], s56 offen  lds
  s_add_u32 s56, s56, 131072
  s_add_u32 s91, s91, 24576
  s_cmp_eq_u32 s91, 147456
  s_cselect_b32 s91, 0, s91
  s_waitcnt vmcnt(28)
  s_barrier
  s_add_u32 m0, s90, 0
  s_nop 0
  buffer_load_dwordx4 v16, s[24:27], s55 offen sc1 lds
  s_add_u32 m0, s90, 3072
  s_nop 0
  buffer_load_dwordx4 v17, s[24:27], s55 offen sc1 lds
  s_add_u32 m0, s90, 6144
  s_nop 0
  buffer_load_dwordx4 v18, s[24:27], s55 offen sc1 lds
  s_add_u32 m0, s90, 9216
  s_nop 0
  buffer_load_dwordx4 v19, s[24:27], s55 offen sc1 lds
  s_add_u32 m0, s90, 12288
  s_nop 0
  buffer_load_dwordx4 v20, s[24:27], s55 offen sc1 lds
  s_add_u32 m0, s90, 15360
  s_nop 0
  buffer_load_dwordx4 v21, s[24:27], s55 offen sc1 lds
  s_add_u32 s55, s55, 16384
  s_add_u32 s90, s90, 24576
  s_cmp_eq_u32 s90, 147456
  s_cselect_b32 s90, 0, s90
  s_add_u32 m0, s91, 18432
  s_nop 0
  buffer_load_dwordx4 v22, s[28:31], s56 offen  lds
  s_add_u32 m0, s91, 21504
  s_nop 0
  buffer_load_dwordx4 v23, s[28:31], s56 offen  lds
  s_add_u32 s56, s56, 131072
  s_add_u32 s91, s91, 24576
  s_cmp_eq_u32 s91, 147456
  s_cselect_b32 s91, 0, s91
  s_waitcnt vmcnt(30)
  s_barrier
  s_add_u32 m0, s90, 0
  s_nop 0
  buffer_load_dwordx4 v16, s[24:27], s55 offen sc1 lds
  s_add_u32 m0, s90, 3072
  s_nop 0
  buffer_load_dwordx4 v17, s[24:27], s55 offen sc1 lds
  s_add_u32 m0, s90, 6144
  s_nop 0
  buffer_load_dwordx4 v18, s[24:27], s55 offen sc1 lds
  s_add_u32 m0, s90, 9216
  s_nop 0
  buffer_load_dwordx4 v19, s[24:27], s55 offen sc1 lds
  s_add_u32 m0, s90, 12288
  s_nop 0
  buffer_load_dwordx4 v20, s[24:27], s55 offen sc1 lds
  s_add_u32 m0, s90, 15360
  s_nop 0
  buffer_load_dwordx4 v21, s[24:27], s55 offen sc1 lds
  s_add_u32 s55, s55, 16384
  s_add_u32 s90, s90, 24576
  s_cmp_eq_u32 s90, 147456
  s_cselect_b32 s90, 0, s90
  s_add_u32 m0, s91, 18432
  s_nop 0
  buffer_load_dwordx4 v22, s[28:31], s56 offen  lds
  s_add_u32 m0, s91, 21504
  s_nop 0
  buffer_load_dwordx4 v23, s[28:31], s56 offen  lds
  s_add_u32 s56, s56, 131072
  s_add_u32 s91, s91, 24576
  s_cmp_eq_u32 s91, 147456
  s_cselect_b32 s91, 0, s91
  s_mov_b32 s52, 6
p2_l0_0:
  s_waitcnt vmcnt(32)
  s_barrier
  s_add_u32 m0, s90, 0
  s_nop 0
  buffer_load_dwordx4 v16, s[24:27], s55 offen sc1 lds
  s_add_u32 m0, s90, 3072
  s_nop 0
  buffer_load_dwordx4 v17, s[24:27], s55 offen sc1 lds
  s_add_u32 m0, s90, 6144
  s_nop 0
  buffer_load_dwordx4 v18, s[24:27], s55 offen sc1 lds
  s_add_u32 m0, s90, 9216
  s_nop 0
  buffer_load_dwordx4 v19, s[24:27], s55 offen sc1 lds
  s_add_u32 m0, s90, 12288
  s_nop 0
  buffer_load_dwordx4 v20, s[24:27], s55 offen sc1 lds
  s_add_u32 m0, s90, 15360
  s_nop 0
  buffer_load_dwordx4 v21, s[24:27], s55 offen sc1 lds
  s_add_u32 s55, s55, 16384
  s_add_u32 s90, s90, 24576
  s_cmp_eq_u32 s90, 147456
  s_cselect_b32 s90, 0, s90
  s_add_u32 m0, s91, 18432
  s_nop 0
  buffer_load_dwordx4 v22, s[28:31], s56 offen  lds
  s_add_u32 m0, s91, 21504
  s_nop 0
  buffer_load_dwordx4 v23, s[28:31], s56 offen  lds
  s_add_u32 s56, s56, 131072
  s_add_u32 s91, s91, 24576
  s_cmp_eq_u32 s91, 147456
  s_cselect_b32 s91, 0, s91
  s_sub_u32 s52, s52, 1
  s_cmp_lg_u32 s52, 0
  s_cbranch_scc1 p2_l0_0
  s_waitcnt vmcnt(32)
  s_barrier
  s_waitcnt vmcnt(24)
  s_barrier
  s_waitcnt vmcnt(16)
  s_barrier
  s_waitcnt vmcnt(8)
  s_barrier
  s_waitcnt vmcnt(0)
  s_barrier
  s_barrier
  s_mov_b32 s44, s57
  s_mov_b32 s45, s58
  s_add_u32 s24, s4, 0x800000
  s_addc_u32 s25, s5, 0x0
  s_mov_b32 s26, 0x400000
  s_mov_b32 s27, 0x20000
  s_add_u32 s28, s4, 0x2800000
  s_addc_u32 s29, s5, 0x0
  s_mov_b32 s30, 0x700000
  s_mov_b32 s31, 0x20000
  s_mov_b32 s32, s14
  s_mov_b32 s33, s15
  s_mov_b32 s34, 0x800000
  s_mov_b32 s35, 0x20000
  s_add_u32 s36, s4, 0x1400000
  s_addc_u32 s37, s5, 0x0
  s_mov_b32 s38, 0x700000
  s_mov_b32 s39, 0x20000
  v_lshrrev_b32 v1, 3, v0
  v_and_b32 v2, 7, v0
  v_and_b32 v3, 6, v1
  v_xor_b32 v2, v2, v3
  v_lshrrev_b32 v3, 2, v2
  v_lshlrev_b32 v8, 13, v3
  v_lshl_add_u32 v8, v1, 6, v8
  v_and_b32 v3, 3, v2
  v_lshl_add_u32 v8, v3, 4, v8
  s_lshl_b32 s49, s44, 18
  v_add_u32 v8, s49, v8
  v_lshrrev_b32 v1, 3, v0
  v_and_b32 v2, 7, v0
  v_and_b32 v3, 6, v1
  v_xor_b32 v3, v2, v3
  v_lshlrev_b32 v3, 4, v3
  s_mov_b32 s47, 4096
  v_mul_lo_u32 v9, v1, s47
  v_add_u32 v9, v9, v3
  s_lshl_b32 s49, s44, 19
  v_add_u32 v9, s49, v9
  v_add_u32 v16, 0, v8
  v_add_u32 v17, 1536, v8
  v_add_u32 v18, 3072, v8
  v_add_u32 v19, 4608, v8
  v_add_u32 v20, 6144, v8
  v_add_u32 v21, 7680, v8
  v_add_u32 v22, 0, v9
  v_add_u32 v23, 98304, v9
  v_add_u32 v24, 196608, v9
  v_add_u32 v25, 294912, v9
  v_add_u32 v26, 393216, v9
  v_add_u32 v27, 491520, v9
  v_lshlrev_b32 v28, 4, v0
  v_add_u32 v28, 2048, v28
  v_lshlrev_b32 v29, 4, v0
  v_add_u32 v29, 5120, v29
  v_lshlrev_b32 v30, 4, v0
  v_add_u32 v30, 8192, v30
  v_lshlrev_b32 v31, 4, v0
  v_add_u32 v31, 11264, v31
  s_mov_b32 s28, s12
  s_mov_b32 s29, s13
  s_mov_b32 s30, 0x700000
  s_mov_b32 s31, 0x20000
  s_mul_i32 s49, s45, 224
  s_mov_b32 s47, 4682
  s_mov_b32 s48, 7168
  v_add_u32 v1, 128, v0
  v_mul_lo_u32 v2, v1, s47
  v_lshrrev_b32 v2, 16, v2
  v_mul_u32_u24 v3, 14, v2
  v_sub_u32 v3, v1, v3
  v_and_b32 v4, 0x33, v2
  v_bfe_u32 v5, v2, 2, 1
  v_lshl_or_b32 v4, v5, 3, v4
  v_bfe_u32 v5, v2, 3, 1
  v_lshl_or_b32 v4, v5, 2, v4
  v_mul_lo_u32 v4, v4, s48
  v_lshl_add_u32 v4, v3, 4, v4
  v_add_u32 v32, s49, v4
  v_add_u32 v1, 320, v0
  v_mul_lo_u32 v2, v1, s47
  v_lshrrev_b32 v2, 16, v2
  v_mul_u32_u24 v3, 14, v2
  v_sub_u32 v3, v1, v3
  v_and_b32 v4, 0x33, v2
  v_bfe_u32 v5, v2, 2, 1
  v_lshl_or_b32 v4, v5, 3, v4
  v_bfe_u32 v5, v2, 3, 1
  v_lshl_or_b32 v4, v5, 2, v4
  v_mul_lo_u32 v4, v4, s48
  v_lshl_add_u32 v4, v3, 4, v4
  v_add_u32 v33, s49, v4
  v_add_u32 v1, 512, v0
  v_mul_lo_u32 v2, v1, s47
  v_lshrrev_b32 v2, 16, v2
  v_mul_u32_u24 v3, 14, v2
  v_sub_u32 v3, v1, v3
  v_and_b32 v4, 0x33, v2
  v_bfe_u32 v5, v2, 2, 1
  v_lshl_or_b32 v4, v5, 3, v4
  v_bfe_u32 v5, v2, 3, 1
  v_lshl_or_b32 v4, v5, 2, v4
  v_mul_lo_u32 v4, v4, s48
  v_lshl_add_u32 v4, v3, 4, v4
  v_add_u32 v34, s49, v4
  v_add_u32 v1, 704, v0
  v_mul_lo_u32 v2, v1, s47
  v_lshrrev_b32 v2, 16, v2
  v_mul_u32_u24 v3, 14, v2
  v_sub_u32 v3, v1, v3
  v_and_b32 v4, 0x33, v2
  v_bfe_u32 v5, v2, 2, 1
  v_lshl_or_b32 v4, v5, 3, v4
  v_bfe_u32 v5, v2, 3, 1
  v_lshl_or_b32 v4, v5, 2, v4
  v_mul_lo_u32 v4, v4, s48
  v_lshl_add_u32 v4, v3, 4, v4
  v_add_u32 v35, s49, v4
  s_barrier
  s_barrier
  s_mov_b32 s55, 0
  s_mov_b32 s90, 0
  s_mov_b32 s91, 0
  s_mov_b32 s56, 3584
  s_add_u32 m0, s91, 18432
  s_nop 0
  buffer_load_dwordx4 v32, s[28:31], s56 offen  lds
  s_add_u32 m0, s91, 21504
  s_nop 0
  buffer_load_dwordx4 v33, s[28:31], s56 offen  lds
  s_add_u32 m0, s91, 24576
  s_nop 0
  buffer_load_dwordx4 v34, s[28:31], s56 offen  lds
  s_add_u32 m0, s91, 27648
  s_nop 0
  buffer_load_dwordx4 v35, s[28:31], s56 offen  lds
  s_add_u32 s56, s56, 458752
  s_add_u32 s91, s91, 30720
  s_cmp_eq_u32 s91, 153600
  s_cselect_b32 s91, 0, s91
  s_add_u32 m0, s91, 18432
  s_nop 0
  buffer_load_dwordx4 v32, s[28:31], s56 offen  lds
  s_add_u32 m0, s91, 21504
  s_nop 0
  buffer_load_dwordx4 v33, s[28:31], s56 offen  lds
  s_add_u32 m0, s91, 24576
  s_nop 0
  buffer_load_dwordx4 v34, s[28:31], s56 offen  lds
  s_add_u32 m0, s91, 27648
  s_nop 0
  buffer_load_dwordx4 v35, s[28:31], s56 offen  lds
  s_add_u32 s56, s56, 458752
  s_add_u32 s91, s91, 30720
  s_cmp_eq_u32 s91, 153600
  s_cselect_b32 s91, 0, s91
  s_add_u32 m0, s91, 18432
  s_nop 0
  buffer_load_dwordx4 v32, s[28:31], s56 offen  lds
  s_add_u32 m0, s91, 21504
  s_nop 0
  buffer_load_dwordx4 v33, s[28:31], s56 offen  lds
  s_add_u32 m0, s91, 24576
  s_nop 0
  buffer_load_dwordx4 v34, s[28:31], s56 offen  lds
  s_add_u32 m0, s91, 27648
  s_nop 0
  buffer_load_dwordx4 v35, s[28:31], s56 offen  lds
  s_add_u32 s56, s56, 458752
  s_add_u32 s91, s91, 30720
  s_cmp_eq_u32 s91, 153600
  s_cselect_b32 s91, 0, s91
  s_add_u32 m0, s91, 18432
  s_nop 0
  buffer_load_dwordx4 v32, s[28:31], s56 offen  lds
  s_add_u32 m0, s91, 21504
  s_nop 0
  buffer_load_dwordx4 v33, s[28:31], s56 offen  lds
  s_add_u32 m0, s91, 24576
  s_nop 0
  buffer_load_dwordx4 v34, s[28:31], s56 offen  lds
  s_add_u32 m0, s91, 27648
  s_nop 0
  buffer_load_dwordx4 v35, s[28:31], s56 offen  lds
  s_add_u32 s56, s56, 458752
  s_add_u32 s91, s91, 30720
  s_cmp_eq_u32 s91, 153600
  s_cselect_b32 s91, 0, s91
  s_add_u32 m0, s91, 18432
  s_nop 0
  buffer_load_dwordx4 v32, s[28:31], s56 offen  lds
  s_add_u32 m0, s91, 21504
  s_nop 0
  buffer_load_dwordx4 v33, s[28:31], s56 offen  lds
  s_add_u32 m0, s91, 24576
  s_nop 0
  buffer_load_dwordx4 v34, s[28:31], s56 offen  lds
  s_add_u32 m0, s91, 27648
  s_nop 0
  buffer_load_dwordx4 v35, s[28:31], s56 offen  lds
  s_add_u32 s56, s56, 458752
  s_add_u32 s91, s91, 30720
  s_cmp_eq_u32 s91, 153600
  s_cselect_b32 s91, 0, s91
  s_barrier
  s_barrier
  s_barrier
  s_add_u32 m0, s90, 0
  s_nop 0
  buffer_load_dwordx4 v16, s[24:27], s55 offen sc1 lds
  s_add_u32 m0, s90, 3072
  s_nop 0
  buffer_load_dwordx4 v17, s[24:27], s55 offen sc1 lds
  s_add_u32 m0, s90, 6144
  s_nop 0
  buffer_load_dwordx4 v18, s[24:27], s55 offen sc1 lds
  s_add_u32 m0, s90, 9216
  s_nop 0
  buffer_load_dwordx4 v19, s[24:27], s55 offen sc1 lds
  s_add_u32 m0, s90, 12288
  s_nop 0
  buffer_load_dwordx4 v20, s[24:27], s55 offen sc1 lds
  s_add_u32 m0, s90, 15360
  s_nop 0
  buffer_load_dwordx4 v21, s[24:27], s55 offen sc1 lds
  s_add_u32 s55, s55, 16384
  s_add_u32 s90, s90, 30720
  s_cmp_eq_u32 s90, 153600
  s_cselect_b32 s90, 0, s90
  s_add_u32 m0, s90, 0
  s_nop 0
  buffer_load_dwordx4 v16, s[24:27], s55 offen sc1 lds
  s_add_u32 m0, s90, 3072
  s_nop 0
  buffer_load_dwordx4 v17, s[24:27], s55 offen sc1 lds
  s_add_u32 m0, s90, 6144
  s_nop 0
  buffer_load_dwordx4 v18, s[24:27], s55 offen sc1 lds
  s_add_u32 m0, s90, 9216
  s_nop 0
  buffer_load_dwordx4 v19, s[24:27], s55 offen sc1 lds
  s_add_u32 m0, s90, 12288
  s_nop 0
  buffer_load_dwordx4 v20, s[24:27], s55 offen sc1 lds
  s_add_u32 m0, s90, 15360
  s_nop 0
  buffer_load_dwordx4 v21, s[24:27], s55 offen sc1 lds
  s_add_u32 s55, s55, 16384
  s_add_u32 s90, s90, 30720
  s_cmp_eq_u32 s90, 153600
  s_cselect_b32 s90, 0, s90
  s_add_u32 m0, s90, 0
  s_nop 0
  buffer_load_dwordx4 v16, s[24:27], s55 offen sc1 lds
  s_add_u32 m0, s90, 3072
  s_nop 0
  buffer_load_dwordx4 v17, s[24:27], s55 offen sc1 lds
  s_add_u32 m0, s90, 6144
  s_nop 0
  buffer_load_dwordx4 v18, s[24:27], s55 offen sc1 lds
  s_add_u32 m0, s90, 9216
  s_nop 0
  buffer_load_dwordx4 v19, s[24:27], s55 offen sc1 lds
  s_add_u32 m0, s90, 12288
  s_nop 0
  buffer_load_dwordx4 v20, s[24:27], s55 offen sc1 lds
  s_add_u32 m0, s90, 15360
  s_nop 0
  buffer_load_dwordx4 v21, s[24:27], s55 offen sc1 lds
  s_add_u32 s55, s55, 16384
  s_add_u32 s90, s90, 30720
  s_cmp_eq_u32 s90, 153600
  s_cselect_b32 s90, 0, s90
  s_add_u32 m0, s90, 0
  s_nop 0
  buffer_load_dwordx4 v16, s[24:27], s55 offen sc1 lds
  s_add_u32 m0, s90, 3072
  s_nop 0
  buffer_load_dwordx4 v17, s[24:27], s55 offen sc1 lds
  s_add_u32 m0, s90, 6144
  s_nop 0
  buffer_load_dwordx4 v18, s[24:27], s55 offen sc1 lds
  s_add_u32 m0, s90, 9216
  s_nop 0
  buffer_load_dwordx4 v19, s[24:27], s55 offen sc1 lds
  s_add_u32 m0, s90, 12288
  s_nop 0
  buffer_load_dwordx4 v20, s[24:27], s55 offen sc1 lds
  s_add_u32 m0, s90, 15360
  s_nop 0
  buffer_load_dwordx4 v21, s[24:27], s55 offen sc1 lds
  s_add_u32 s55, s55, 16384
  s_add_u32 s90, s90, 30720
  s_cmp_eq_u32 s90, 153600
  s_cselect_b32 s90, 0, s90
  s_add_u32 m0, s90, 0
  s_nop 0
  buffer_load_dwordx4 v16, s[24:27], s55 offen sc1 lds
  s_add_u32 m0, s90, 3072
  s_nop 0
  buffer_load_dwordx4 v17, s[24:27], s55 offen sc1 lds
  s_add_u32 m0, s90, 6144
  s_nop 0
  buffer_load_dwordx4 v18, s[24:27], s55 offen sc1 lds
  s_add_u32 m0, s90, 9216
  s_nop 0
  buffer_load_dwordx4 v19, s[24:27], s55 offen sc1 lds
  s_add_u32 m0, s90, 12288
  s_nop 0
  buffer_load_dwordx4 v20, s[24:27], s55 offen sc1 lds
  s_add_u32 m0, s90, 15360
  s_nop 0
  buffer_load_dwordx4 v21, s[24:27], s55 offen sc1 lds
  s_add_u32 s55, s55, 16384
  s_add_u32 s90, s90, 30720
  s_cmp_eq_u32 s90, 153600
  s_cselect_b32 s90, 0, s90
  s_waitcnt vmcnt(24)
  s_barrier
  s_waitcnt vmcnt(18)
  s_barrier
  s_add_u32 m0, s90, 0
  s_nop 0
  buffer_load_dwordx4 v16, s[24:27], s55 offen sc1 lds
  s_add_u32 m0, s90, 3072
  s_nop 0
  buffer_load_dwordx4 v17, s[24:27], s55 offen sc1 lds
  s_add_u32 m0, s90, 6144
  s_nop 0
  buffer_load_dwordx4 v18, s[24:27], s55 offen sc1 lds
  s_add_u32 m0, s90, 9216
  s_nop 0
  buffer_load_dwordx4 v19, s[24:27], s55 offen sc1 lds
  s_add_u32 m0, s90, 12288
  s_nop 0
  buffer_load_dwordx4 v20, s[24:27], s55 offen sc1 lds
  s_add_u32 m0, s90, 15360
  s_nop 0
  buffer_load_dwordx4 v21, s[24:27], s55 offen sc1 lds
  s_add_u32 s55, s55, 16384
  s_add_u32 s90, s90, 30720
  s_cmp_eq_u32 s90, 153600
  s_cselect_b32 s90, 0, s90
  s_add_u32 m0, s91, 18432
  s_nop 0
  buffer_load_dwordx4 v32, s[28:31], s56 offen  lds
  s_add_u32 m0, s91, 21504
  s_nop 0
  buffer_load_dwordx4 v33, s[28:31], s56 offen  lds
  s_add_u32 m0, s91, 24576
  s_nop 0
  buffer_load_dwordx4 v34, s[28:31], s56 offen  lds
  s_add_u32 m0, s91, 27648
  s_nop 0
  buffer_load_dwordx4 v35, s[28:31], s56 offen  lds
  s_add_u32 s56, s56, 458752
  s_add_u32 s91, s91, 30720
  s_cmp_eq_u32 s91, 153600
  s_cselect_b32 s91, 0, s91
  s_waitcnt vmcnt(22)
  s_barrier
  s_add_u32 m0, s90, 0
  s_nop 0
  buffer_load_dwordx4 v16, s[24:27], s55 offen sc1 lds
  s_add_u32 m0, s90, 3072
  s_nop 0
  buffer_load_dwordx4 v17, s[24:27], s55 offen sc1 lds
  s_add_u32 m0, s90, 6144
  s_nop 0
  buffer_load_dwordx4 v18, s[24:27], s55 offen sc1 lds
  s_add_u32 m0, s90, 9216
  s_nop 0
  buffer_load_dwordx4 v19, s[24:27], s55 offen sc1 lds
  s_add_u32 m0, s90, 12288
  s_nop 0
  buffer_load_dwordx4 v20, s[24:27], s55 offen sc1 lds
  s_add_u32 m0, s90, 15360
  s_nop 0
  buffer_load_dwordx4 v21, s[24:27], s55 offen sc1 lds
  s_add_u32 s55, s55, 16384
  s_add_u32 s90, s90, 30720
  s_cmp_eq_u32 s90, 153600
  s_cselect_b32 s90, 0, s90
  s_add_u32 m0, s91, 18432
  s_nop 0
  buffer_load_dwordx4 v32, s[28:31], s56 offen  lds
  s_add_u32 m0, s91, 21504
  s_nop 0
  buffer_load_dwordx4 v33, s[28:31], s56 offen  lds
  s_add_u32 m0, s91, 24576
  s_nop 0
  buffer_load_dwordx4 v34, s[28:31], s56 offen  lds
  s_add_u32 m0, s91, 27648
  s_nop 0
  buffer_load_dwordx4 v35, s[28:31], s56 offen  lds
  s_add_u32 s56, s56, 458752
  s_add_u32 s91, s91, 30720
  s_cmp_eq_u32 s91, 153600
  s_cselect_b32 s91, 0, s91
  s_waitcnt vmcnt(26)
  s_barrier
  s_add_u32 m0, s90, 0
  s_nop 0
  buffer_load_dwordx4 v16, s[24:27], s55 offen sc1 lds
  s_add_u32 m0, s90, 3072
  s_nop 0
  buffer_load_dwordx4 v17, s[24:27], s55 offen sc1 lds
  s_add_u32 m0, s90, 6144
  s_nop 0
  buffer_load_dwordx4 v18, s[24:27], s55 offen sc1 lds
  s_add_u32 m0, s90, 9216
  s_nop 0
  buffer_load_dwordx4 v19, s[24:27], s55 offen sc1 lds
  s_add_u32 m0, s90, 12288
  s_nop 0
  buffer_load_dwordx4 v20, s[24:27], s55 offen sc1 lds
  s_add_u32 m0, s90, 15360
  s_nop 0
  buffer_load_dwordx4 v21, s[24:27], s55 offen sc1 lds
  s_add_u32 s55, s55, 16384
  s_add_u32 s90, s90, 30720
  s_cmp_eq_u32 s90, 153600
  s_cselect_b32 s90, 0, s90
  s_add_u32 m0, s91, 18432
  s_nop 0
  buffer_load_dwordx4 v32, s[28:31], s56 offen  lds
  s_add_u32 m0, s91, 21504
  s_nop 0
  buffer_load_dwordx4 v33, s[28:31], s56 offen  lds
  s_add_u32 m0, s91, 24576
  s_nop 0
  buffer_load_dwordx4 v34, s[28:31], s56 offen  lds
  s_add_u32 m0, s91, 27648
  s_nop 0
  buffer_load_dwordx4 v35, s[28:31], s56 offen  lds
  s_add_u32 s56, s56, 458752
  s_add_u32 s91, s91, 30720
  s_cmp_eq_u32 s91, 153600
  s_cselect_b32 s91, 0, s91
  s_mov_b32 s52, 8
p34_l0_0:
  s_waitcnt vmcnt(30)
  s_barrier
  s_add_u32 m0, s90, 0
  s_nop 0
  buffer_load_dwordx4 v16, s[24:27], s55 offen sc1 lds
  s_add_u32 m0, s90, 3072
  s_nop 0
  buffer_load_dwordx4 v17, s[24:27], s55 offen sc1 lds
  s_add_u32 m0, s90, 6144
  s_nop 0
  buffer_load_dwordx4 v18, s[24:27], s55 offen sc1 lds
  s_add_u32 m0, s90, 9216
  s_nop 0
  buffer_load_dwordx4 v19, s[24:27], s55 offen sc1 lds
  s_add_u32 m0, s90, 12288
  s_nop 0
  buffer_load_dwordx4 v20, s[24:27], s55 offen sc1 lds
  s_add_u32 m0, s90, 15360
  s_nop 0
  buffer_load_dwordx4 v21, s[24:27], s55 offen sc1 lds
  s_add_u32 s55, s55, 16384
  s_add_u32 s90, s90, 30720
  s_cmp_eq_u32 s90, 153600
  s_cselect_b32 s90, 0, s90
  s_add_u32 m0, s91, 18432
  s_nop 0
  buffer_load_dwordx4 v32, s[28:31], s56 offen  lds
  s_add_u32 m0, s91, 21504
  s_nop 0
  buffer_load_dwordx4 v33, s[28:31], s56 offen  lds
  s_add_u32 m0, s91, 24576
  s_nop 0
  buffer_load_dwordx4 v34, s[28:31], s56 offen  lds
  s_add_u32 m0, s91, 27648
  s_nop 0
  buffer_load_dwordx4 v35, s[28:31], s56 offen  lds
  s_add_u32 s56, s56, 458752
  s_add_u32 s91, s91, 30720
  s_cmp_eq_u32 s91, 153600
  s_cselect_b32 s91, 0, s91
  s_sub_u32 s52, s52, 1
  s_cmp_lg_u32 s52, 0
  s_cbranch_scc1 p34_l0_0
  s_waitcnt vmcnt(30)
  s_barrier
  s_mov_b32 s55, 0
  s_mov_b32 s56, 0
  s_add_u32 m0, s90, 0
  s_nop 0
  buffer_load_dwordx4 v16, s[24:27], s55 offen sc1 lds
  s_add_u32 m0, s90, 3072
  s_nop 0
  buffer_load_dwordx4 v17, s[24:27], s55 offen sc1 lds
  s_add_u32 m0, s90, 6144
  s_nop 0
  buffer_load_dwordx4 v18, s[24:27], s55 offen sc1 lds
  s_add_u32 m0, s90, 9216
  s_nop 0
  buffer_load_dwordx4 v19, s[24:27], s55 offen sc1 lds
  s_add_u32 m0, s90, 12288
  s_nop 0
  buffer_load_dwordx4 v20, s[24:27], s55 offen sc1 lds
  s_add_u32 m0, s90, 15360
  s_nop 0
  buffer_load_dwordx4 v21, s[24:27], s55 offen sc1 lds
  s_add_u32 s55, s55, 16384
  s_add_u32 s90, s90, 30720
  s_cmp_eq_u32 s90, 153600
  s_cselect_b32 s90, 0, s90
  s_add_u32 m0, s91, 18432
  s_nop 0
  buffer_load_dwordx4 v32, s[28:31], s56 offen  lds
  s_add_u32 m0, s91, 21504
  s_nop 0
  buffer_load_dwordx4 v33, s[28:31], s56 offen  lds
  s_add_u32 m0, s91, 24576
  s_nop 0
  buffer_load_dwordx4 v34, s[28:31], s56 offen  lds
  s_add_u32 m0, s91, 27648
  s_nop 0
  buffer_load_dwordx4 v35, s[28:31], s56 offen  lds
  s_add_u32 s56, s56, 458752
  s_add_u32 s91, s91, 30720
  s_cmp_eq_u32 s91, 153600
  s_cselect_b32 s91, 0, s91
  s_mov_b32 s52, 3
p34_l0_1:
  s_waitcnt vmcnt(30)
  s_barrier
  s_add_u32 m0, s90, 0
  s_nop 0
  buffer_load_dwordx4 v16, s[24:27], s55 offen sc1 lds
  s_add_u32 m0, s90, 3072
  s_nop 0
  buffer_load_dwordx4 v17, s[24:27], s55 offen sc1 lds
  s_add_u32 m0, s90, 6144
  s_nop 0
  buffer_load_dwordx4 v18, s[24:27], s55 offen sc1 lds
  s_add_u32 m0, s90, 9216
  s_nop 0
  buffer_load_dwordx4 v19, s[24:27], s55 offen sc1 lds
  s_add_u32 m0, s90, 12288
  s_nop 0
  buffer_load_dwordx4 v20, s[24:27], s55 offen sc1 lds
  s_add_u32 m0, s90, 15360
  s_nop 0
  buffer_load_dwordx4 v21, s[24:27], s55 offen sc1 lds
  s_add_u32 s55, s55, 16384
  s_add_u32 s90, s90, 30720
  s_cmp_eq_u32 s90, 153600
  s_cselect_b32 s90, 0, s90
  s_add_u32 m0, s91, 18432
  s_nop 0
  buffer_load_dwordx4 v32, s[28:31], s56 offen  lds
  s_add_u32 m0, s91, 21504
  s_nop 0
  buffer_load_dwordx4 v33, s[28:31], s56 offen  lds
  s_add_u32 m0, s91, 24576
  s_nop 0
  buffer_load_dwordx4 v34, s[28:31], s56 offen  lds
  s_add_u32 m0, s91, 27648
  s_nop 0
  buffer_load_dwordx4 v35, s[28:31], s56 offen  lds
  s_add_u32 s56, s56, 458752
  s_add_u32 s91, s91, 30720
  s_cmp_eq_u32 s91, 153600
  s_cselect_b32 s91, 0, s91
  s_sub_u32 s52, s52, 1
  s_cmp_lg_u32 s52, 0
  s_cbranch_scc1 p34_l0_1
  s_waitcnt vmcnt(30)
  s_barrier
  s_add_u32 m0, s90, 0
  s_nop 0
  buffer_load_dwordx4 v16, s[24:27], s55 offen sc1 lds
  s_add_u32 m0, s90, 3072
  s_nop 0
  buffer_load_dwordx4 v17, s[24:27], s55 offen sc1 lds
  s_add_u32 m0, s90, 6144
  s_nop 0
  buffer_load_dwordx4 v18, s[24:27], s55 offen sc1 lds
  s_add_u32 m0, s90, 9216
  s_nop 0
  buffer_load_dwordx4 v19, s[24:27], s55 offen sc1 lds
  s_add_u32 m0, s90, 12288
  s_nop 0
  buffer_load_dwordx4 v20, s[24:27], s55 offen sc1 lds
  s_add_u32 m0, s90, 15360
  s_nop 0
  buffer_load_dwordx4 v21, s[24:27], s55 offen sc1 lds
  s_add_u32 s55, s55, 16384
  s_add_u32 s90, s90, 30720
  s_cmp_eq_u32 s90, 153600
  s_cselect_b32 s90, 0, s90
  s_add_u32 m0, s91, 18432
  s_nop 0
  buffer_load_dwordx4 v32, s[28:31], s56 offen  lds
  s_add_u32 m0, s91, 21504
  s_nop 0
  buffer_load_dwordx4 v33, s[28:31], s56 offen  lds
  s_add_u32 m0, s91, 24576
  s_nop 0
  buffer_load_dwordx4 v34, s[28:31], s56 offen  lds
  s_add_u32 m0, s91, 27648
  s_nop 0
  buffer_load_dwordx4 v35, s[28:31], s56 offen  lds
  s_add_u32 s56, s56, 458752
  s_add_u32 s91, s91, 30720
  s_cmp_eq_u32 s91, 153600
  s_cselect_b32 s91, 0, s91
  s_mov_b32 s40, s14
  s_mov_b32 s41, s15
  s_mov_b32 s42, 0x800000
  s_mov_b32 s43, 0x20000
  s_mul_i32 s50, s2, 32768
  s_add_u32 s50, s50, 0
  v_min_u32 v60, 63, v0
  v_lshlrev_b32 v60, 7, v60
  buffer_load_dword v61, v60, s[40:43], s50 offen
  s_mov_b32 s52, 4
p34_l0_2:
  s_waitcnt vmcnt(31)
  s_barrier
  s_add_u32 m0, s90, 0
  s_nop 0
  buffer_load_dwordx4 v16, s[24:27], s55 offen sc1 lds
  s_add_u32 m0, s90, 3072
  s_nop 0
  buffer_load_dwordx4 v17, s[24:27], s55 offen sc1 lds
  s_add_u32 m0, s90, 6144
  s_nop 0
  buffer_load_dwordx4 v18, s[24:27], s55 offen sc1 lds
  s_add_u32 m0, s90, 9216
  s_nop 0
  buffer_load_dwordx4 v19, s[24:27], s55 offen sc1 lds
  s_add_u32 m0, s90, 12288
  s_nop 0
  buffer_load_dwordx4 v20, s[24:27], s55 offen sc1 lds
  s_add_u32 m0, s90, 15360
  s_nop 0
  buffer_load_dwordx4 v21, s[24:27], s55 offen sc1 lds
  s_add_u32 s55, s55, 16384
  s_add_u32 s90, s90, 30720
  s_cmp_eq_u32 s90, 153600
  s_cselect_b32 s90, 0, s90
  s_add_u32 m0, s91, 18432
  s_nop 0
  buffer_load_dwordx4 v32, s[28:31], s56 offen  lds
  s_add_u32 m0, s91, 21504
  s_nop 0
  buffer_load_dwordx4 v33, s[28:31], s56 offen  lds
  s_add_u32 m0, s91, 24576
  s_nop 0
  buffer_load_dwordx4 v34, s[28:31], s56 offen  lds
  s_add_u32 m0, s91, 27648
  s_nop 0
  buffer_load_dwordx4 v35, s[28:31], s56 offen  lds
  s_add_u32 s56, s56, 458752
  s_add_u32 s91, s91, 30720
  s_cmp_eq_u32 s91, 153600
  s_cselect_b32 s91, 0, s91
  s_sub_u32 s52, s52, 1
  s_cmp_lg_u32 s52, 0
  s_cbranch_scc1 p34_l0_2
  s_mov_b32 s52, 7
p34_l0_3:
  s_waitcnt vmcnt(30)
  s_barrier
  s_add_u32 m0, s90, 0
  s_nop 0
  buffer_load_dwordx4 v16, s[24:27], s55 offen sc1 lds
  s_add_u32 m0, s90, 3072
  s_nop 0
  buffer_load_dwordx4 v17, s[24:27], s55 offen sc1 lds
  s_add_u32 m0, s90, 6144
  s_nop 0
  buffer_load_dwordx4 v18, s[24:27], s55 offen sc1 lds
  s_add_u32 m0, s90, 9216
  s_nop 0
  buffer_load_dwordx4 v19, s[24:27], s55 offen sc1 lds
  s_add_u32 m0, s90, 12288
  s_nop 0
  buffer_load_dwordx4 v20, s[24:27], s55 offen sc1 lds
  s_add_u32 m0, s90, 15360
  s_nop 0
  buffer_load_dwordx4 v21, s[24:27], s55 offen sc1 lds
  s_add_u32 s55, s55, 16384
  s_add_u32 s90, s90, 30720
  s_cmp_eq_u32 s90, 153600
  s_cselect_b32 s90, 0, s90
  s_add_u32 m0, s91, 18432
  s_nop 0
  buffer_load_dwordx4 v32, s[28:31], s56 offen  lds
  s_add_u32 m0, s91, 21504
  s_nop 0
  buffer_load_dwordx4 v33, s[28:31], s56 offen  lds
  s_add_u32 m0, s91, 24576
  s_nop 0
  buffer_load_dwordx4 v34, s[28:31], s56 offen  lds
  s_add_u32 m0, s91, 27648
  s_nop 0
  buffer_load_dwordx4 v35, s[28:31], s56 offen  lds
  s_add_u32 s56, s56, 458752
  s_add_u32 s91, s91, 30720
  s_cmp_eq_u32 s91, 153600
  s_cselect_b32 s91, 0, s91
  s_sub_u32 s52, s52, 1
  s_cmp_lg_u32 s52, 0
  s_cbranch_scc1 p34_l0_3
  s_waitcnt vmcnt(30)
  s_barrier
  s_lshl_b32 s55, s44, 8
  s_mul_i32 s94, s45, 458752
  s_add_u32 s95, s94, 458752
  s_mul_i32 s56, s44, 28672
  s_add_u32 s56, s56, s94
  s_add_u32 m0, s90, 0
  s_nop 0
  buffer_load_dwordx4 v22, s[32:35], s55 offen  lds
  s_add_u32 m0, s90, 3072
  s_nop 0
  buffer_load_dwordx4 v23, s[32:35], s55 offen  lds
  s_add_u32 m0, s90, 6144
  s_nop 0
  buffer_load_dwordx4 v24, s[32:35], s55 offen  lds
  s_add_u32 m0, s90, 9216
  s_nop 0
  buffer_load_dwordx4 v25, s[32:35], s55 offen  lds
  s_add_u32 m0, s90, 12288
  s_nop 0
  buffer_load_dwordx4 v26, s[32:35], s55 offen  lds
  s_add_u32 m0, s90, 15360
  s_nop 0
  buffer_load_dwordx4 v27, s[32:35], s55 offen  lds
  s_add_u32 s55, s55, 128
  s_add_u32 s90, s90, 30720
  s_cmp_eq_u32 s90, 153600
  s_cselect_b32 s90, 0, s90
  s_and_b32 s55, s55, 4095
  s_waitcnt vmcnt(26)
  s_barrier
  s_add_u32 m0, s90, 0
  s_nop 0
  buffer_load_dwordx4 v22, s[32:35], s55 offen  lds
  s_add_u32 m0, s90, 3072
  s_nop 0
  buffer_load_dwordx4 v23, s[32:35], s55 offen  lds
  s_add_u32 m0, s90, 6144
  s_nop 0
  buffer_load_dwordx4 v24, s[32:35], s55 offen  lds
  s_add_u32 m0, s90, 9216
  s_nop 0
  buffer_load_dwordx4 v25, s[32:35], s55 offen  lds
  s_add_u32 m0, s90, 12288
  s_nop 0
  buffer_load_dwordx4 v26, s[32:35], s55 offen  lds
  s_add_u32 m0, s90, 15360
  s_nop 0
  buffer_load_dwordx4 v27, s[32:35], s55 offen  lds
  s_add_u32 s55, s55, 128
  s_add_u32 s90, s90, 30720
  s_cmp_eq_u32 s90, 153600
  s_cselect_b32 s90, 0, s90
  s_and_b32 s55, s55, 4095
  s_waitcnt vmcnt(22)
  s_barrier
  s_add_u32 m0, s90, 0
  s_nop 0
  buffer_load_dwordx4 v22, s[32:35], s55 offen  lds
  s_add_u32 m0, s90, 3072
  s_nop 0
  buffer_load_dwordx4 v23, s[32:35], s55 offen  lds
  s_add_u32 m0, s90, 6144
  s_nop 0
  buffer_load_dwordx4 v24, s[32:35], s55 offen  lds
  s_add_u32 m0, s90, 9216
  s_nop 0
  buffer_load_dwordx4 v25, s[32:35], s55 offen  lds
  s_add_u32 m0, s90, 12288
  s_nop 0
  buffer_load_dwordx4 v26, s[32:35], s55 offen  lds
  s_add_u32 m0, s90, 15360
  s_nop 0
  buffer_load_dwordx4 v27, s[32:35], s55 offen  lds
  s_add_u32 s55, s55, 128
  s_add_u32 s90, s90, 30720
  s_cmp_eq_u32 s90, 153600
  s_cselect_b32 s90, 0, s90
  s_and_b32 s55, s55, 4095
  s_waitcnt vmcnt(18)
  s_barrier
  s_add_u32 m0, s90, 0
  s_nop 0
  buffer_load_dwordx4 v22, s[32:35], s55 offen  lds
  s_add_u32 m0, s90, 3072
  s_nop 0
  buffer_load_dwordx4 v23, s[32:35], s55 offen  lds
  s_add_u32 m0, s90, 6144
  s_nop 0
  buffer_load_dwordx4 v24, s[32:35], s55 offen  lds
  s_add_u32 m0, s90, 9216
  s_nop 0
  buffer_load_dwordx4 v25, s[32:35], s55 offen  lds
  s_add_u32 m0, s90, 12288
  s_nop 0
  buffer_load_dwordx4 v26, s[32:35], s55 offen  lds
  s_add_u32 m0, s90, 15360
  s_nop 0
  buffer_load_dwordx4 v27, s[32:35], s55 offen  lds
  s_add_u32 s55, s55, 128
  s_add_u32 s90, s90, 30720
  s_cmp_eq_u32 s90, 153600
  s_cselect_b32 s90, 0, s90
  s_and_b32 s55, s55, 4095
  s_mov_b32 s40, s18
  s_mov_b32 s41, s19
  s_mov_b32 s42, 0x380000
  s_mov_b32 s43, 0x20000
  s_mul_i32 s50, s2, 14336
  s_add_u32 s50, s50, 0
  v_min_u32 v60, 37, v0
  v_lshlrev_b32 v60, 7, v60
  buffer_load_dword v61, v60, s[40:43], s50 offen
  s_barrier
  s_add_u32 m0, s91, 18432
  s_nop 0
  buffer_load_dwordx4 v28, s[36:39], s56 offen sc1 lds
  s_add_u32 m0, s91, 21504
  s_nop 0
  buffer_load_dwordx4 v29, s[36:39], s56 offen sc1 lds
  s_add_u32 m0, s91, 24576
  s_nop 0
  buffer_load_dwordx4 v30, s[36:39], s56 offen sc1 lds
  s_add_u32 m0, s91, 27648
  s_nop 0
  buffer_load_dwordx4 v31, s[36:39], s56 offen sc1 lds
  s_add_u32 s56, s56, 14336
  s_add_u32 s91, s91, 30720
  s_cmp_eq_u32 s91, 153600
  s_cselect_b32 s91, 0, s91
  s_cmp_eq_u32 s56, s95
  s_cselect_b32 s56, s94, s56
  s_add_u32 m0, s91, 18432
  s_nop 0
  buffer_load_dwordx4 v28, s[36:39], s56 offen sc1 lds
  s_add_u32 m0, s91, 21504
  s_nop 0
  buffer_load_dwordx4 v29, s[36:39], s56 offen sc1 lds
  s_add_u32 m0, s91, 24576
  s_nop 0
  buffer_load_dwordx4 v30, s[36:39], s56 offen sc1 lds
  s_add_u32 m0, s91, 27648
  s_nop 0
  buffer_load_dwordx4 v31, s[36:39], s56 offen sc1 lds
  s_add_u32 s56, s56, 14336
  s_add_u32 s91, s91, 30720
  s_cmp_eq_u32 s91, 153600
  s_cselect_b32 s91, 0, s91
  s_cmp_eq_u32 s56, s95
  s_cselect_b32 s56, s94, s56
  s_add_u32 m0, s91, 18432
  s_nop 0
  buffer_load_dwordx4 v28, s[36:39], s56 offen sc1 lds
  s_add_u32 m0, s91, 21504
  s_nop 0
  buffer_load_dwordx4 v29, s[36:39], s56 offen sc1 lds
  s_add_u32 m0, s91, 24576
  s_nop 0
  buffer_load_dwordx4 v30, s[36:39], s56 offen sc1 lds
  s_add_u32 m0, s91, 27648
  s_nop 0
  buffer_load_dwordx4 v31, s[36:39], s56 offen sc1 lds
  s_add_u32 s56, s56, 14336
  s_add_u32 s91, s91, 30720
  s_cmp_eq_u32 s91, 153600
  s_cselect_b32 s91, 0, s91
  s_cmp_eq_u32 s56, s95
  s_cselect_b32 s56, s94, s56
  s_add_u32 m0, s91, 18432
  s_nop 0
  buffer_load_dwordx4 v28, s[36:39], s56 offen sc1 lds
  s_add_u32 m0, s91, 21504
  s_nop 0
  buffer_load_dwordx4 v29, s[36:39], s56 offen sc1 lds
  s_add_u32 m0, s91, 24576
  s_nop 0
  buffer_load_dwordx4 v30, s[36:39], s56 offen sc1 lds
  s_add_u32 m0, s91, 27648
  s_nop 0
  buffer_load_dwordx4 v31, s[36:39], s56 offen sc1 lds
  s_add_u32 s56, s56, 14336
  s_add_u32 s91, s91, 30720
  s_cmp_eq_u32 s91, 153600
  s_cselect_b32 s91, 0, s91
  s_cmp_eq_u32 s56, s95
  s_cselect_b32 s56, s94, s56
  s_add_u32 m0, s90, 0
  s_nop 0
  buffer_load_dwordx4 v22, s[32:35], s55 offen  lds
  s_add_u32 m0, s90, 3072
  s_nop 0
  buffer_load_dwordx4 v23, s[32:35], s55 offen  lds
  s_add_u32 m0, s90, 6144
  s_nop 0
  buffer_load_dwordx4 v24, s[32:35], s55 offen  lds
  s_add_u32 m0, s90, 9216
  s_nop 0
  buffer_load_dwordx4 v25, s[32:35], s55 offen  lds
  s_add_u32 m0, s90, 12288
  s_nop 0
  buffer_load_dwordx4 v26, s[32:35], s55 offen  lds
  s_add_u32 m0, s90, 15360
  s_nop 0
  buffer_load_dwordx4 v27, s[32:35], s55 offen  lds
  s_add_u32 s55, s55, 128
  s_add_u32 s90, s90, 30720
  s_cmp_eq_u32 s90, 153600
  s_cselect_b32 s90, 0, s90
  s_and_b32 s55, s55, 4095
  s_add_u32 m0, s91, 18432
  s_nop 0
  buffer_load_dwordx4 v28, s[36:39], s56 offen sc1 lds
  s_add_u32 m0, s91, 21504
  s_nop 0
  buffer_load_dwordx4 v29, s[36:39], s56 offen sc1 lds
  s_add_u32 m0, s91, 24576
  s_nop 0
  buffer_load_dwordx4 v30, s[36:39], s56 offen sc1 lds
  s_add_u32 m0, s91, 27648
  s_nop 0
  buffer_load_dwordx4 v31, s[36:39], s56 offen sc1 lds
  s_add_u32 s56, s56, 14336
  s_add_u32 s91, s91, 30720
  s_cmp_eq_u32 s91, 153600
  s_cselect_b32 s91, 0, s91
  s_cmp_eq_u32 s56, s95
  s_cselect_b32 s56, s94, s56
  s_waitcnt vmcnt(22)
  s_barrier
  s_waitcnt vmcnt(18)
  s_barrier
  s_add_u32 m0, s90, 0
  s_nop 0
  buffer_load_dwordx4 v22, s[32:35], s55 offen  lds
  s_add_u32 m0, s90, 3072
  s_nop 0
  buffer_load_dwordx4 v23, s[32:35], s55 offen  lds
  s_add_u32 m0, s90, 6144
  s_nop 0
  buffer_load_dwordx4 v24, s[32:35], s55 offen  lds
  s_add_u32 m0, s90, 9216
  s_nop 0
  buffer_load_dwordx4 v25, s[32:35], s55 offen  lds
  s_add_u32 m0, s90, 12288
  s_nop 0
  buffer_load_dwordx4 v26, s[32:35], s55 offen  lds
  s_add_u32 m0, s90, 15360
  s_nop 0
  buffer_load_dwordx4 v27, s[32:35], s55 offen  lds
  s_add_u32 s55, s55, 128
  s_add_u32 s90, s90, 30720
  s_cmp_eq_u32 s90, 153600
  s_cselect_b32 s90, 0, s90
  s_and_b32 s55, s55, 4095
  s_add_u32 m0, s91, 18432
  s_nop 0
  buffer_load_dwordx4 v28, s[36:39], s56 offen sc1 lds
  s_add_u32 m0, s91, 21504
  s_nop 0
  buffer_load_dwordx4 v29, s[36:39], s56 offen sc1 lds
  s_add_u32 m0, s91, 24576
  s_nop 0
  buffer_load_dwordx4 v30, s[36:39], s56 offen sc1 lds
  s_add_u32 m0, s91, 27648
  s_nop 0
  buffer_load_dwordx4 v31, s[36:39], s56 offen sc1 lds
  s_add_u32 s56, s56, 14336
  s_add_u32 s91, s91, 30720
  s_cmp_eq_u32 s91, 153600
  s_cselect_b32 s91, 0, s91
  s_cmp_eq_u32 s56, s95
  s_cselect_b32 s56, s94, s56
  s_waitcnt vmcnt(24)
  s_barrier
  s_add_u32 m0, s90, 0
  s_nop 0
  buffer_load_dwordx4 v22, s[32:35], s55 offen  lds
  s_add_u32 m0, s90, 3072
  s_nop 0
  buffer_load_dwordx4 v23, s[32:35], s55 offen  lds
  s_add_u32 m0, s90, 6144
  s_nop 0
  buffer_load_dwordx4 v24, s[32:35], s55 offen  lds
  s_add_u32 m0, s90, 9216
  s_nop 0
  buffer_load_dwordx4 v25, s[32:35], s55 offen  lds
  s_add_u32 m0, s90, 12288
  s_nop 0
  buffer_load_dwordx4 v26, s[32:35], s55 offen  lds
  s_add_u32 m0, s90, 15360
  s_nop 0
  buffer_load_dwordx4 v27, s[32:35], s55 offen  lds
  s_add_u32 s55, s55, 128
  s_add_u32 s90, s90, 30720
  s_cmp_eq_u32 s90, 153600
  s_cselect_b32 s90, 0, s90
  s_and_b32 s55, s55, 4095
  s_add_u32 m0, s91, 18432
  s_nop 0
  buffer_load_dwordx4 v28, s[36:39], s56 offen sc1 lds
  s_add_u32 m0, s91, 21504
  s_nop 0
  buffer_load_dwordx4 v29, s[36:39], s56 offen sc1 lds
  s_add_u32 m0, s91, 24576
  s_nop 0
  buffer_load_dwordx4 v30, s[36:39], s56 offen sc1 lds
  s_add_u32 m0, s91, 27648
  s_nop 0
  buffer_load_dwordx4 v31, s[36:39], s56 offen sc1 lds
  s_add_u32 s56, s56, 14336
  s_add_u32 s91, s91, 30720
  s_cmp_eq_u32 s91, 153600
  s_cselect_b32 s91, 0, s91
  s_cmp_eq_u32 s56, s95
  s_cselect_b32 s56, s94, s56
  s_mov_b32 s52, 25
p34_l0_4:
  s_waitcnt vmcnt(30)
  s_barrier
  s_add_u32 m0, s90, 0
  s_nop 0
  buffer_load_dwordx4 v22, s[32:35], s55 offen  lds
  s_add_u32 m0, s90, 3072
  s_nop 0
  buffer_load_dwordx4 v23, s[32:35], s55 offen  lds
  s_add_u32 m0, s90, 6144
  s_nop 0
  buffer_load_dwordx4 v24, s[32:35], s55 offen  lds
  s_add_u32 m0, s90, 9216
  s_nop 0
  buffer_load_dwordx4 v25, s[32:35], s55 offen  lds
  s_add_u32 m0, s90, 12288
  s_nop 0
  buffer_load_dwordx4 v26, s[32:35], s55 offen  lds
  s_add_u32 m0, s90, 15360
  s_nop 0
  buffer_load_dwordx4 v27, s[32:35], s55 offen  lds
  s_add_u32 s55, s55, 128
  s_add_u32 s90, s90, 30720
  s_cmp_eq_u32 s90, 153600
  s_cselect_b32 s90, 0, s90
  s_and_b32 s55, s55, 4095
  s_add_u32 m0, s91, 18432
  s_nop 0
  buffer_load_dwordx4 v28, s[36:39], s56 offen sc1 lds
  s_add_u32 m0, s91, 21504
  s_nop 0
  buffer_load_dwordx4 v29, s[36:39], s56 offen sc1 lds
  s_add_u32 m0, s91, 24576
  s_nop 0
  buffer_load_dwordx4 v30, s[36:39], s56 offen sc1 lds
  s_add_u32 m0, s91, 27648
  s_nop 0
  buffer_load_dwordx4 v31, s[36:39], s56 offen sc1 lds
  s_add_u32 s56, s56, 14336
  s_add_u32 s91, s91, 30720
  s_cmp_eq_u32 s91, 153600
  s_cselect_b32 s91, 0, s91
  s_cmp_eq_u32 s56, s95
  s_cselect_b32 s56, s94, s56
  s_sub_u32 s52, s52, 1
  s_cmp_lg_u32 s52, 0
  s_cbranch_scc1 p34_l0_4
  s_waitcnt vmcnt(30)
  s_barrier
  s_waitcnt vmcnt(20)
  s_barrier
  s_waitcnt vmcnt(10)
  s_barrier
  s_waitcnt vmcnt(0)
  s_barrier
  s_barrier
  s_mov_b32 s44, s59
  s_mov_b32 s45, s60
  s_add_u32 s24, s4, 0x1c00000
  s_addc_u32 s25, s5, 0x0
  s_mov_b32 s26, 0x700000
  s_mov_b32 s27, 0x20000
  s_mov_b32 s28, s18
  s_mov_b32 s29, s19
  s_mov_b32 s30, 0x380000
  s_mov_b32 s31, 0x20000
  v_lshrrev_b32 v1, 3, v0
  v_and_b32 v2, 7, v0
  v_and_b32 v3, 2, v1
  v_xor_b32 v3, v2, v3
  v_lshlrev_b32 v3, 4, v3
  s_mov_b32 s47, 2048
  v_mul_lo_u32 v9, v1, s47
  v_add_u32 v9, v9, v3
  v_lshrrev_b32 v1, 3, v0
  v_and_b32 v2, 7, v0
  v_and_b32 v3, 6, v1
  v_xor_b32 v2, v2, v3
  v_lshrrev_b32 v3, 2, v2
  v_lshlrev_b32 v8, 13, v3
  v_lshl_add_u32 v8, v1, 6, v8
  v_and_b32 v3, 3, v2
  v_lshl_add_u32 v8, v3, 4, v8
  s_mul_i32 s49, s44, 458752
  v_add_u32 v8, s49, v8
  s_lshl_b32 s49, s45, 7
  v_add_u32 v9, s49, v9
  v_add_u32 v16, 0, v8
  v_add_u32 v17, 1536, v8
  v_add_u32 v18, 3072, v8
  v_add_u32 v19, 4608, v8
  v_add_u32 v20, 6144, v8
  v_add_u32 v21, 7680, v8
  v_add_u32 v22, 32768, v9
  v_add_u32 v23, 81920, v9
  v_xor_b32 v23, 64, v23
  s_barrier
  s_barrier
  s_mov_b32 s55, 0
  s_mov_b32 s56, 0
  s_mov_b32 s90, 0
  s_mov_b32 s91, 0
  s_add_u32 m0, s91, 18432
  s_nop 0
  buffer_load_dwordx4 v22, s[28:31], s56 offen  lds
  s_add_u32 m0, s91, 21504
  s_nop 0
  buffer_load_dwordx4 v23, s[28:31], s56 offen  lds
  s_add_u32 s56, s56, 131072
  s_add_u32 s91, s91, 24576
  s_cmp_eq_u32 s91, 147456
  s_cselect_b32 s91, 0, s91
  s_add_u32 m0, s91, 18432
  s_nop 0
  buffer_load_dwordx4 v22, s[28:31], s56 offen  lds
  s_add_u32 m0, s91, 21504
  s_nop 0
  buffer_load_dwordx4 v23, s[28:31], s56 offen  lds
  s_add_u32 s56, s56, 131072
  s_add_u32 s91, s91, 24576
  s_cmp_eq_u32 s91, 147456
  s_cselect_b32 s91, 0, s91
  s_add_u32 m0, s91, 18432
  s_nop 0
  buffer_load_dwordx4 v22, s[28:31], s56 offen  lds
  s_add_u32 m0, s91, 21504
  s_nop 0
  buffer_load_dwordx4 v23, s[28:31], s56 offen  lds
  s_add_u32 s56, s56, 131072
  s_add_u32 s91, s91, 24576
  s_cmp_eq_u32 s91, 147456
  s_cselect_b32 s91, 0, s91
  s_add_u32 m0, s91, 18432
  s_nop 0
  buffer_load_dwordx4 v22, s[28:31], s56 offen  lds
  s_add_u32 m0, s91, 21504
  s_nop 0
  buffer_load_dwordx4 v23, s[28:31], s56 offen  lds
  s_add_u32 s56, s56, 131072
  s_add_u32 s91, s91, 24576
  s_cmp_eq_u32 s91, 147456
  s_cselect_b32 s91, 0, s91
  s_add_u32 m0, s91, 18432
  s_nop 0
  buffer_load_dwordx4 v22, s[28:31], s56 offen  lds
  s_add_u32 m0, s91, 21504
  s_nop 0
  buffer_load_dwordx4 v23, s[28:31], s56 offen  lds
  s_add_u32 s56, s56, 131072
  s_add_u32 s91, s91, 24576
  s_cmp_eq_u32 s91, 147456
  s_cselect_b32 s91, 0, s91
  s_add_u32 m0, s91, 18432
  s_nop 0
  buffer_load_dwordx4 v22, s[28:31], s56 offen  lds
  s_add_u32 m0, s91, 21504
  s_nop 0
  buffer_load_dwordx4 v23, s[28:31], s56 offen  lds
  s_add_u32 s56, s56, 131072
  s_add_u32 s91, s91, 24576
  s_cmp_eq_u32 s91, 147456
  s_cselect_b32 s91, 0, s91
  s_barrier
  s_barrier
  s_add_u32 m0, s90, 0
  s_nop 0
  buffer_load_dwordx4 v16, s[24:27], s55 offen sc1 lds
  s_add_u32 m0, s90, 3072
  s_nop 0
  buffer_load_dwordx4 v17, s[24:27], s55 offen sc1 lds
  s_add_u32 m0, s90, 6144
  s_nop 0
  buffer_load_dwordx4 v18, s[24:27], s55 offen sc1 lds
  s_add_u32 m0, s90, 9216
  s_nop 0
  buffer_load_dwordx4 v19, s[24:27], s55 offen sc1 lds
  s_add_u32 m0, s90, 12288
  s_nop 0
  buffer_load_dwordx4 v20, s[24:27], s55 offen sc1 lds
  s_add_u32 m0, s90, 15360
  s_nop 0
  buffer_load_dwordx4 v21, s[24:27], s55 offen sc1 lds
  s_add_u32 s55, s55, 16384
  s_add_u32 s90, s90, 24576
  s_cmp_eq_u32 s90, 147456
  s_cselect_b32 s90, 0, s90
  s_add_u32 m0, s90, 0
  s_nop 0
  buffer_load_dwordx4 v16, s[24:27], s55 offen sc1 lds
  s_add_u32 m0, s90, 3072
  s_nop 0
  buffer_load_dwordx4 v17, s[24:27], s55 offen sc1 lds
  s_add_u32 m0, s90, 6144
  s_nop 0
  buffer_load_dwordx4 v18, s[24:27], s55 offen sc1 lds
  s_add_u32 m0, s90, 9216
  s_nop 0
  buffer_load_dwordx4 v19, s[24:27], s55 offen sc1 lds
  s_add_u32 m0, s90, 12288
  s_nop 0
  buffer_load_dwordx4 v20, s[24:27], s55 offen sc1 lds
  s_add_u32 m0, s90, 15360
  s_nop 0
  buffer_load_dwordx4 v21, s[24:27], s55 offen sc1 lds
  s_add_u32 s55, s55, 16384
  s_add_u32 s90, s90, 24576
  s_cmp_eq_u32 s90, 147456
  s_cselect_b32 s90, 0, s90
  s_add_u32 m0, s90, 0
  s_nop 0
  buffer_load_dwordx4 v16, s[24:27], s55 offen sc1 lds
  s_add_u32 m0, s90, 3072
  s_nop 0
  buffer_load_dwordx4 v17, s[24:27], s55 offen sc1 lds
  s_add_u32 m0, s90, 6144
  s_nop 0
  buffer_load_dwordx4 v18, s[24:27], s55 offen sc1 lds
  s_add_u32 m0, s90, 9216
  s_nop 0
  buffer_load_dwordx4 v19, s[24:27], s55 offen sc1 lds
  s_add_u32 m0, s90, 12288
  s_nop 0
  buffer_load_dwordx4 v20, s[24:27], s55 offen sc1 lds
  s_add_u32 m0, s90, 15360
  s_nop 0
  buffer_load_dwordx4 v21, s[24:27], s55 offen sc1 lds
  s_add_u32 s55, s55, 16384
  s_add_u32 s90, s90, 24576
  s_cmp_eq_u32 s90, 147456
  s_cselect_b32 s90, 0, s90
  s_add_u32 m0, s90, 0
  s_nop 0
  buffer_load_dwordx4 v16, s[24:27], s55 offen sc1 lds
  s_add_u32 m0, s90, 3072
  s_nop 0
  buffer_load_dwordx4 v17, s[24:27], s55 offen sc1 lds
  s_add_u32 m0, s90, 6144
  s_nop 0
  buffer_load_dwordx4 v18, s[24:27], s55 offen sc1 lds
  s_add_u32 m0, s90, 9216
  s_nop 0
  buffer_load_dwordx4 v19, s[24:27], s55 offen sc1 lds
  s_add_u32 m0, s90, 12288
  s_nop 0
  buffer_load_dwordx4 v20, s[24:27], s55 offen sc1 lds
  s_add_u32 m0, s90, 15360
  s_nop 0
  buffer_load_dwordx4 v21, s[24:27], s55 offen sc1 lds
  s_add_u32 s55, s55, 16384
  s_add_u32 s90, s90, 24576
  s_cmp_eq_u32 s90, 147456
  s_cselect_b32 s90, 0, s90
  s_add_u32 m0, s90, 0
  s_nop 0
  buffer_load_dwordx4 v16, s[24:27], s55 offen sc1 lds
  s_add_u32 m0, s90, 3072
  s_nop 0
  buffer_load_dwordx4 v17, s[24:27], s55 offen sc1 lds
  s_add_u32 m0, s90, 6144
  s_nop 0
  buffer_load_dwordx4 v18, s[24:27], s55 offen sc1 lds
  s_add_u32 m0, s90, 9216
  s_nop 0
  buffer_load_dwordx4 v19, s[24:27], s55 offen sc1 lds
  s_add_u32 m0, s90, 12288
  s_nop 0
  buffer_load_dwordx4 v20, s[24:27], s55 offen sc1 lds
  s_add_u32 m0, s90, 15360
  s_nop 0
  buffer_load_dwordx4 v21, s[24:27], s55 offen sc1 lds
  s_add_u32 s55, s55, 16384
  s_add_u32 s90, s90, 24576
  s_cmp_eq_u32 s90, 147456
  s_cselect_b32 s90, 0, s90
  s_add_u32 m0, s90, 0
  s_nop 0
  buffer_load_dwordx4 v16, s[24:27], s55 offen sc1 lds
  s_add_u32 m0, s90, 3072
  s_nop 0
  buffer_load_dwordx4 v17, s[24:27], s55 offen sc1 lds
  s_add_u32 m0, s90, 6144
  s_nop 0
  buffer_load_dwordx4 v18, s[24:27], s55 offen sc1 lds
  s_add_u32 m0, s90, 9216
  s_nop 0
  buffer_load_dwordx4 v19, s[24:27], s55 offen sc1 lds
  s_add_u32 m0, s90, 12288
  s_nop 0
  buffer_load_dwordx4 v20, s[24:27], s55 offen sc1 lds
  s_add_u32 m0, s90, 15360
  s_nop 0
  buffer_load_dwordx4 v21, s[24:27], s55 offen sc1 lds
  s_add_u32 s55, s55, 16384
  s_add_u32 s90, s90, 24576
  s_cmp_eq_u32 s90, 147456
  s_cselect_b32 s90, 0, s90
  s_waitcnt vmcnt(30)
  s_barrier
  s_waitcnt vmcnt(24)
  s_barrier
  s_add_u32 m0, s90, 0
  s_nop 0
  buffer_load_dwordx4 v16, s[24:27], s55 offen sc1 lds
  s_add_u32 m0, s90, 3072
  s_nop 0
  buffer_load_dwordx4 v17, s[24:27], s55 offen sc1 lds
  s_add_u32 m0, s90, 6144
  s_nop 0
  buffer_load_dwordx4 v18, s[24:27], s55 offen sc1 lds
  s_add_u32 m0, s90, 9216
  s_nop 0
  buffer_load_dwordx4 v19, s[24:27], s55 offen sc1 lds
  s_add_u32 m0, s90, 12288
  s_nop 0
  buffer_load_dwordx4 v20, s[24:27], s55 offen sc1 lds
  s_add_u32 m0, s90, 15360
  s_nop 0
  buffer_load_dwordx4 v21, s[24:27], s55 offen sc1 lds
  s_add_u32 s55, s55, 16384
  s_add_u32 s90, s90, 24576
  s_cmp_eq_u32 s90, 147456
  s_cselect_b32 s90, 0, s90
  s_add_u32 m0, s91, 18432
  s_nop 0
  buffer_load_dwordx4 v22, s[28:31], s56 offen  lds
  s_add_u32 m0, s91, 21504
  s_nop 0
  buffer_load_dwordx4 v23, s[28:31], s56 offen  lds
  s_add_u32 s56, s56, 131072
  s_add_u32 s91, s91, 24576
  s_cmp_eq_u32 s91, 147456
  s_cselect_b32 s91, 0, s91
  s_waitcnt vmcnt(26)
  s_barrier
  s_add_u32 m0, s90, 0
  s_nop 0
  buffer_load_dwordx4 v16, s[24:27], s55 offen sc1 lds
  s_add_u32 m0, s90, 3072
  s_nop 0
  buffer_load_dwordx4 v17, s[24:27], s55 offen sc1 lds
  s_add_u32 m0, s90, 6144
  s_nop 0
  buffer_load_dwordx4 v18, s[24:27], s55 offen sc1 lds
  s_add_u32 m0, s90, 9216
  s_nop 0
  buffer_load_dwordx4 v19, s[24:27], s55 offen sc1 lds
  s_add_u32 m0, s90, 12288
  s_nop 0
  buffer_load_dwordx4 v20, s[24:27], s55 offen sc1 lds
  s_add_u32 m0, s90, 15360
  s_nop 0
  buffer_load_dwordx4 v21, s[24:27], s55 offen sc1 lds
  s_add_u32 s55, s55, 16384
  s_add_u32 s90, s90, 24576
  s_cmp_eq_u32 s90, 147456
  s_cselect_b32 s90, 0, s90
  s_add_u32 m0, s91, 18432
  s_nop 0
  buffer_load_dwordx4 v22, s[28:31], s56 offen  lds
  s_add_u32 m0, s91, 21504
  s_nop 0
  buffer_load_dwordx4 v23, s[28:31], s56 offen  lds
  s_add_u32 s56, s56, 131072
  s_add_u32 s91, s91, 24576
  s_cmp_eq_u32 s91, 147456
  s_cselect_b32 s91, 0, s91
  s_waitcnt vmcnt(28)
  s_barrier
  s_add_u32 m0, s90, 0
  s_nop 0
  buffer_load_dwordx4 v16, s[24:27], s55 offen sc1 lds
  s_add_u32 m0, s90, 3072
  s_nop 0
  buffer_load_dwordx4 v17, s[24:27], s55 offen sc1 lds
  s_add_u32 m0, s90, 6144
  s_nop 0
  buffer_load_dwordx4 v18, s[24:27], s55 offen sc1 lds
  s_add_u32 m0, s90, 9216
  s_nop 0
  buffer_load_dwordx4 v19, s[24:27], s55 offen sc1 lds
  s_add_u32 m0, s90, 12288
  s_nop 0
  buffer_load_dwordx4 v20, s[24:27], s55 offen sc1 lds
  s_add_u32 m0, s90, 15360
  s_nop 0
  buffer_load_dwordx4 v21, s[24:27], s55 offen sc1 lds
  s_add_u32 s55, s55, 16384
  s_add_u32 s90, s90, 24576
  s_cmp_eq_u32 s90, 147456
  s_cselect_b32 s90, 0, s90
  s_add_u32 m0, s91, 18432
  s_nop 0
  buffer_load_dwordx4 v22, s[28:31], s56 offen  lds
  s_add_u32 m0, s91, 21504
  s_nop 0
  buffer_load_dwordx4 v23, s[28:31], s56 offen  lds
  s_add_u32 s56, s56, 131072
  s_add_u32 s91, s91, 24576
  s_cmp_eq_u32 s91, 147456
  s_cselect_b32 s91, 0, s91
  s_waitcnt vmcnt(30)
  s_barrier
  s_add_u32 m0, s90, 0
  s_nop 0
  buffer_load_dwordx4 v16, s[24:27], s55 offen sc1 lds
  s_add_u32 m0, s90, 3072
  s_nop 0
  buffer_load_dwordx4 v17, s[24:27], s55 offen sc1 lds
  s_add_u32 m0, s90, 6144
  s_nop 0
  buffer_load_dwordx4 v18, s[24:27], s55 offen sc1 lds
  s_add_u32 m0, s90, 9216
  s_nop 0
  buffer_load_dwordx4 v19, s[24:27], s55 offen sc1 lds
  s_add_u32 m0, s90, 12288
  s_nop 0
  buffer_load_dwordx4 v20, s[24:27], s55 offen sc1 lds
  s_add_u32 m0, s90, 15360
  s_nop 0
  buffer_load_dwordx4 v21, s[24:27], s55 offen sc1 lds
  s_add_u32 s55, s55, 16384
  s_add_u32 s90, s90, 24576
  s_cmp_eq_u32 s90, 147456
  s_cselect_b32 s90, 0, s90
  s_add_u32 m0, s91, 18432
  s_nop 0
  buffer_load_dwordx4 v22, s[28:31], s56 offen  lds
  s_add_u32 m0, s91, 21504
  s_nop 0
  buffer_load_dwordx4 v23, s[28:31], s56 offen  lds
  s_add_u32 s56, s56, 131072
  s_add_u32 s91, s91, 24576
  s_cmp_eq_u32 s91, 147456
  s_cselect_b32 s91, 0, s91
  s_mov_b32 s52, 18
p5_l0_0:
  s_waitcnt vmcnt(32)
  s_barrier
  s_add_u32 m0, s90, 0
  s_nop 0
  buffer_load_dwordx4 v16, s[24:27], s55 offen sc1 lds
  s_add_u32 m0, s90, 3072
  s_nop 0
  buffer_load_dwordx4 v17, s[24:27], s55 offen sc1 lds
  s_add_u32 m0, s90, 6144
  s_nop 0
  buffer_load_dwordx4 v18, s[24:27], s55 offen sc1 lds
  s_add_u32 m0, s90, 9216
  s_nop 0
  buffer_load_dwordx4 v19, s[24:27], s55 offen sc1 lds
  s_add_u32 m0, s90, 12288
  s_nop 0
  buffer_load_dwordx4 v20, s[24:27], s55 offen sc1 lds
  s_add_u32 m0, s90, 15360
  s_nop 0
  buffer_load_dwordx4 v21, s[24:27], s55 offen sc1 lds
  s_add_u32 s55, s55, 16384
  s_add_u32 s90, s90, 24576
  s_cmp_eq_u32 s90, 147456
  s_cselect_b32 s90, 0, s90
  s_add_u32 m0, s91, 18432
  s_nop 0
  buffer_load_dwordx4 v22, s[28:31], s56 offen  lds
  s_add_u32 m0, s91, 21504
  s_nop 0
  buffer_load_dwordx4 v23, s[28:31], s56 offen  lds
  s_add_u32 s56, s56, 131072
  s_add_u32 s91, s91, 24576
  s_cmp_eq_u32 s91, 147456
  s_cselect_b32 s91, 0, s91
  s_sub_u32 s52, s52, 1
  s_cmp_lg_u32 s52, 0
  s_cbranch_scc1 p5_l0_0
  s_waitcnt vmcnt(32)
  s_barrier
  s_waitcnt vmcnt(24)
  s_barrier
  s_waitcnt vmcnt(16)
  s_barrier
  s_waitcnt vmcnt(8)
  s_barrier
  s_waitcnt vmcnt(0)
  s_barrier
  s_barrier
  s_barrier
  s_endpgm
mk_ld1:
  s_mov_b32 s44, s57
  s_mov_b32 s45, s58
  v_lshrrev_b32 v1, 3, v0
  v_and_b32 v2, 7, v0
  v_and_b32 v3, 6, v1
  v_xor_b32 v3, v2, v3
  v_lshlrev_b32 v3, 4, v3
  s_mov_b32 s47, 2048
  v_mul_lo_u32 v8, v1, s47
  v_add_u32 v8, v8, v3
  v_and_b32 v3, 2, v1
  v_xor_b32 v3, v2, v3
  v_lshlrev_b32 v3, 4, v3
  s_mov_b32 s47, 6144
  v_mul_lo_u32 v9, v1, s47
  v_add_u32 v9, v9, v3
  v_and_b32 v10, 0x7f, v8
  s_lshl_b32 s49, s44, 18
  s_sub_u32 s49, s49, 32768
  v_add_u32 v8, s49, v8
  s_lshl_b32 s49, s45, 7
  v_add_u32 v9, s49, v9
  v_add_u32 v16, 16384, v8
  v_max_i32 v16, v16, v10
  v_add_u32 v17, 65536, v8
  v_add_u32 v18, 114688, v8
  v_add_u32 v19, 163840, v8
  v_add_u32 v20, 212992, v8
  v_add_u32 v21, 262144, v8
  v_add_u32 v22, 49152, v9
  v_xor_b32 v22, 64, v22
  v_add_u32 v23, 196608, v9
  v_add_u32 v24, 344064, v9
  v_xor_b32 v24, 64, v24
  v_add_u32 v25, 100352, v9
  v_add_u32 v26, 247808, v9
  v_xor_b32 v26, 64, v26
  v_add_u32 v27, 4096, v9
  v_add_u32 v28, 151552, v9
  v_xor_b32 v28, 64, v28
  v_add_u32 v29, 299008, v9
  s_waitcnt lgkmcnt(0)
  s_mov_b32 s24, s72
  s_mov_b32 s25, s73
  s_mov_b32 s26, 0x400000
  s_mov_b32 s27, 0x20000
  s_mov_b32 s28, s74
  s_mov_b32 s29, s75
  s_mov_b32 s30, 0x600000
  s_mov_b32 s31, 0x20000
  s_mov_b32 s55, 0
  s_mov_b32 s56, 0
  s_mov_b32 s90, 0
  s_mov_b32 s91, 0
  s_mul_i32 s55, s44, 128
  s_mul_i32 s56, s44, 393216
  s_add_u32 m0, s90, 1024
  s_nop 0
  buffer_load_dwordx4 v16, s[24:27], s55 offen  lds
  s_add_u32 m0, s90, 4096
  s_nop 0
  buffer_load_dwordx4 v17, s[24:27], s55 offen  lds
  s_add_u32 m0, s90, 7168
  s_nop 0
  buffer_load_dwordx4 v18, s[24:27], s55 offen  lds
  s_add_u32 m0, s90, 10240
  s_nop 0
  buffer_load_dwordx4 v19, s[24:27], s55 offen  lds
  s_add_u32 m0, s90, 13312
  s_nop 0
  buffer_load_dwordx4 v20, s[24:27], s55 offen  lds
  s_add_u32 m0, s90, 16384
  s_nop 0
  buffer_load_dwordx4 v21, s[24:27], s55 offen  lds
  s_add_u32 s55, s55, 128
  s_add_u32 s90, s90, 43008
  s_cmp_eq_u32 s90, 129024
  s_cselect_b32 s90, 0, s90
  s_cmp_eq_u32 s55, 2048
  s_cselect_b32 s55, 0, s55
  s_add_u32 m0, s91, 19456
  s_nop 0
  buffer_load_dwordx4 v22, s[28:31], s56 offen  lds
  s_add_u32 m0, s91, 22528
  s_nop 0
  buffer_load_dwordx4 v23, s[28:31], s56 offen  lds
  s_add_u32 m0, s91, 25600
  s_nop 0
  buffer_load_dwordx4 v24, s[28:31], s56 offen  lds
  s_add_u32 m0, s91, 28672
  s_nop 0
  buffer_load_dwordx4 v25, s[28:31], s56 offen  lds
  s_add_u32 m0, s91, 31744
  s_nop 0
  buffer_load_dwordx4 v26, s[28:31], s56 offen  lds
  s_add_u32 m0, s91, 34816
  s_nop 0
  buffer_load_dwordx4 v27, s[28:31], s56 offen  lds
  s_add_u32 m0, s91, 37888
  s_nop 0
  buffer_load_dwordx4 v28, s[28:31], s56 offen  lds
  s_add_u32 m0, s91, 40960
  s_nop 0
  buffer_load_dwordx4 v29, s[28:31], s56 offen  lds
  s_add_u32 s56, s56, 393216
  s_add_u32 s91, s91, 43008
  s_cmp_eq_u32 s91, 129024
  s_cselect_b32 s91, 0, s91
  s_cmp_eq_u32 s56, 6291456
  s_cselect_b32 s56, 0, s56
  s_add_u32 m0, s90, 1024
  s_nop 0
  buffer_load_dwordx4 v16, s[24:27], s55 offen  lds
  s_add_u32 m0, s90, 4096
  s_nop 0
  buffer_load_dwordx4 v17, s[24:27], s55 offen  lds
  s_add_u32 m0, s90, 7168
  s_nop 0
  buffer_load_dwordx4 v18, s[24:27], s55 offen  lds
  s_add_u32 m0, s90, 10240
  s_nop 0
  buffer_load_dwordx4 v19, s[24:27], s55 offen  lds
  s_add_u32 m0, s90, 13312
  s_nop 0
  buffer_load_dwordx4 v20, s[24:27], s55 offen  lds
  s_add_u32 m0, s90, 16384
  s_nop 0
  buffer_load_dwordx4 v21, s[24:27], s55 offen  lds
  s_add_u32 s55, s55, 128
  s_add_u32 s90, s90, 43008
  s_cmp_eq_u32 s90, 129024
  s_cselect_b32 s90, 0, s90
  s_cmp_eq_u32 s55, 2048
  s_cselect_b32 s55, 0, s55
  s_add_u32 m0, s91, 19456
  s_nop 0
  buffer_load_dwordx4 v22, s[28:31], s56 offen  lds
  s_add_u32 m0, s91, 22528
  s_nop 0
  buffer_load_dwordx4 v23, s[28:31], s56 offen  lds
  s_add_u32 m0, s91, 25600
  s_nop 0
  buffer_load_dwordx4 v24, s[28:31], s56 offen  lds
  s_add_u32 m0, s91, 28672
  s_nop 0
  buffer_load_dwordx4 v25, s[28:31], s56 offen  lds
  s_add_u32 m0, s91, 31744
  s_nop 0
  buffer_load_dwordx4 v26, s[28:31], s56 offen  lds
  s_add_u32 m0, s91, 34816
  s_nop 0
  buffer_load_dwordx4 v27, s[28:31], s56 offen  lds
  s_add_u32 m0, s91, 37888
  s_nop 0
  buffer_load_dwordx4 v28, s[28:31], s56 offen  lds
  s_add_u32 m0, s91, 40960
  s_nop 0
  buffer_load_dwordx4 v29, s[28:31], s56 offen  lds
  s_add_u32 s56, s56, 393216
  s_add_u32 s91, s91, 43008
  s_cmp_eq_u32 s91, 129024
  s_cselect_b32 s91, 0, s91
  s_cmp_eq_u32 s56, 6291456
  s_cselect_b32 s56, 0, s56
  s_add_u32 m0, s90, 1024
  s_nop 0
  buffer_load_dwordx4 v16, s[24:27], s55 offen  lds
  s_add_u32 m0, s90, 4096
  s_nop 0
  buffer_load_dwordx4 v17, s[24:27], s55 offen  lds
  s_add_u32 m0, s90, 7168
  s_nop 0
  buffer_load_dwordx4 v18, s[24:27], s55 offen  lds
  s_add_u32 m0, s90, 10240
  s_nop 0
  buffer_load_dwordx4 v19, s[24:27], s55 offen  lds
  s_add_u32 m0, s90, 13312
  s_nop 0
  buffer_load_dwordx4 v20, s[24:27], s55 offen  lds
  s_add_u32 m0, s90, 16384
  s_nop 0
  buffer_load_dwordx4 v21, s[24:27], s55 offen  lds
  s_add_u32 s55, s55, 128
  s_add_u32 s90, s90, 43008
  s_cmp_eq_u32 s90, 129024
  s_cselect_b32 s90, 0, s90
  s_cmp_eq_u32 s55, 2048
  s_cselect_b32 s55, 0, s55
  s_add_u32 m0, s91, 19456
  s_nop 0
  buffer_load_dwordx4 v22, s[28:31], s56 offen  lds
  s_add_u32 m0, s91, 22528
  s_nop 0
  buffer_load_dwordx4 v23, s[28:31], s56 offen  lds
  s_add_u32 m0, s91, 25600
  s_nop 0
  buffer_load_dwordx4 v24, s[28:31], s56 offen  lds
  s_add_u32 m0, s91, 28672
  s_nop 0
  buffer_load_dwordx4 v25, s[28:31], s56 offen  lds
  s_add_u32 m0, s91, 31744
  s_nop 0
  buffer_load_dwordx4 v26, s[28:31], s56 offen  lds
  s_add_u32 m0, s91, 34816
  s_nop 0
  buffer_load_dwordx4 v27, s[28:31], s56 offen  lds
  s_add_u32 m0, s91, 37888
  s_nop 0
  buffer_load_dwordx4 v28, s[28:31], s56 offen  lds
  s_add_u32 m0, s91, 40960
  s_nop 0
  buffer_load_dwordx4 v29, s[28:31], s56 offen  lds
  s_add_u32 s56, s56, 393216
  s_add_u32 s91, s91, 43008
  s_cmp_eq_u32 s91, 129024
  s_cselect_b32 s91, 0, s91
  s_cmp_eq_u32 s56, 6291456
  s_cselect_b32 s56, 0, s56
  s_waitcnt vmcnt(28)
  s_barrier
  s_mov_b32 s52, 13
p1_l1_0:
  s_waitcnt vmcnt(14)
  s_barrier
  s_add_u32 m0, s90, 1024
  s_nop 0
  buffer_load_dwordx4 v16, s[24:27], s55 offen  lds
  s_add_u32 m0, s90, 4096
  s_nop 0
  buffer_load_dwordx4 v17, s[24:27], s55 offen  lds
  s_add_u32 m0, s90, 7168
  s_nop 0
  buffer_load_dwordx4 v18, s[24:27], s55 offen  lds
  s_add_u32 m0, s90, 10240
  s_nop 0
  buffer_load_dwordx4 v19, s[24:27], s55 offen  lds
  s_add_u32 m0, s90, 13312
  s_nop 0
  buffer_load_dwordx4 v20, s[24:27], s55 offen  lds
  s_add_u32 m0, s90, 16384
  s_nop 0
  buffer_load_dwordx4 v21, s[24:27], s55 offen  lds
  s_add_u32 s55, s55, 128
  s_add_u32 s90, s90, 43008
  s_cmp_eq_u32 s90, 129024
  s_cselect_b32 s90, 0, s90
  s_cmp_eq_u32 s55, 2048
  s_cselect_b32 s55, 0, s55
  s_add_u32 m0, s91, 19456
  s_nop 0
  buffer_load_dwordx4 v22, s[28:31], s56 offen  lds
  s_add_u32 m0, s91, 22528
  s_nop 0
  buffer_load_dwordx4 v23, s[28:31], s56 offen  lds
  s_add_u32 m0, s91, 25600
  s_nop 0
  buffer_load_dwordx4 v24, s[28:31], s56 offen  lds
  s_add_u32 m0, s91, 28672
  s_nop 0
  buffer_load_dwordx4 v25, s[28:31], s56 offen  lds
  s_add_u32 m0, s91, 31744
  s_nop 0
  buffer_load_dwordx4 v26, s[28:31], s56 offen  lds
  s_add_u32 m0, s91, 34816
  s_nop 0
  buffer_load_dwordx4 v27, s[28:31], s56 offen  lds
  s_add_u32 m0, s91, 37888
  s_nop 0
  buffer_load_dwordx4 v28, s[28:31], s56 offen  lds
  s_add_u32 m0, s91, 40960
  s_nop 0
  buffer_load_dwordx4 v29, s[28:31], s56 offen  lds
  s_add_u32 s56, s56, 393216
  s_add_u32 s91, s91, 43008
  s_cmp_eq_u32 s91, 129024
  s_cselect_b32 s91, 0, s91
  s_cmp_eq_u32 s56, 6291456
  s_cselect_b32 s56, 0, s56
  s_sub_u32 s52, s52, 1
  s_cmp_lg_u32 s52, 0
  s_cbranch_scc1 p1_l1_0
  s_waitcnt vmcnt(14)
  s_barrier
  s_waitcnt vmcnt(0)
  s_barrier
  s_barrier
  s_barrier
  s_mov_b32 s40, s12
  s_mov_b32 s41, s13
  s_mov_b32 s42, 0x700000
  s_mov_b32 s43, 0x20000
  s_mul_i32 s50, s2, 28672
  s_add_u32 s50, s50, 7168
  v_min_u32 v60, 55, v0
  v_lshlrev_b32 v60, 7, v60
  buffer_load_dword v61, v60, s[40:43], s50 offen
  s_barrier
  s_call_b64 s[84:85], attn_sub
  s_barrier
  s_mov_b32 s44, s59
  s_mov_b32 s45, s60
  s_add_u32 s24, s4, 0x400000
  s_addc_u32 s25, s5, 0x0
  s_mov_b32 s26, 0x400000
  s_mov_b32 s27, 0x20000
  s_mov_b32 s28, s10
  s_mov_b32 s29, s11
  s_mov_b32 s30, 0x200000
  s_mov_b32 s31, 0x20000
  v_lshrrev_b32 v1, 3, v0
  v_and_b32 v2, 7, v0
  v_and_b32 v3, 2, v1
  v_xor_b32 v3, v2, v3
  v_lshlrev_b32 v3, 4, v3
  s_mov_b32 s47, 2048
  v_mul_lo_u32 v9, v1, s47
  v_add_u32 v9, v9, v3
  v_lshrrev_b32 v1, 3, v0
  v_and_b32 v2, 7, v0
  v_and_b32 v3, 6, v1
  v_xor_b32 v2, v2, v3
  v_lshrrev_b32 v3, 2, v2
  v_lshlrev_b32 v8, 13, v3
  v_and_b32 v3, 1, v1
  v_lshl_add_u32 v8, v3, 12, v8
  v_lshrrev_b32 v3, 4, v0
  v_lshl_add_u32 v8, v3, 6, v8
  v_and_b32 v3, 3, v2
  v_lshl_add_u32 v8, v3, 4, v8
  s_mul_i32 s49, s44, 262144
  v_add_u32 v8, s49, v8
  s_lshl_b32 s49, s45, 7
  v_add_u32 v9, s49, v9
  v_add_u32 v16, 256, v8
  v_add_u32 v17, 1024, v8
  v_add_u32 v18, 1792, v8
  v_add_u32 v19, 2560, v8
  v_add_u32 v20, 3328, v8
  v_add_u32 v21, 0, v9
  v_add_u32 v22, 49152, v9
  v_xor_b32 v22, 64, v22
  v_add_u32 v23, 98304, v9
  s_mov_b32 s55, 0
  s_mov_b32 s56, 0
  s_mov_b32 s90, 0
  s_mov_b32 s91, 0
  s_add_u32 m0, s91, 16384
  s_nop 0
  buffer_load_dwordx4 v21, s[28:31], s56 offen  lds
  s_add_u32 m0, s91, 19456
  s_nop 0
  buffer_load_dwordx4 v22, s[28:31], s56 offen  lds
  s_add_u32 m0, s91, 22528
  s_nop 0
  buffer_load_dwordx4 v23, s[28:31], s56 offen  lds
  s_add_u32 s56, s56, 131072
  s_add_u32 s91, s91, 24576
  s_cmp_eq_u32 s91, 147456
  s_cselect_b32 s91, 0, s91
  s_add_u32 m0, s91, 16384
  s_nop 0
  buffer_load_dwordx4 v21, s[28:31], s56 offen  lds
  s_add_u32 m0, s91, 19456
  s_nop 0
  buffer_load_dwordx4 v22, s[28:31], s56 offen  lds
  s_add_u32 m0, s91, 22528
  s_nop 0
  buffer_load_dwordx4 v23, s[28:31], s56 offen  lds
  s_add_u32 s56, s56, 131072
  s_add_u32 s91, s91, 24576
  s_cmp_eq_u32 s91, 147456
  s_cselect_b32 s91, 0, s91
  s_add_u32 m0, s91, 16384
  s_nop 0
  buffer_load_dwordx4 v21, s[28:31], s56 offen  lds
  s_add_u32 m0, s91, 19456
  s_nop 0
  buffer_load_dwordx4 v22, s[28:31], s56 offen  lds
  s_add_u32 m0, s91, 22528
  s_nop 0
  buffer_load_dwordx4 v23, s[28:31], s56 offen  lds
  s_add_u32 s56, s56, 131072
  s_add_u32 s91, s91, 24576
  s_cmp_eq_u32 s91, 147456
  s_cselect_b32 s91, 0, s91
  s_add_u32 m0, s91, 16384
  s_nop 0
  buffer_load_dwordx4 v21, s[28:31], s56 offen  lds
  s_add_u32 m0, s91, 19456
  s_nop 0
  buffer_load_dwordx4 v22, s[28:31], s56 offen  lds
  s_add_u32 m0, s91, 22528
  s_nop 0
  buffer_load_dwordx4 v23, s[28:31], s56 offen  lds
  s_add_u32 s56, s56, 131072
  s_add_u32 s91, s91, 24576
  s_cmp_eq_u32 s91, 147456
  s_cselect_b32 s91, 0, s91
  s_add_u32 m0, s91, 16384
  s_nop 0
  buffer_load_dwordx4 v21, s[28:31], s56 offen  lds
  s_add_u32 m0, s91, 19456
  s_nop 0
  buffer_load_dwordx4 v22, s[28:31], s56 offen  lds
  s_add_u32 m0, s91, 22528
  s_nop 0
  buffer_load_dwordx4 v23, s[28:31], s56 offen  lds
  s_add_u32 s56, s56, 131072
  s_add_u32 s91, s91, 24576
  s_cmp_eq_u32 s91, 147456
  s_cselect_b32 s91, 0, s91
  s_add_u32 m0, s91, 16384
  s_nop 0
  buffer_load_dwordx4 v21, s[28:31], s56 offen  lds
  s_add_u32 m0, s91, 19456
  s_nop 0
  buffer_load_dwordx4 v22, s[28:31], s56 offen  lds
  s_add_u32 m0, s91, 22528
  s_nop 0
  buffer_load_dwordx4 v23, s[28:31], s56 offen  lds
  s_add_u32 s56, s56, 131072
  s_add_u32 s91, s91, 24576
  s_cmp_eq_u32 s91, 147456
  s_cselect_b32 s91, 0, s91
  s_waitcnt vmcnt(18)
  s_barrier
  s_barrier
  s_add_u32 m0, s90, 1024
  s_nop 0
  buffer_load_dwordx4 v16, s[24:27], s55 offen sc1 lds
  s_add_u32 m0, s90, 4096
  s_nop 0
  buffer_load_dwordx4 v17, s[24:27], s55 offen sc1 lds
  s_add_u32 m0, s90, 7168
  s_nop 0
  buffer_load_dwordx4 v18, s[24:27], s55 offen sc1 lds
  s_add_u32 m0, s90, 10240
  s_nop 0
  buffer_load_dwordx4 v19, s[24:27], s55 offen sc1 lds
  s_add_u32 m0, s90, 13312
  s_nop 0
  buffer_load_dwordx4 v20, s[24:27], s55 offen sc1 lds
  s_add_u32 s55, s55, 16384
  s_add_u32 s90, s90, 24576
  s_cmp_eq_u32 s90, 147456
  s_cselect_b32 s90, 0, s90
  s_add_u32 m0, s90, 1024
  s_nop 0
  buffer_load_dwordx4 v16, s[24:27], s55 offen sc1 lds
  s_add_u32 m0, s90, 4096
  s_nop 0
  buffer_load_dwordx4 v17, s[24:27], s55 offen sc1 lds
  s_add_u32 m0, s90, 7168
  s_nop 0
  buffer_load_dwordx4 v18, s[24:27], s55 offen sc1 lds
  s_add_u32 m0, s90, 10240
  s_nop 0
  buffer_load_dwordx4 v19, s[24:27], s55 offen sc1 lds
  s_add_u32 m0, s90, 13312
  s_nop 0
  buffer_load_dwordx4 v20, s[24:27], s55 offen sc1 lds
  s_add_u32 s55, s55, 16384
  s_add_u32 s90, s90, 24576
  s_cmp_eq_u32 s90, 147456
  s_cselect_b32 s90, 0, s90
  s_add_u32 m0, s90, 1024
  s_nop 0
  buffer_load_dwordx4 v16, s[24:27], s55 offen sc1 lds
  s_add_u32 m0, s90, 4096
  s_nop 0
  buffer_load_dwordx4 v17, s[24:27], s55 offen sc1 lds
  s_add_u32 m0, s90, 7168
  s_nop 0
  buffer_load_dwordx4 v18, s[24:27], s55 offen sc1 lds
  s_add_u32 m0, s90, 10240
  s_nop 0
  buffer_load_dwordx4 v19, s[24:27], s55 offen sc1 lds
  s_add_u32 m0, s90, 13312
  s_nop 0
  buffer_load_dwordx4 v20, s[24:27], s55 offen sc1 lds
  s_add_u32 s55, s55, 16384
  s_add_u32 s90, s90, 24576
  s_cmp_eq_u32 s90, 147456
  s_cselect_b32 s90, 0, s90
  s_add_u32 m0, s90, 1024
  s_nop 0
  buffer_load_dwordx4 v16, s[24:27], s55 offen sc1 lds
  s_add_u32 m0, s90, 4096
  s_nop 0
  buffer_load_dwordx4 v17, s[24:27], s55 offen sc1 lds
  s_add_u32 m0, s90, 7168
  s_nop 0
  buffer_load_dwordx4 v18, s[24:27], s55 offen sc1 lds
  s_add_u32 m0, s90, 10240
  s_nop 0
  buffer_load_dwordx4 v19, s[24:27], s55 offen sc1 lds
  s_add_u32 m0, s90, 13312
  s_nop 0
  buffer_load_dwordx4 v20, s[24:27], s55 offen sc1 lds
  s_add_u32 s55, s55, 16384
  s_add_u32 s90, s90, 24576
  s_cmp_eq_u32 s90, 147456
  s_cselect_b32 s90, 0, s90
  s_add_u32 m0, s90, 1024
  s_nop 0
  buffer_load_dwordx4 v16, s[24:27], s55 offen sc1 lds
  s_add_u32 m0, s90, 4096
  s_nop 0
  buffer_load_dwordx4 v17, s[24:27], s55 offen sc1 lds
  s_add_u32 m0, s90, 7168
  s_nop 0
  buffer_load_dwordx4 v18, s[24:27], s55 offen sc1 lds
  s_add_u32 m0, s90, 10240
  s_nop 0
  buffer_load_dwordx4 v19, s[24:27], s55 offen sc1 lds
  s_add_u32 m0, s90, 13312
  s_nop 0
  buffer_load_dwordx4 v20, s[24:27], s55 offen sc1 lds
  s_add_u32 s55, s55, 16384
  s_add_u32 s90, s90, 24576
  s_cmp_eq_u32 s90, 147456
  s_cselect_b32 s90, 0, s90
  s_add_u32 m0, s90, 1024
  s_nop 0
  buffer_load_dwordx4 v16, s[24:27], s55 offen sc1 lds
  s_add_u32 m0, s90, 4096
  s_nop 0
  buffer_load_dwordx4 v17, s[24:27], s55 offen sc1 lds
  s_add_u32 m0, s90, 7168
  s_nop 0
  buffer_load_dwordx4 v18, s[24:27], s55 offen sc1 lds
  s_add_u32 m0, s90, 10240
  s_nop 0
  buffer_load_dwordx4 v19, s[24:27], s55 offen sc1 lds
  s_add_u32 m0, s90, 13312
  s_nop 0
  buffer_load_dwordx4 v20, s[24:27], s55 offen sc1 lds
  s_add_u32 s55, s55, 16384
  s_add_u32 s90, s90, 24576
  s_cmp_eq_u32 s90, 147456
  s_cselect_b32 s90, 0, s90
  s_waitcnt vmcnt(25)
  s_barrier
  s_waitcnt vmcnt(20)
  s_barrier
  s_add_u32 m0, s90, 1024
  s_nop 0
  buffer_load_dwordx4 v16, s[24:27], s55 offen sc1 lds
  s_add_u32 m0, s90, 4096
  s_nop 0
  buffer_load_dwordx4 v17, s[24:27], s55 offen sc1 lds
  s_add_u32 m0, s90, 7168
  s_nop 0
  buffer_load_dwordx4 v18, s[24:27], s55 offen sc1 lds
  s_add_u32 m0, s90, 10240
  s_nop 0
  buffer_load_dwordx4 v19, s[24:27], s55 offen sc1 lds
  s_add_u32 m0, s90, 13312
  s_nop 0
  buffer_load_dwordx4 v20, s[24:27], s55 offen sc1 lds
  s_add_u32 s55, s55, 16384
  s_add_u32 s90, s90, 24576
  s_cmp_eq_u32 s90, 147456
  s_cselect_b32 s90, 0, s90
  s_add_u32 m0, s91, 16384
  s_nop 0
  buffer_load_dwordx4 v21, s[28:31], s56 offen  lds
  s_add_u32 m0, s91, 19456
  s_nop 0
  buffer_load_dwordx4 v22, s[28:31], s56 offen  lds
  s_add_u32 m0, s91, 22528
  s_nop 0
  buffer_load_dwordx4 v23, s[28:31], s56 offen  lds
  s_add_u32 s56, s56, 131072
  s_add_u32 s91, s91, 24576
  s_cmp_eq_u32 s91, 147456
  s_cselect_b32 s91, 0, s91
  s_waitcnt vmcnt(23)
  s_barrier
  s_add_u32 m0, s90, 1024
  s_nop 0
  buffer_load_dwordx4 v16, s[24:27], s55 offen sc1 lds
  s_add_u32 m0, s90, 4096
  s_nop 0
  buffer_load_dwordx4 v17, s[24:27], s55 offen sc1 lds
  s_add_u32 m0, s90, 7168
  s_nop 0
  buffer_load_dwordx4 v18, s[24:27], s55 offen sc1 lds
  s_add_u32 m0, s90, 10240
  s_nop 0
  buffer_load_dwordx4 v19, s[24:27], s55 offen sc1 lds
  s_add_u32 m0, s90, 13312
  s_nop 0
  buffer_load_dwordx4 v20, s[24:27], s55 offen sc1 lds
  s_add_u32 s55, s55, 16384
  s_add_u32 s90, s90, 24576
  s_cmp_eq_u32 s90, 147456
  s_cselect_b32 s90, 0, s90
  s_add_u32 m0, s91, 16384
  s_nop 0
  buffer_load_dwordx4 v21, s[28:31], s56 offen  lds
  s_add_u32 m0, s91, 19456
  s_nop 0
  buffer_load_dwordx4 v22, s[28:31], s56 offen  lds
  s_add_u32 m0, s91, 22528
  s_nop 0
  buffer_load_dwordx4 v23, s[28:31], s56 offen  lds
  s_add_u32 s56, s56, 131072
  s_add_u32 s91, s91, 24576
  s_cmp_eq_u32 s91, 147456
  s_cselect_b32 s91, 0, s91
  s_waitcnt vmcnt(26)
  s_barrier
  s_add_u32 m0, s90, 1024
  s_nop 0
  buffer_load_dwordx4 v16, s[24:27], s55 offen sc1 lds
  s_add_u32 m0, s90, 4096
  s_nop 0
  buffer_load_dwordx4 v17, s[24:27], s55 offen sc1 lds
  s_add_u32 m0, s90, 7168
  s_nop 0
  buffer_load_dwordx4 v18, s[24:27], s55 offen sc1 lds
  s_add_u32 m0, s90, 10240
  s_nop 0
  buffer_load_dwordx4 v19, s[24:27], s55 offen sc1 lds
  s_add_u32 m0, s90, 13312
  s_nop 0
  buffer_load_dwordx4 v20, s[24:27], s55 offen sc1 lds
  s_add_u32 s55, s55, 16384
  s_add_u32 s90, s90, 24576
  s_cmp_eq_u32 s90, 147456
  s_cselect_b32 s90, 0, s90
  s_add_u32 m0, s91, 16384
  s_nop 0
  buffer_load_dwordx4 v21, s[28:31], s56 offen  lds
  s_add_u32 m0, s91, 19456
  s_nop 0
  buffer_load_dwordx4 v22, s[28:31], s56 offen  lds
  s_add_u32 m0, s91, 22528
  s_nop 0
  buffer_load_dwordx4 v23, s[28:31], s56 offen  lds
  s_add_u32 s56, s56, 131072
  s_add_u32 s91, s91, 24576
  s_cmp_eq_u32 s91, 147456
  s_cselect_b32 s91, 0, s91
  s_waitcnt vmcnt(29)
  s_barrier
  s_add_u32 m0, s90, 1024
  s_nop 0
  buffer_load_dwordx4 v16, s[24:27], s55 offen sc1 lds
  s_add_u32 m0, s90, 4096
  s_nop 0
  buffer_load_dwordx4 v17, s[24:27], s55 offen sc1 lds
  s_add_u32 m0, s90, 7168
  s_nop 0
  buffer_load_dwordx4 v18, s[24:27], s55 offen sc1 lds
  s_add_u32 m0, s90, 10240
  s_nop 0
  buffer_load_dwordx4 v19, s[24:27], s55 offen sc1 lds
  s_add_u32 m0, s90, 13312
  s_nop 0
  buffer_load_dwordx4 v20, s[24:27], s55 offen sc1 lds
  s_add_u32 s55, s55, 16384
  s_add_u32 s90, s90, 24576
  s_cmp_eq_u32 s90, 147456
  s_cselect_b32 s90, 0, s90
  s_add_u32 m0, s91, 16384
  s_nop 0
  buffer_load_dwordx4 v21, s[28:31], s56 offen  lds
  s_add_u32 m0, s91, 19456
  s_nop 0
  buffer_load_dwordx4 v22, s[28:31], s56 offen  lds
  s_add_u32 m0, s91, 22528
  s_nop 0
  buffer_load_dwordx4 v23, s[28:31], s56 offen  lds
  s_add_u32 s56, s56, 131072
  s_add_u32 s91, s91, 24576
  s_cmp_eq_u32 s91, 147456
  s_cselect_b32 s91, 0, s91
  s_mov_b32 s52, 6
p2_l1_0:
  s_waitcnt vmcnt(32)
  s_barrier
  s_add_u32 m0, s90, 1024
  s_nop 0
  buffer_load_dwordx4 v16, s[24:27], s55 offen sc1 lds
  s_add_u32 m0, s90, 4096
  s_nop 0
  buffer_load_dwordx4 v17, s[24:27], s55 offen sc1 lds
  s_add_u32 m0, s90, 7168
  s_nop 0
  buffer_load_dwordx4 v18, s[24:27], s55 offen sc1 lds
  s_add_u32 m0, s90, 10240
  s_nop 0
  buffer_load_dwordx4 v19, s[24:27], s55 offen sc1 lds
  s_add_u32 m0, s90, 13312
  s_nop 0
  buffer_load_dwordx4 v20, s[24:27], s55 offen sc1 lds
  s_add_u32 s55, s55, 16384
  s_add_u32 s90, s90, 24576
  s_cmp_eq_u32 s90, 147456
  s_cselect_b32 s90, 0, s90
  s_add_u32 m0, s91, 16384
  s_nop 0
  buffer_load_dwordx4 v21, s[28:31], s56 offen  lds
  s_add_u32 m0, s91, 19456
  s_nop 0
  buffer_load_dwordx4 v22, s[28:31], s56 offen  lds
  s_add_u32 m0, s91, 22528
  s_nop 0
  buffer_load_dwordx4 v23, s[28:31], s56 offen  lds
  s_add_u32 s56, s56, 131072
  s_add_u32 s91, s91, 24576
  s_cmp_eq_u32 s91, 147456
  s_cselect_b32 s91, 0, s91
  s_sub_u32 s52, s52, 1
  s_cmp_lg_u32 s52, 0
  s_cbranch_scc1 p2_l1_0
  s_waitcnt vmcnt(32)
  s_barrier
  s_waitcnt vmcnt(24)
  s_barrier
  s_waitcnt vmcnt(16)
  s_barrier
  s_waitcnt vmcnt(8)
  s_barrier
  s_waitcnt vmcnt(0)
  s_barrier
  s_barrier
  s_mov_b32 s44, s57
  s_mov_b32 s45, s58
  s_add_u32 s24, s4, 0x800000
  s_addc_u32 s25, s5, 0x0
  s_mov_b32 s26, 0x400000
  s_mov_b32 s27, 0x20000
  s_add_u32 s28, s4, 0x2800000
  s_addc_u32 s29, s5, 0x0
  s_mov_b32 s30, 0x700000
  s_mov_b32 s31, 0x20000
  s_mov_b32 s32, s14
  s_mov_b32 s33, s15
  s_mov_b32 s34, 0x800000
  s_mov_b32 s35, 0x20000
  s_add_u32 s36, s4, 0x1400000
  s_addc_u32 s37, s5, 0x0
  s_mov_b32 s38, 0x700000
  s_mov_b32 s39, 0x20000
  v_lshrrev_b32 v1, 3, v0
  v_and_b32 v2, 7, v0
  v_and_b32 v3, 6, v1
  v_xor_b32 v2, v2, v3
  v_lshrrev_b32 v3, 2, v2
  v_lshlrev_b32 v8, 13, v3
  v_lshl_add_u32 v8, v1, 6, v8
  v_and_b32 v3, 3, v2
  v_lshl_add_u32 v8, v3, 4, v8
  s_lshl_b32 s49, s44, 18
  v_add_u32 v8, s49, v8
  v_lshrrev_b32 v1, 3, v0
  v_and_b32 v2, 7, v0
  v_and_b32 v3, 6, v1
  v_xor_b32 v3, v2, v3
  v_lshlrev_b32 v3, 4, v3
  s_mov_b32 s47, 4096
  v_mul_lo_u32 v9, v1, s47
  v_add_u32 v9, v9, v3
  s_lshl_b32 s49, s44, 19
  v_add_u32 v9, s49, v9
  v_add_u32 v16, 512, v8
  v_add_u32 v17, 2048, v8
  v_add_u32 v18, 3584, v8
  v_add_u32 v19, 5120, v8
  v_add_u32 v20, 6656, v8
  v_add_u32 v21, 32768, v9
  v_add_u32 v22, 131072, v9
  v_add_u32 v23, 229376, v9
  v_add_u32 v24, 327680, v9
  v_add_u32 v25, 425984, v9
  v_lshlrev_b32 v26, 4, v0
  v_add_u32 v26, 0, v26
  v_lshlrev_b32 v27, 4, v0
  v_add_u32 v27, 3072, v27
  v_lshlrev_b32 v28, 4, v0
  v_add_u32 v28, 6144, v28
  v_lshlrev_b32 v29, 4, v0
  v_add_u32 v29, 9216, v29
  v_lshlrev_b32 v30, 4, v0
  v_add_u32 v30, 12288, v30
  s_mov_b32 s28, s12
  s_mov_b32 s29, s13
  s_mov_b32 s30, 0x700000
  s_mov_b32 s31, 0x20000
  s_mul_i32 s49, s45, 224
  s_mov_b32 s47, 4682
  s_mov_b32 s48, 7168
  v_add_u32 v1, 0, v0
  v_mul_lo_u32 v2, v1, s47
  v_lshrrev_b32 v2, 16, v2
  v_mul_u32_u24 v3, 14, v2
  v_sub_u32 v3, v1, v3
  v_and_b32 v4, 0x33, v2
  v_bfe_u32 v5, v2, 2, 1
  v_lshl_or_b32 v4, v5, 3, v4
  v_bfe_u32 v5, v2, 3, 1
  v_lshl_or_b32 v4, v5, 2, v4
  v_mul_lo_u32 v4, v4, s48
  v_lshl_add_u32 v4, v3, 4, v4
  v_add_u32 v31, s49, v4
  v_add_u32 v1, 192, v0
  v_mul_lo_u32 v2, v1, s47
  v_lshrrev_b32 v2, 16, v2
  v_mul_u32_u24 v3, 14, v2
  v_sub_u32 v3, v1, v3
  v_and_b32 v4, 0x33, v2
  v_bfe_u32 v5, v2, 2, 1
  v_lshl_or_b32 v4, v5, 3, v4
  v_bfe_u32 v5, v2, 3, 1
  v_lshl_or_b32 v4, v5, 2, v4
  v_mul_lo_u32 v4, v4, s48
  v_lshl_add_u32 v4, v3, 4, v4
  v_add_u32 v32, s49, v4
  v_add_u32 v1, 384, v0
  v_mul_lo_u32 v2, v1, s47
  v_lshrrev_b32 v2, 16, v2
  v_mul_u32_u24 v3, 14, v2
  v_sub_u32 v3, v1, v3
  v_and_b32 v4, 0x33, v2
  v_bfe_u32 v5, v2, 2, 1
  v_lshl_or_b32 v4, v5, 3, v4
  v_bfe_u32 v5, v2, 3, 1
  v_lshl_or_b32 v4, v5, 2, v4
  v_mul_lo_u32 v4, v4, s48
  v_lshl_add_u32 v4, v3, 4, v4
  v_add_u32 v33, s49, v4
  v_add_u32 v1, 576, v0
  v_mul_lo_u32 v2, v1, s47
  v_lshrrev_b32 v2, 16, v2
  v_mul_u32_u24 v3, 14, v2
  v_sub_u32 v3, v1, v3
  v_and_b32 v4, 0x33, v2
  v_bfe_u32 v5, v2, 2, 1
  v_lshl_or_b32 v4, v5, 3, v4
  v_bfe_u32 v5, v2, 3, 1
  v_lshl_or_b32 v4, v5, 2, v4
  v_mul_lo_u32 v4, v4, s48
  v_lshl_add_u32 v4, v3, 4, v4
  v_add_u32 v34, s49, v4
  v_add_u32 v1, 768, v0
  v_mul_lo_u32 v2, v1, s47
  v_lshrrev_b32 v2, 16, v2
  v_mul_u32_u24 v3, 14, v2
  v_sub_u32 v3, v1, v3
  v_and_b32 v4, 0x33, v2
  v_bfe_u32 v5, v2, 2, 1
  v_lshl_or_b32 v4, v5, 3, v4
  v_bfe_u32 v5, v2, 3, 1
  v_lshl_or_b32 v4, v5, 2, v4
  v_mul_lo_u32 v4, v4, s48
  v_lshl_add_u32 v4, v3, 4, v4
  v_add_u32 v35, s49, v4
  s_barrier
  s_barrier
  s_mov_b32 s55, 0
  s_mov_b32 s90, 0
  s_mov_b32 s91, 0
  s_mov_b32 s56, 3584
  s_add_u32 m0, s91, 16384
  s_nop 0
  buffer_load_dwordx4 v31, s[28:31], s56 offen  lds
  s_add_u32 m0, s91, 19456
  s_nop 0
  buffer_load_dwordx4 v32, s[28:31], s56 offen  lds
  s_add_u32 m0, s91, 22528
  s_nop 0
  buffer_load_dwordx4 v33, s[28:31], s56 offen  lds
  s_add_u32 m0, s91, 25600
  s_nop 0
  buffer_load_dwordx4 v34, s[28:31], s56 offen  lds
  s_add_u32 m0, s91, 28672
  s_nop 0
  buffer_load_dwordx4 v35, s[28:31], s56 offen  lds
  s_add_u32 s56, s56, 458752
  s_add_u32 s91, s91, 30720
  s_cmp_eq_u32 s91, 153600
  s_cselect_b32 s91, 0, s91
  s_add_u32 m0, s91, 16384
  s_nop 0
  buffer_load_dwordx4 v31, s[28:31], s56 offen  lds
  s_add_u32 m0, s91, 19456
  s_nop 0
  buffer_load_dwordx4 v32, s[28:31], s56 offen  lds
  s_add_u32 m0, s91, 22528
  s_nop 0
  buffer_load_dwordx4 v33, s[28:31], s56 offen  lds
  s_add_u32 m0, s91, 25600
  s_nop 0
  buffer_load_dwordx4 v34, s[28:31], s56 offen  lds
  s_add_u32 m0, s91, 28672
  s_nop 0
  buffer_load_dwordx4 v35, s[28:31], s56 offen  lds
  s_add_u32 s56, s56, 458752
  s_add_u32 s91, s91, 30720
  s_cmp_eq_u32 s91, 153600
  s_cselect_b32 s91, 0, s91
  s_add_u32 m0, s91, 16384
  s_nop 0
  buffer_load_dwordx4 v31, s[28:31], s56 offen  lds
  s_add_u32 m0, s91, 19456
  s_nop 0
  buffer_load_dwordx4 v32, s[28:31], s56 offen  lds
  s_add_u32 m0, s91, 22528
  s_nop 0
  buffer_load_dwordx4 v33, s[28:31], s56 offen  lds
  s_add_u32 m0, s91, 25600
  s_nop 0
  buffer_load_dwordx4 v34, s[28:31], s56 offen  lds
  s_add_u32 m0, s91, 28672
  s_nop 0
  buffer_load_dwordx4 v35, s[28:31], s56 offen  lds
  s_add_u32 s56, s56, 458752
  s_add_u32 s91, s91, 30720
  s_cmp_eq_u32 s91, 153600
  s_cselect_b32 s91, 0, s91
  s_add_u32 m0, s91, 16384
  s_nop 0
  buffer_load_dwordx4 v31, s[28:31], s56 offen  lds
  s_add_u32 m0, s91, 19456
  s_nop 0
  buffer_load_dwordx4 v32, s[28:31], s56 offen  lds
  s_add_u32 m0, s91, 22528
  s_nop 0
  buffer_load_dwordx4 v33, s[28:31], s56 offen  lds
  s_add_u32 m0, s91, 25600
  s_nop 0
  buffer_load_dwordx4 v34, s[28:31], s56 offen  lds
  s_add_u32 m0, s91, 28672
  s_nop 0
  buffer_load_dwordx4 v35, s[28:31], s56 offen  lds
  s_add_u32 s56, s56, 458752
  s_add_u32 s91, s91, 30720
  s_cmp_eq_u32 s91, 153600
  s_cselect_b32 s91, 0, s91
  s_add_u32 m0, s91, 16384
  s_nop 0
  buffer_load_dwordx4 v31, s[28:31], s56 offen  lds
  s_add_u32 m0, s91, 19456
  s_nop 0
  buffer_load_dwordx4 v32, s[28:31], s56 offen  lds
  s_add_u32 m0, s91, 22528
  s_nop 0
  buffer_load_dwordx4 v33, s[28:31], s56 offen  lds
  s_add_u32 m0, s91, 25600
  s_nop 0
  buffer_load_dwordx4 v34, s[28:31], s56 offen  lds
  s_add_u32 m0, s91, 28672
  s_nop 0
  buffer_load_dwordx4 v35, s[28:31], s56 offen  lds
  s_add_u32 s56, s56, 458752
  s_add_u32 s91, s91, 30720
  s_cmp_eq_u32 s91, 153600
  s_cselect_b32 s91, 0, s91
  s_barrier
  s_barrier
  s_barrier
  s_add_u32 m0, s90, 1024
  s_nop 0
  buffer_load_dwordx4 v16, s[24:27], s55 offen sc1 lds
  s_add_u32 m0, s90, 4096
  s_nop 0
  buffer_load_dwordx4 v17, s[24:27], s55 offen sc1 lds
  s_add_u32 m0, s90, 7168
  s_nop 0
  buffer_load_dwordx4 v18, s[24:27], s55 offen sc1 lds
  s_add_u32 m0, s90, 10240
  s_nop 0
  buffer_load_dwordx4 v19, s[24:27], s55 offen sc1 lds
  s_add_u32 m0, s90, 13312
  s_nop 0
  buffer_load_dwordx4 v20, s[24:27], s55 offen sc1 lds
  s_add_u32 s55, s55, 16384
  s_add_u32 s90, s90, 30720
  s_cmp_eq_u32 s90, 153600
  s_cselect_b32 s90, 0, s90
  s_add_u32 m0, s90, 1024
  s_nop 0
  buffer_load_dwordx4 v16, s[24:27], s55 offen sc1 lds
  s_add_u32 m0, s90, 4096
  s_nop 0
  buffer_load_dwordx4 v17, s[24:27], s55 offen sc1 lds
  s_add_u32 m0, s90, 7168
  s_nop 0
  buffer_load_dwordx4 v18, s[24:27], s55 offen sc1 lds
  s_add_u32 m0, s90, 10240
  s_nop 0
  buffer_load_dwordx4 v19, s[24:27], s55 offen sc1 lds
  s_add_u32 m0, s90, 13312
  s_nop 0
  buffer_load_dwordx4 v20, s[24:27], s55 offen sc1 lds
  s_add_u32 s55, s55, 16384
  s_add_u32 s90, s90, 30720
  s_cmp_eq_u32 s90, 153600
  s_cselect_b32 s90, 0, s90
  s_add_u32 m0, s90, 1024
  s_nop 0
  buffer_load_dwordx4 v16, s[24:27], s55 offen sc1 lds
  s_add_u32 m0, s90, 4096
  s_nop 0
  buffer_load_dwordx4 v17, s[24:27], s55 offen sc1 lds
  s_add_u32 m0, s90, 7168
  s_nop 0
  buffer_load_dwordx4 v18, s[24:27], s55 offen sc1 lds
  s_add_u32 m0, s90, 10240
  s_nop 0
  buffer_load_dwordx4 v19, s[24:27], s55 offen sc1 lds
  s_add_u32 m0, s90, 13312
  s_nop 0
  buffer_load_dwordx4 v20, s[24:27], s55 offen sc1 lds
  s_add_u32 s55, s55, 16384
  s_add_u32 s90, s90, 30720
  s_cmp_eq_u32 s90, 153600
  s_cselect_b32 s90, 0, s90
  s_add_u32 m0, s90, 1024
  s_nop 0
  buffer_load_dwordx4 v16, s[24:27], s55 offen sc1 lds
  s_add_u32 m0, s90, 4096
  s_nop 0
  buffer_load_dwordx4 v17, s[24:27], s55 offen sc1 lds
  s_add_u32 m0, s90, 7168
  s_nop 0
  buffer_load_dwordx4 v18, s[24:27], s55 offen sc1 lds
  s_add_u32 m0, s90, 10240
  s_nop 0
  buffer_load_dwordx4 v19, s[24:27], s55 offen sc1 lds
  s_add_u32 m0, s90, 13312
  s_nop 0
  buffer_load_dwordx4 v20, s[24:27], s55 offen sc1 lds
  s_add_u32 s55, s55, 16384
  s_add_u32 s90, s90, 30720
  s_cmp_eq_u32 s90, 153600
  s_cselect_b32 s90, 0, s90
  s_add_u32 m0, s90, 1024
  s_nop 0
  buffer_load_dwordx4 v16, s[24:27], s55 offen sc1 lds
  s_add_u32 m0, s90, 4096
  s_nop 0
  buffer_load_dwordx4 v17, s[24:27], s55 offen sc1 lds
  s_add_u32 m0, s90, 7168
  s_nop 0
  buffer_load_dwordx4 v18, s[24:27], s55 offen sc1 lds
  s_add_u32 m0, s90, 10240
  s_nop 0
  buffer_load_dwordx4 v19, s[24:27], s55 offen sc1 lds
  s_add_u32 m0, s90, 13312
  s_nop 0
  buffer_load_dwordx4 v20, s[24:27], s55 offen sc1 lds
  s_add_u32 s55, s55, 16384
  s_add_u32 s90, s90, 30720
  s_cmp_eq_u32 s90, 153600
  s_cselect_b32 s90, 0, s90
  s_waitcnt vmcnt(20)
  s_barrier
  s_waitcnt vmcnt(15)
  s_barrier
  s_add_u32 m0, s90, 1024
  s_nop 0
  buffer_load_dwordx4 v16, s[24:27], s55 offen sc1 lds
  s_add_u32 m0, s90, 4096
  s_nop 0
  buffer_load_dwordx4 v17, s[24:27], s55 offen sc1 lds
  s_add_u32 m0, s90, 7168
  s_nop 0
  buffer_load_dwordx4 v18, s[24:27], s55 offen sc1 lds
  s_add_u32 m0, s90, 10240
  s_nop 0
  buffer_load_dwordx4 v19, s[24:27], s55 offen sc1 lds
  s_add_u32 m0, s90, 13312
  s_nop 0
  buffer_load_dwordx4 v20, s[24:27], s55 offen sc1 lds
  s_add_u32 s55, s55, 16384
  s_add_u32 s90, s90, 30720
  s_cmp_eq_u32 s90, 153600
  s_cselect_b32 s90, 0, s90
  s_add_u32 m0, s91, 16384
  s_nop 0
  buffer_load_dwordx4 v31, s[28:31], s56 offen  lds
  s_add_u32 m0, s91, 19456
  s_nop 0
  buffer_load_dwordx4 v32, s[28:31], s56 offen  lds
  s_add_u32 m0, s91, 22528
  s_nop 0
  buffer_load_dwordx4 v33, s[28:31], s56 offen  lds
  s_add_u32 m0, s91, 25600
  s_nop 0
  buffer_load_dwordx4 v34, s[28:31], s56 offen  lds
  s_add_u32 m0, s91, 28672
  s_nop 0
  buffer_load_dwordx4 v35, s[28:31], s56 offen  lds
  s_add_u32 s56, s56, 458752
  s_add_u32 s91, s91, 30720
  s_cmp_eq_u32 s91, 153600
  s_cselect_b32 s91, 0, s91
  s_waitcnt vmcnt(20)
  s_barrier
  s_add_u32 m0, s90, 1024
  s_nop 0
  buffer_load_dwordx4 v16, s[24:27], s55 offen sc1 lds
  s_add_u32 m0, s90, 4096
  s_nop 0
  buffer_load_dwordx4 v17, s[24:27], s55 offen sc1 lds
  s_add_u32 m0, s90, 7168
  s_nop 0
  buffer_load_dwordx4 v18, s[24:27], s55 offen sc1 lds
  s_add_u32 m0, s90, 10240
  s_nop 0
  buffer_load_dwordx4 v19, s[24:27], s55 offen sc1 lds
  s_add_u32 m0, s90, 13312
  s_nop 0
  buffer_load_dwordx4 v20, s[24:27], s55 offen sc1 lds
  s_add_u32 s55, s55, 16384
  s_add_u32 s90, s90, 30720
  s_cmp_eq_u32 s90, 153600
  s_cselect_b32 s90, 0, s90
  s_add_u32 m0, s91, 16384
  s_nop 0
  buffer_load_dwordx4 v31, s[28:31], s56 offen  lds
  s_add_u32 m0, s91, 19456
  s_nop 0
  buffer_load_dwordx4 v32, s[28:31], s56 offen  lds
  s_add_u32 m0, s91, 22528
  s_nop 0
  buffer_load_dwordx4 v33, s[28:31], s56 offen  lds
  s_add_u32 m0, s91, 25600
  s_nop 0
  buffer_load_dwordx4 v34, s[28:31], s56 offen  lds
  s_add_u32 m0, s91, 28672
  s_nop 0
  buffer_load_dwordx4 v35, s[28:31], s56 offen  lds
  s_add_u32 s56, s56, 458752
  s_add_u32 s91, s91, 30720
  s_cmp_eq_u32 s91, 153600
  s_cselect_b32 s91, 0, s91
  s_waitcnt vmcnt(25)
  s_barrier
  s_add_u32 m0, s90, 1024
  s_nop 0
  buffer_load_dwordx4 v16, s[24:27], s55 offen sc1 lds
  s_add_u32 m0, s90, 4096
  s_nop 0
  buffer_load_dwordx4 v17, s[24:27], s55 offen sc1 lds
  s_add_u32 m0, s90, 7168
  s_nop 0
  buffer_load_dwordx4 v18, s[24:27], s55 offen sc1 lds
  s_add_u32 m0, s90, 10240
  s_nop 0
  buffer_load_dwordx4 v19, s[24:27], s55 offen sc1 lds
  s_add_u32 m0, s90, 13312
  s_nop 0
  buffer_load_dwordx4 v20, s[24:27], s55 offen sc1 lds
  s_add_u32 s55, s55, 16384
  s_add_u32 s90, s90, 30720
  s_cmp_eq_u32 s90, 153600
  s_cselect_b32 s90, 0, s90
  s_add_u32 m0, s91, 16384
  s_nop 0
  buffer_load_dwordx4 v31, s[28:31], s56 offen  lds
  s_add_u32 m0, s91, 19456
  s_nop 0
  buffer_load_dwordx4 v32, s[28:31], s56 offen  lds
  s_add_u32 m0, s91, 22528
  s_nop 0
  buffer_load_dwordx4 v33, s[28:31], s56 offen  lds
  s_add_u32 m0, s91, 25600
  s_nop 0
  buffer_load_dwordx4 v34, s[28:31], s56 offen  lds
  s_add_u32 m0, s91, 28672
  s_nop 0
  buffer_load_dwordx4 v35, s[28:31], s56 offen  lds
  s_add_u32 s56, s56, 458752
  s_add_u32 s91, s91, 30720
  s_cmp_eq_u32 s91, 153600
  s_cselect_b32 s91, 0, s91
  s_mov_b32 s52, 8
p34_l1_0:
  s_waitcnt vmcnt(30)
  s_barrier
  s_add_u32 m0, s90, 1024
  s_nop 0
  buffer_load_dwordx4 v16, s[24:27], s55 offen sc1 lds
  s_add_u32 m0, s90, 4096
  s_nop 0
  buffer_load_dwordx4 v17, s[24:27], s55 offen sc1 lds
  s_add_u32 m0, s90, 7168
  s_nop 0
  buffer_load_dwordx4 v18, s[24:27], s55 offen sc1 lds
  s_add_u32 m0, s90, 10240
  s_nop 0
  buffer_load_dwordx4 v19, s[24:27], s55 offen sc1 lds
  s_add_u32 m0, s90, 13312
  s_nop 0
  buffer_load_dwordx4 v20, s[24:27], s55 offen sc1 lds
  s_add_u32 s55, s55, 16384
  s_add_u32 s90, s90, 30720
  s_cmp_eq_u32 s90, 153600
  s_cselect_b32 s90, 0, s90
  s_add_u32 m0, s91, 16384
  s_nop 0
  buffer_load_dwordx4 v31, s[28:31], s56 offen  lds
  s_add_u32 m0, s91, 19456
  s_nop 0
  buffer_load_dwordx4 v32, s[28:31], s56 offen  lds
  s_add_u32 m0, s91, 22528
  s_nop 0
  buffer_load_dwordx4 v33, s[28:31], s56 offen  lds
  s_add_u32 m0, s91, 25600
  s_nop 0
  buffer_load_dwordx4 v34, s[28:31], s56 offen  lds
  s_add_u32 m0, s91, 28672
  s_nop 0
  buffer_load_dwordx4 v35, s[28:31], s56 offen  lds
  s_add_u32 s56, s56, 458752
  s_add_u32 s91, s91, 30720
  s_cmp_eq_u32 s91, 153600
  s_cselect_b32 s91, 0, s91
  s_sub_u32 s52, s52, 1
  s_cmp_lg_u32 s52, 0
  s_cbranch_scc1 p34_l1_0
  s_waitcnt vmcnt(30)
  s_barrier
  s_mov_b32 s55, 0
  s_mov_b32 s56, 0
  s_add_u32 m0, s90, 1024
  s_nop 0
  buffer_load_dwordx4 v16, s[24:27], s55 offen sc1 lds
  s_add_u32 m0, s90, 4096
  s_nop 0
  buffer_load_dwordx4 v17, s[24:27], s55 offen sc1 lds
  s_add_u32 m0, s90, 7168
  s_nop 0
  buffer_load_dwordx4 v18, s[24:27], s55 offen sc1 lds
  s_add_u32 m0, s90, 10240
  s_nop 0
  buffer_load_dwordx4 v19, s[24:27], s55 offen sc1 lds
  s_add_u32 m0, s90, 13312
  s_nop 0
  buffer_load_dwordx4 v20, s[24:27], s55 offen sc1 lds
  s_add_u32 s55, s55, 16384
  s_add_u32 s90, s90, 30720
  s_cmp_eq_u32 s90, 153600
  s_cselect_b32 s90, 0, s90
  s_add_u32 m0, s91, 16384
  s_nop 0
  buffer_load_dwordx4 v31, s[28:31], s56 offen  lds
  s_add_u32 m0, s91, 19456
  s_nop 0
  buffer_load_dwordx4 v32, s[28:31], s56 offen  lds
  s_add_u32 m0, s91, 22528
  s_nop 0
  buffer_load_dwordx4 v33, s[28:31], s56 offen  lds
  s_add_u32 m0, s91, 25600
  s_nop 0
  buffer_load_dwordx4 v34, s[28:31], s56 offen  lds
  s_add_u32 m0, s91, 28672
  s_nop 0
  buffer_load_dwordx4 v35, s[28:31], s56 offen  lds
  s_add_u32 s56, s56, 458752
  s_add_u32 s91, s91, 30720
  s_cmp_eq_u32 s91, 153600
  s_cselect_b32 s91, 0, s91
  s_mov_b32 s52, 3
p34_l1_1:
  s_waitcnt vmcnt(30)
  s_barrier
  s_add_u32 m0, s90, 1024
  s_nop 0
  buffer_load_dwordx4 v16, s[24:27], s55 offen sc1 lds
  s_add_u32 m0, s90, 4096
  s_nop 0
  buffer_load_dwordx4 v17, s[24:27], s55 offen sc1 lds
  s_add_u32 m0, s90, 7168
  s_nop 0
  buffer_load_dwordx4 v18, s[24:27], s55 offen sc1 lds
  s_add_u32 m0, s90, 10240
  s_nop 0
  buffer_load_dwordx4 v19, s[24:27], s55 offen sc1 lds
  s_add_u32 m0, s90, 13312
  s_nop 0
  buffer_load_dwordx4 v20, s[24:27], s55 offen sc1 lds
  s_add_u32 s55, s55, 16384
  s_add_u32 s90, s90, 30720
  s_cmp_eq_u32 s90, 153600
  s_cselect_b32 s90, 0, s90
  s_add_u32 m0, s91, 16384
  s_nop 0
  buffer_load_dwordx4 v31, s[28:31], s56 offen  lds
  s_add_u32 m0, s91, 19456
  s_nop 0
  buffer_load_dwordx4 v32, s[28:31], s56 offen  lds
  s_add_u32 m0, s91, 22528
  s_nop 0
  buffer_load_dwordx4 v33, s[28:31], s56 offen  lds
  s_add_u32 m0, s91, 25600
  s_nop 0
  buffer_load_dwordx4 v34, s[28:31], s56 offen  lds
  s_add_u32 m0, s91, 28672
  s_nop 0
  buffer_load_dwordx4 v35, s[28:31], s56 offen  lds
  s_add_u32 s56, s56, 458752
  s_add_u32 s91, s91, 30720
  s_cmp_eq_u32 s91, 153600
  s_cselect_b32 s91, 0, s91
  s_sub_u32 s52, s52, 1
  s_cmp_lg_u32 s52, 0
  s_cbranch_scc1 p34_l1_1
  s_waitcnt vmcnt(30)
  s_barrier
  s_add_u32 m0, s90, 1024
  s_nop 0
  buffer_load_dwordx4 v16, s[24:27], s55 offen sc1 lds
  s_add_u32 m0, s90, 4096
  s_nop 0
  buffer_load_dwordx4 v17, s[24:27], s55 offen sc1 lds
  s_add_u32 m0, s90, 7168
  s_nop 0
  buffer_load_dwordx4 v18, s[24:27], s55 offen sc1 lds
  s_add_u32 m0, s90, 10240
  s_nop 0
  buffer_load_dwordx4 v19, s[24:27], s55 offen sc1 lds
  s_add_u32 m0, s90, 13312
  s_nop 0
  buffer_load_dwordx4 v20, s[24:27], s55 offen sc1 lds
  s_add_u32 s55, s55, 16384
  s_add_u32 s90, s90, 30720
  s_cmp_eq_u32 s90, 153600
  s_cselect_b32 s90, 0, s90
  s_add_u32 m0, s91, 16384
  s_nop 0
  buffer_load_dwordx4 v31, s[28:31], s56 offen  lds
  s_add_u32 m0, s91, 19456
  s_nop 0
  buffer_load_dwordx4 v32, s[28:31], s56 offen  lds
  s_add_u32 m0, s91, 22528
  s_nop 0
  buffer_load_dwordx4 v33, s[28:31], s56 offen  lds
  s_add_u32 m0, s91, 25600
  s_nop 0
  buffer_load_dwordx4 v34, s[28:31], s56 offen  lds
  s_add_u32 m0, s91, 28672
  s_nop 0
  buffer_load_dwordx4 v35, s[28:31], s56 offen  lds
  s_add_u32 s56, s56, 458752
  s_add_u32 s91, s91, 30720
  s_cmp_eq_u32 s91, 153600
  s_cselect_b32 s91, 0, s91
  s_mov_b32 s40, s14
  s_mov_b32 s41, s15
  s_mov_b32 s42, 0x800000
  s_mov_b32 s43, 0x20000
  s_mul_i32 s50, s2, 32768
  s_add_u32 s50, s50, 8192
  v_min_u32 v60, 63, v0
  v_lshlrev_b32 v60, 7, v60
  buffer_load_dword v61, v60, s[40:43], s50 offen
  s_mov_b32 s52, 4
p34_l1_2:
  s_waitcnt vmcnt(31)
  s_barrier
  s_add_u32 m0, s90, 1024
  s_nop 0
  buffer_load_dwordx4 v16, s[24:27], s55 offen sc1 lds
  s_add_u32 m0, s90, 4096
  s_nop 0
  buffer_load_dwordx4 v17, s[24:27], s55 offen sc1 lds
  s_add_u32 m0, s90, 7168
  s_nop 0
  buffer_load_dwordx4 v18, s[24:27], s55 offen sc1 lds
  s_add_u32 m0, s90, 10240
  s_nop 0
  buffer_load_dwordx4 v19, s[24:27], s55 offen sc1 lds
  s_add_u32 m0, s90, 13312
  s_nop 0
  buffer_load_dwordx4 v20, s[24:27], s55 offen sc1 lds
  s_add_u32 s55, s55, 16384
  s_add_u32 s90, s90, 30720
  s_cmp_eq_u32 s90, 153600
  s_cselect_b32 s90, 0, s90
  s_add_u32 m0, s91, 16384
  s_nop 0
  buffer_load_dwordx4 v31, s[28:31], s56 offen  lds
  s_add_u32 m0, s91, 19456
  s_nop 0
  buffer_load_dwordx4 v32, s[28:31], s56 offen  lds
  s_add_u32 m0, s91, 22528
  s_nop 0
  buffer_load_dwordx4 v33, s[28:31], s56 offen  lds
  s_add_u32 m0, s91, 25600
  s_nop 0
  buffer_load_dwordx4 v34, s[28:31], s56 offen  lds
  s_add_u32 m0, s91, 28672
  s_nop 0
  buffer_load_dwordx4 v35, s[28:31], s56 offen  lds
  s_add_u32 s56, s56, 458752
  s_add_u32 s91, s91, 30720
  s_cmp_eq_u32 s91, 153600
  s_cselect_b32 s91, 0, s91
  s_sub_u32 s52, s52, 1
  s_cmp_lg_u32 s52, 0
  s_cbranch_scc1 p34_l1_2
  s_mov_b32 s52, 7
p34_l1_3:
  s_waitcnt vmcnt(30)
  s_barrier
  s_add_u32 m0, s90, 1024
  s_nop 0
  buffer_load_dwordx4 v16, s[24:27], s55 offen sc1 lds
  s_add_u32 m0, s90, 4096
  s_nop 0
  buffer_load_dwordx4 v17, s[24:27], s55 offen sc1 lds
  s_add_u32 m0, s90, 7168
  s_nop 0
  buffer_load_dwordx4 v18, s[24:27], s55 offen sc1 lds
  s_add_u32 m0, s90, 10240
  s_nop 0
  buffer_load_dwordx4 v19, s[24:27], s55 offen sc1 lds
  s_add_u32 m0, s90, 13312
  s_nop 0
  buffer_load_dwordx4 v20, s[24:27], s55 offen sc1 lds
  s_add_u32 s55, s55, 16384
  s_add_u32 s90, s90, 30720
  s_cmp_eq_u32 s90, 153600
  s_cselect_b32 s90, 0, s90
  s_add_u32 m0, s91, 16384
  s_nop 0
  buffer_load_dwordx4 v31, s[28:31], s56 offen  lds
  s_add_u32 m0, s91, 19456
  s_nop 0
  buffer_load_dwordx4 v32, s[28:31], s56 offen  lds
  s_add_u32 m0, s91, 22528
  s_nop 0
  buffer_load_dwordx4 v33, s[28:31], s56 offen  lds
  s_add_u32 m0, s91, 25600
  s_nop 0
  buffer_load_dwordx4 v34, s[28:31], s56 offen  lds
  s_add_u32 m0, s91, 28672
  s_nop 0
  buffer_load_dwordx4 v35, s[28:31], s56 offen  lds
  s_add_u32 s56, s56, 458752
  s_add_u32 s91, s91, 30720
  s_cmp_eq_u32 s91, 153600
  s_cselect_b32 s91, 0, s91
  s_sub_u32 s52, s52, 1
  s_cmp_lg_u32 s52, 0
  s_cbranch_scc1 p34_l1_3
  s_waitcnt vmcnt(30)
  s_barrier
  s_lshl_b32 s55, s44, 8
  s_mul_i32 s94, s45, 458752
  s_add_u32 s95, s94, 458752
  s_mul_i32 s56, s44, 28672
  s_add_u32 s56, s56, s94
  s_add_u32 m0, s90, 1024
  s_nop 0
  buffer_load_dwordx4 v21, s[32:35], s55 offen  lds
  s_add_u32 m0, s90, 4096
  s_nop 0
  buffer_load_dwordx4 v22, s[32:35], s55 offen  lds
  s_add_u32 m0, s90, 7168
  s_nop 0
  buffer_load_dwordx4 v23, s[32:35], s55 offen  lds
  s_add_u32 m0, s90, 10240
  s_nop 0
  buffer_load_dwordx4 v24, s[32:35], s55 offen  lds
  s_add_u32 m0, s90, 13312
  s_nop 0
  buffer_load_dwordx4 v25, s[32:35], s55 offen  lds
  s_add_u32 s55, s55, 128
  s_add_u32 s90, s90, 30720
  s_cmp_eq_u32 s90, 153600
  s_cselect_b32 s90, 0, s90
  s_and_b32 s55, s55, 4095
  s_waitcnt vmcnt(25)
  s_barrier
  s_add_u32 m0, s90, 1024
  s_nop 0
  buffer_load_dwordx4 v21, s[32:35], s55 offen  lds
  s_add_u32 m0, s90, 4096
  s_nop 0
  buffer_load_dwordx4 v22, s[32:35], s55 offen  lds
  s_add_u32 m0, s90, 7168
  s_nop 0
  buffer_load_dwordx4 v23, s[32:35], s55 offen  lds
  s_add_u32 m0, s90, 10240
  s_nop 0
  buffer_load_dwordx4 v24, s[32:35], s55 offen  lds
  s_add_u32 m0, s90, 13312
  s_nop 0
  buffer_load_dwordx4 v25, s[32:35], s55 offen  lds
  s_add_u32 s55, s55, 128
  s_add_u32 s90, s90, 30720
  s_cmp_eq_u32 s90, 153600
  s_cselect_b32 s90, 0, s90
  s_and_b32 s55, s55, 4095
  s_waitcnt vmcnt(20)
  s_barrier
  s_add_u32 m0, s90, 1024
  s_nop 0
  buffer_load_dwordx4 v21, s[32:35], s55 offen  lds
  s_add_u32 m0, s90, 4096
  s_nop 0
  buffer_load_dwordx4 v22, s[32:35], s55 offen  lds
  s_add_u32 m0, s90, 7168
  s_nop 0
  buffer_load_dwordx4 v23, s[32:35], s55 offen  lds
  s_add_u32 m0, s90, 10240
  s_nop 0
  buffer_load_dwordx4 v24, s[32:35], s55 offen  lds
  s_add_u32 m0, s90, 13312
  s_nop 0
  buffer_load_dwordx4 v25, s[32:35], s55 offen  lds
  s_add_u32 s55, s55, 128
  s_add_u32 s90, s90, 30720
  s_cmp_eq_u32 s90, 153600
  s_cselect_b32 s90, 0, s90
  s_and_b32 s55, s55, 4095
  s_waitcnt vmcnt(15)
  s_barrier
  s_add_u32 m0, s90, 1024
  s_nop 0
  buffer_load_dwordx4 v21, s[32:35], s55 offen  lds
  s_add_u32 m0, s90, 4096
  s_nop 0
  buffer_load_dwordx4 v22, s[32:35], s55 offen  lds
  s_add_u32 m0, s90, 7168
  s_nop 0
  buffer_load_dwordx4 v23, s[32:35], s55 offen  lds
  s_add_u32 m0, s90, 10240
  s_nop 0
  buffer_load_dwordx4 v24, s[32:35], s55 offen  lds
  s_add_u32 m0, s90, 13312
  s_nop 0
  buffer_load_dwordx4 v25, s[32:35], s55 offen  lds
  s_add_u32 s55, s55, 128
  s_add_u32 s90, s90, 30720
  s_cmp_eq_u32 s90, 153600
  s_cselect_b32 s90, 0, s90
  s_and_b32 s55, s55, 4095
  s_mov_b32 s40, s18
  s_mov_b32 s41, s19
  s_mov_b32 s42, 0x380000
  s_mov_b32 s43, 0x20000
  s_mul_i32 s50, s2, 14336
  s_add_u32 s50, s50, 4864
  v_min_u32 v60, 37, v0
  v_lshlrev_b32 v60, 7, v60
  buffer_load_dword v61, v60, s[40:43], s50 offen
  s_barrier
  s_add_u32 m0, s91, 16384
  s_nop 0
  buffer_load_dwordx4 v26, s[36:39], s56 offen sc1 lds
  s_add_u32 m0, s91, 19456
  s_nop 0
  buffer_load_dwordx4 v27, s[36:39], s56 offen sc1 lds
  s_add_u32 m0, s91, 22528
  s_nop 0
  buffer_load_dwordx4 v28, s[36:39], s56 offen sc1 lds
  s_add_u32 m0, s91, 25600
  s_nop 0
  buffer_load_dwordx4 v29, s[36:39], s56 offen sc1 lds
  s_add_u32 m0, s91, 28672
  s_nop 0
  buffer_load_dwordx4 v30, s[36:39], s56 offen sc1 lds
  s_add_u32 s56, s56, 14336
  s_add_u32 s91, s91, 30720
  s_cmp_eq_u32 s91, 153600
  s_cselect_b32 s91, 0, s91
  s_cmp_eq_u32 s56, s95
  s_cselect_b32 s56, s94, s56
  s_add_u32 m0, s91, 16384
  s_nop 0
  buffer_load_dwordx4 v26, s[36:39], s56 offen sc1 lds
  s_add_u32 m0, s91, 19456
  s_nop 0
  buffer_load_dwordx4 v27, s[36:39], s56 offen sc1 lds
  s_add_u32 m0, s91, 22528
  s_nop 0
  buffer_load_dwordx4 v28, s[36:39], s56 offen sc1 lds
  s_add_u32 m0, s91, 25600
  s_nop 0
  buffer_load_dwordx4 v29, s[36:39], s56 offen sc1 lds
  s_add_u32 m0, s91, 28672
  s_nop 0
  buffer_load_dwordx4 v30, s[36:39], s56 offen sc1 lds
  s_add_u32 s56, s56, 14336
  s_add_u32 s91, s91, 30720
  s_cmp_eq_u32 s91, 153600
  s_cselect_b32 s91, 0, s91
  s_cmp_eq_u32 s56, s95
  s_cselect_b32 s56, s94, s56
  s_add_u32 m0, s91, 16384
  s_nop 0
  buffer_load_dwordx4 v26, s[36:39], s56 offen sc1 lds
  s_add_u32 m0, s91, 19456
  s_nop 0
  buffer_load_dwordx4 v27, s[36:39], s56 offen sc1 lds
  s_add_u32 m0, s91, 22528
  s_nop 0
  buffer_load_dwordx4 v28, s[36:39], s56 offen sc1 lds
  s_add_u32 m0, s91, 25600
  s_nop 0
  buffer_load_dwordx4 v29, s[36:39], s56 offen sc1 lds
  s_add_u32 m0, s91, 28672
  s_nop 0
  buffer_load_dwordx4 v30, s[36:39], s56 offen sc1 lds
  s_add_u32 s56, s56, 14336
  s_add_u32 s91, s91, 30720
  s_cmp_eq_u32 s91, 153600
  s_cselect_b32 s91, 0, s91
  s_cmp_eq_u32 s56, s95
  s_cselect_b32 s56, s94, s56
  s_add_u32 m0, s91, 16384
  s_nop 0
  buffer_load_dwordx4 v26, s[36:39], s56 offen sc1 lds
  s_add_u32 m0, s91, 19456
  s_nop 0
  buffer_load_dwordx4 v27, s[36:39], s56 offen sc1 lds
  s_add_u32 m0, s91, 22528
  s_nop 0
  buffer_load_dwordx4 v28, s[36:39], s56 offen sc1 lds
  s_add_u32 m0, s91, 25600
  s_nop 0
  buffer_load_dwordx4 v29, s[36:39], s56 offen sc1 lds
  s_add_u32 m0, s91, 28672
  s_nop 0
  buffer_load_dwordx4 v30, s[36:39], s56 offen sc1 lds
  s_add_u32 s56, s56, 14336
  s_add_u32 s91, s91, 30720
  s_cmp_eq_u32 s91, 153600
  s_cselect_b32 s91, 0, s91
  s_cmp_eq_u32 s56, s95
  s_cselect_b32 s56, s94, s56
  s_add_u32 m0, s90, 1024
  s_nop 0
  buffer_load_dwordx4 v21, s[32:35], s55 offen  lds
  s_add_u32 m0, s90, 4096
  s_nop 0
  buffer_load_dwordx4 v22, s[32:35], s55 offen  lds
  s_add_u32 m0, s90, 7168
  s_nop 0
  buffer_load_dwordx4 v23, s[32:35], s55 offen  lds
  s_add_u32 m0, s90, 10240
  s_nop 0
  buffer_load_dwordx4 v24, s[32:35], s55 offen  lds
  s_add_u32 m0, s90, 13312
  s_nop 0
  buffer_load_dwordx4 v25, s[32:35], s55 offen  lds
  s_add_u32 s55, s55, 128
  s_add_u32 s90, s90, 30720
  s_cmp_eq_u32 s90, 153600
  s_cselect_b32 s90, 0, s90
  s_and_b32 s55, s55, 4095
  s_add_u32 m0, s91, 16384
  s_nop 0
  buffer_load_dwordx4 v26, s[36:39], s56 offen sc1 lds
  s_add_u32 m0, s91, 19456
  s_nop 0
  buffer_load_dwordx4 v27, s[36:39], s56 offen sc1 lds
  s_add_u32 m0, s91, 22528
  s_nop 0
  buffer_load_dwordx4 v28, s[36:39], s56 offen sc1 lds
  s_add_u32 m0, s91, 25600
  s_nop 0
  buffer_load_dwordx4 v29, s[36:39], s56 offen sc1 lds
  s_add_u32 m0, s91, 28672
  s_nop 0
  buffer_load_dwordx4 v30, s[36:39], s56 offen sc1 lds
  s_add_u32 s56, s56, 14336
  s_add_u32 s91, s91, 30720
  s_cmp_eq_u32 s91, 153600
  s_cselect_b32 s91, 0, s91
  s_cmp_eq_u32 s56, s95
  s_cselect_b32 s56, s94, s56
  s_waitcnt vmcnt(25)
  s_barrier
  s_waitcnt vmcnt(20)
  s_barrier
  s_add_u32 m0, s90, 1024
  s_nop 0
  buffer_load_dwordx4 v21, s[32:35], s55 offen  lds
  s_add_u32 m0, s90, 4096
  s_nop 0
  buffer_load_dwordx4 v22, s[32:35], s55 offen  lds
  s_add_u32 m0, s90, 7168
  s_nop 0
  buffer_load_dwordx4 v23, s[32:35], s55 offen  lds
  s_add_u32 m0, s90, 10240
  s_nop 0
  buffer_load_dwordx4 v24, s[32:35], s55 offen  lds
  s_add_u32 m0, s90, 13312
  s_nop 0
  buffer_load_dwordx4 v25, s[32:35], s55 offen  lds
  s_add_u32 s55, s55, 128
  s_add_u32 s90, s90, 30720
  s_cmp_eq_u32 s90, 153600
  s_cselect_b32 s90, 0, s90
  s_and_b32 s55, s55, 4095
  s_add_u32 m0, s91, 16384
  s_nop 0
  buffer_load_dwordx4 v26, s[36:39], s56 offen sc1 lds
  s_add_u32 m0, s91, 19456
  s_nop 0
  buffer_load_dwordx4 v27, s[36:39], s56 offen sc1 lds
  s_add_u32 m0, s91, 22528
  s_nop 0
  buffer_load_dwordx4 v28, s[36:39], s56 offen sc1 lds
  s_add_u32 m0, s91, 25600
  s_nop 0
  buffer_load_dwordx4 v29, s[36:39], s56 offen sc1 lds
  s_add_u32 m0, s91, 28672
  s_nop 0
  buffer_load_dwordx4 v30, s[36:39], s56 offen sc1 lds
  s_add_u32 s56, s56, 14336
  s_add_u32 s91, s91, 30720
  s_cmp_eq_u32 s91, 153600
  s_cselect_b32 s91, 0, s91
  s_cmp_eq_u32 s56, s95
  s_cselect_b32 s56, s94, s56
  s_waitcnt vmcnt(25)
  s_barrier
  s_add_u32 m0, s90, 1024
  s_nop 0
  buffer_load_dwordx4 v21, s[32:35], s55 offen  lds
  s_add_u32 m0, s90, 4096
  s_nop 0
  buffer_load_dwordx4 v22, s[32:35], s55 offen  lds
  s_add_u32 m0, s90, 7168
  s_nop 0
  buffer_load_dwordx4 v23, s[32:35], s55 offen  lds
  s_add_u32 m0, s90, 10240
  s_nop 0
  buffer_load_dwordx4 v24, s[32:35], s55 offen  lds
  s_add_u32 m0, s90, 13312
  s_nop 0
  buffer_load_dwordx4 v25, s[32:35], s55 offen  lds
  s_add_u32 s55, s55, 128
  s_add_u32 s90, s90, 30720
  s_cmp_eq_u32 s90, 153600
  s_cselect_b32 s90, 0, s90
  s_and_b32 s55, s55, 4095
  s_add_u32 m0, s91, 16384
  s_nop 0
  buffer_load_dwordx4 v26, s[36:39], s56 offen sc1 lds
  s_add_u32 m0, s91, 19456
  s_nop 0
  buffer_load_dwordx4 v27, s[36:39], s56 offen sc1 lds
  s_add_u32 m0, s91, 22528
  s_nop 0
  buffer_load_dwordx4 v28, s[36:39], s56 offen sc1 lds
  s_add_u32 m0, s91, 25600
  s_nop 0
  buffer_load_dwordx4 v29, s[36:39], s56 offen sc1 lds
  s_add_u32 m0, s91, 28672
  s_nop 0
  buffer_load_dwordx4 v30, s[36:39], s56 offen sc1 lds
  s_add_u32 s56, s56, 14336
  s_add_u32 s91, s91, 30720
  s_cmp_eq_u32 s91, 153600
  s_cselect_b32 s91, 0, s91
  s_cmp_eq_u32 s56, s95
  s_cselect_b32 s56, s94, s56
  s_mov_b32 s52, 25
p34_l1_4:
  s_waitcnt vmcnt(30)
  s_barrier
  s_add_u32 m0, s90, 1024
  s_nop 0
  buffer_load_dwordx4 v21, s[32:35], s55 offen  lds
  s_add_u32 m0, s90, 4096
  s_nop 0
  buffer_load_dwordx4 v22, s[32:35], s55 offen  lds
  s_add_u32 m0, s90, 7168
  s_nop 0
  buffer_load_dwordx4 v23, s[32:35], s55 offen  lds
  s_add_u32 m0, s90, 10240
  s_nop 0
  buffer_load_dwordx4 v24, s[32:35], s55 offen  lds
  s_add_u32 m0, s90, 13312
  s_nop 0
  buffer_load_dwordx4 v25, s[32:35], s55 offen  lds
  s_add_u32 s55, s55, 128
  s_add_u32 s90, s90, 30720
  s_cmp_eq_u32 s90, 153600
  s_cselect_b32 s90, 0, s90
  s_and_b32 s55, s55, 4095
  s_add_u32 m0, s91, 16384
  s_nop 0
  buffer_load_dwordx4 v26, s[36:39], s56 offen sc1 lds
  s_add_u32 m0, s91, 19456
  s_nop 0
  buffer_load_dwordx4 v27, s[36:39], s56 offen sc1 lds
  s_add_u32 m0, s91, 22528
  s_nop 0
  buffer_load_dwordx4 v28, s[36:39], s56 offen sc1 lds
  s_add_u32 m0, s91, 25600
  s_nop 0
  buffer_load_dwordx4 v29, s[36:39], s56 offen sc1 lds
  s_add_u32 m0, s91, 28672
  s_nop 0
  buffer_load_dwordx4 v30, s[36:39], s56 offen sc1 lds
  s_add_u32 s56, s56, 14336
  s_add_u32 s91, s91, 30720
  s_cmp_eq_u32 s91, 153600
  s_cselect_b32 s91, 0, s91
  s_cmp_eq_u32 s56, s95
  s_cselect_b32 s56, s94, s56
  s_sub_u32 s52, s52, 1
  s_cmp_lg_u32 s52, 0
  s_cbranch_scc1 p34_l1_4
  s_waitcnt vmcnt(30)
  s_barrier
  s_waitcnt vmcnt(20)
  s_barrier
  s_waitcnt vmcnt(10)
  s_barrier
  s_waitcnt vmcnt(0)
  s_barrier
  s_barrier
  s_mov_b32 s44, s59
  s_mov_b32 s45, s60
  s_add_u32 s24, s4, 0x1c00000
  s_addc_u32 s25, s5, 0x0
  s_mov_b32 s26, 0x700000
  s_mov_b32 s27, 0x20000
  s_mov_b32 s28, s18
  s_mov_b32 s29, s19
  s_mov_b32 s30, 0x380000
  s_mov_b32 s31, 0x20000
  v_lshrrev_b32 v1, 3, v0
  v_and_b32 v2, 7, v0
  v_and_b32 v3, 2, v1
  v_xor_b32 v3, v2, v3
  v_lshlrev_b32 v3, 4, v3
  s_mov_b32 s47, 2048
  v_mul_lo_u32 v9, v1, s47
  v_add_u32 v9, v9, v3
  v_lshrrev_b32 v1, 3, v0
  v_and_b32 v2, 7, v0
  v_and_b32 v3, 6, v1
  v_xor_b32 v2, v2, v3
  v_lshrrev_b32 v3, 2, v2
  v_lshlrev_b32 v8, 13, v3
  v_lshl_add_u32 v8, v1, 6, v8
  v_and_b32 v3, 3, v2
  v_lshl_add_u32 v8, v3, 4, v8
  s_mul_i32 s49, s44, 458752
  v_add_u32 v8, s49, v8
  s_lshl_b32 s49, s45, 7
  v_add_u32 v9, s49, v9
  v_add_u32 v16, 512, v8
  v_add_u32 v17, 2048, v8
  v_add_u32 v18, 3584, v8
  v_add_u32 v19, 5120, v8
  v_add_u32 v20, 6656, v8
  v_add_u32 v21, 0, v9
  v_add_u32 v22, 49152, v9
  v_xor_b32 v22, 64, v22
  v_add_u32 v23, 98304, v9
  s_barrier
  s_barrier
  s_mov_b32 s55, 0
  s_mov_b32 s56, 0
  s_mov_b32 s90, 0
  s_mov_b32 s91, 0
  s_add_u32 m0, s91, 16384
  s_nop 0
  buffer_load_dwordx4 v21, s[28:31], s56 offen  lds
  s_add_u32 m0, s91, 19456
  s_nop 0
  buffer_load_dwordx4 v22, s[28:31], s56 offen  lds
  s_add_u32 m0, s91, 22528
  s_nop 0
  buffer_load_dwordx4 v23, s[28:31], s56 offen  lds
  s_add_u32 s56, s56, 131072
  s_add_u32 s91, s91, 24576
  s_cmp_eq_u32 s91, 147456
  s_cselect_b32 s91, 0, s91
  s_add_u32 m0, s91, 16384
  s_nop 0
  buffer_load_dwordx4 v21, s[28:31], s56 offen  lds
  s_add_u32 m0, s91, 19456
  s_nop 0
  buffer_load_dwordx4 v22, s[28:31], s56 offen  lds
  s_add_u32 m0, s91, 22528
  s_nop 0
  buffer_load_dwordx4 v23, s[28:31], s56 offen  lds
  s_add_u32 s56, s56, 131072
  s_add_u32 s91, s91, 24576
  s_cmp_eq_u32 s91, 147456
  s_cselect_b32 s91, 0, s91
  s_add_u32 m0, s91, 16384
  s_nop 0
  buffer_load_dwordx4 v21, s[28:31], s56 offen  lds
  s_add_u32 m0, s91, 19456
  s_nop 0
  buffer_load_dwordx4 v22, s[28:31], s56 offen  lds
  s_add_u32 m0, s91, 22528
  s_nop 0
  buffer_load_dwordx4 v23, s[28:31], s56 offen  lds
  s_add_u32 s56, s56, 131072
  s_add_u32 s91, s91, 24576
  s_cmp_eq_u32 s91, 147456
  s_cselect_b32 s91, 0, s91
  s_add_u32 m0, s91, 16384
  s_nop 0
  buffer_load_dwordx4 v21, s[28:31], s56 offen  lds
  s_add_u32 m0, s91, 19456
  s_nop 0
  buffer_load_dwordx4 v22, s[28:31], s56 offen  lds
  s_add_u32 m0, s91, 22528
  s_nop 0
  buffer_load_dwordx4 v23, s[28:31], s56 offen  lds
  s_add_u32 s56, s56, 131072
  s_add_u32 s91, s91, 24576
  s_cmp_eq_u32 s91, 147456
  s_cselect_b32 s91, 0, s91
  s_add_u32 m0, s91, 16384
  s_nop 0
  buffer_load_dwordx4 v21, s[28:31], s56 offen  lds
  s_add_u32 m0, s91, 19456
  s_nop 0
  buffer_load_dwordx4 v22, s[28:31], s56 offen  lds
  s_add_u32 m0, s91, 22528
  s_nop 0
  buffer_load_dwordx4 v23, s[28:31], s56 offen  lds
  s_add_u32 s56, s56, 131072
  s_add_u32 s91, s91, 24576
  s_cmp_eq_u32 s91, 147456
  s_cselect_b32 s91, 0, s91
  s_add_u32 m0, s91, 16384
  s_nop 0
  buffer_load_dwordx4 v21, s[28:31], s56 offen  lds
  s_add_u32 m0, s91, 19456
  s_nop 0
  buffer_load_dwordx4 v22, s[28:31], s56 offen  lds
  s_add_u32 m0, s91, 22528
  s_nop 0
  buffer_load_dwordx4 v23, s[28:31], s56 offen  lds
  s_add_u32 s56, s56, 131072
  s_add_u32 s91, s91, 24576
  s_cmp_eq_u32 s91, 147456
  s_cselect_b32 s91, 0, s91
  s_barrier
  s_barrier
  s_add_u32 m0, s90, 1024
  s_nop 0
  buffer_load_dwordx4 v16, s[24:27], s55 offen sc1 lds
  s_add_u32 m0, s90, 4096
  s_nop 0
  buffer_load_dwordx4 v17, s[24:27], s55 offen sc1 lds
  s_add_u32 m0, s90, 7168
  s_nop 0
  buffer_load_dwordx4 v18, s[24:27], s55 offen sc1 lds
  s_add_u32 m0, s90, 10240
  s_nop 0
  buffer_load_dwordx4 v19, s[24:27], s55 offen sc1 lds
  s_add_u32 m0, s90, 13312
  s_nop 0
  buffer_load_dwordx4 v20, s[24:27], s55 offen sc1 lds
  s_add_u32 s55, s55, 16384
  s_add_u32 s90, s90, 24576
  s_cmp_eq_u32 s90, 147456
  s_cselect_b32 s90, 0, s90
  s_add_u32 m0, s90, 1024
  s_nop 0
  buffer_load_dwordx4 v16, s[24:27], s55 offen sc1 lds
  s_add_u32 m0, s90, 4096
  s_nop 0
  buffer_load_dwordx4 v17, s[24:27], s55 offen sc1 lds
  s_add_u32 m0, s90, 7168
  s_nop 0
  buffer_load_dwordx4 v18, s[24:27], s55 offen sc1 lds
  s_add_u32 m0, s90, 10240
  s_nop 0
  buffer_load_dwordx4 v19, s[24:27], s55 offen sc1 lds
  s_add_u32 m0, s90, 13312
  s_nop 0
  buffer_load_dwordx4 v20, s[24:27], s55 offen sc1 lds
  s_add_u32 s55, s55, 16384
  s_add_u32 s90, s90, 24576
  s_cmp_eq_u32 s90, 147456
  s_cselect_b32 s90, 0, s90
  s_add_u32 m0, s90, 1024
  s_nop 0
  buffer_load_dwordx4 v16, s[24:27], s55 offen sc1 lds
  s_add_u32 m0, s90, 4096
  s_nop 0
  buffer_load_dwordx4 v17, s[24:27], s55 offen sc1 lds
  s_add_u32 m0, s90, 7168
  s_nop 0
  buffer_load_dwordx4 v18, s[24:27], s55 offen sc1 lds
  s_add_u32 m0, s90, 10240
  s_nop 0
  buffer_load_dwordx4 v19, s[24:27], s55 offen sc1 lds
  s_add_u32 m0, s90, 13312
  s_nop 0
  buffer_load_dwordx4 v20, s[24:27], s55 offen sc1 lds
  s_add_u32 s55, s55, 16384
  s_add_u32 s90, s90, 24576
  s_cmp_eq_u32 s90, 147456
  s_cselect_b32 s90, 0, s90
  s_add_u32 m0, s90, 1024
  s_nop 0
  buffer_load_dwordx4 v16, s[24:27], s55 offen sc1 lds
  s_add_u32 m0, s90, 4096
  s_nop 0
  buffer_load_dwordx4 v17, s[24:27], s55 offen sc1 lds
  s_add_u32 m0, s90, 7168
  s_nop 0
  buffer_load_dwordx4 v18, s[24:27], s55 offen sc1 lds
  s_add_u32 m0, s90, 10240
  s_nop 0
  buffer_load_dwordx4 v19, s[24:27], s55 offen sc1 lds
  s_add_u32 m0, s90, 13312
  s_nop 0
  buffer_load_dwordx4 v20, s[24:27], s55 offen sc1 lds
  s_add_u32 s55, s55, 16384
  s_add_u32 s90, s90, 24576
  s_cmp_eq_u32 s90, 147456
  s_cselect_b32 s90, 0, s90
  s_add_u32 m0, s90, 1024
  s_nop 0
  buffer_load_dwordx4 v16, s[24:27], s55 offen sc1 lds
  s_add_u32 m0, s90, 4096
  s_nop 0
  buffer_load_dwordx4 v17, s[24:27], s55 offen sc1 lds
  s_add_u32 m0, s90, 7168
  s_nop 0
  buffer_load_dwordx4 v18, s[24:27], s55 offen sc1 lds
  s_add_u32 m0, s90, 10240
  s_nop 0
  buffer_load_dwordx4 v19, s[24:27], s55 offen sc1 lds
  s_add_u32 m0, s90, 13312
  s_nop 0
  buffer_load_dwordx4 v20, s[24:27], s55 offen sc1 lds
  s_add_u32 s55, s55, 16384
  s_add_u32 s90, s90, 24576
  s_cmp_eq_u32 s90, 147456
  s_cselect_b32 s90, 0, s90
  s_add_u32 m0, s90, 1024
  s_nop 0
  buffer_load_dwordx4 v16, s[24:27], s55 offen sc1 lds
  s_add_u32 m0, s90, 4096
  s_nop 0
  buffer_load_dwordx4 v17, s[24:27], s55 offen sc1 lds
  s_add_u32 m0, s90, 7168
  s_nop 0
  buffer_load_dwordx4 v18, s[24:27], s55 offen sc1 lds
  s_add_u32 m0, s90, 10240
  s_nop 0
  buffer_load_dwordx4 v19, s[24:27], s55 offen sc1 lds
  s_add_u32 m0, s90, 13312
  s_nop 0
  buffer_load_dwordx4 v20, s[24:27], s55 offen sc1 lds
  s_add_u32 s55, s55, 16384
  s_add_u32 s90, s90, 24576
  s_cmp_eq_u32 s90, 147456
  s_cselect_b32 s90, 0, s90
  s_waitcnt vmcnt(25)
  s_barrier
  s_waitcnt vmcnt(20)
  s_barrier
  s_add_u32 m0, s90, 1024
  s_nop 0
  buffer_load_dwordx4 v16, s[24:27], s55 offen sc1 lds
  s_add_u32 m0, s90, 4096
  s_nop 0
  buffer_load_dwordx4 v17, s[24:27], s55 offen sc1 lds
  s_add_u32 m0, s90, 7168
  s_nop 0
  buffer_load_dwordx4 v18, s[24:27], s55 offen sc1 lds
  s_add_u32 m0, s90, 10240
  s_nop 0
  buffer_load_dwordx4 v19, s[24:27], s55 offen sc1 lds
  s_add_u32 m0, s90, 13312
  s_nop 0
  buffer_load_dwordx4 v20, s[24:27], s55 offen sc1 lds
  s_add_u32 s55, s55, 16384
  s_add_u32 s90, s90, 24576
  s_cmp_eq_u32 s90, 147456
  s_cselect_b32 s90, 0, s90
  s_add_u32 m0, s91, 16384
  s_nop 0
  buffer_load_dwordx4 v21, s[28:31], s56 offen  lds
  s_add_u32 m0, s91, 19456
  s_nop 0
  buffer_load_dwordx4 v22, s[28:31], s56 offen  lds
  s_add_u32 m0, s91, 22528
  s_nop 0
  buffer_load_dwordx4 v23, s[28:31], s56 offen  lds
  s_add_u32 s56, s56, 131072
  s_add_u32 s91, s91, 24576
  s_cmp_eq_u32 s91, 147456
  s_cselect_b32 s91, 0, s91
  s_waitcnt vmcnt(23)
  s_barrier
  s_add_u32 m0, s90, 1024
  s_nop 0
  buffer_load_dwordx4 v16, s[24:27], s55 offen sc1 lds
  s_add_u32 m0, s90, 4096
  s_nop 0
  buffer_load_dwordx4 v17, s[24:27], s55 offen sc1 lds
  s_add_u32 m0, s90, 7168
  s_nop 0
  buffer_load_dwordx4 v18, s[24:27], s55 offen sc1 lds
  s_add_u32 m0, s90, 10240
  s_nop 0
  buffer_load_dwordx4 v19, s[24:27], s55 offen sc1 lds
  s_add_u32 m0, s90, 13312
  s_nop 0
  buffer_load_dwordx4 v20, s[24:27], s55 offen sc1 lds
  s_add_u32 s55, s55, 16384
  s_add_u32 s90, s90, 24576
  s_cmp_eq_u32 s90, 147456
  s_cselect_b32 s90, 0, s90
  s_add_u32 m0, s91, 16384
  s_nop 0
  buffer_load_dwordx4 v21, s[28:31], s56 offen  lds
  s_add_u32 m0, s91, 19456
  s_nop 0
  buffer_load_dwordx4 v22, s[28:31], s56 offen  lds
  s_add_u32 m0, s91, 22528
  s_nop 0
  buffer_load_dwordx4 v23, s[28:31], s56 offen  lds
  s_add_u32 s56, s56, 131072
  s_add_u32 s91, s91, 24576
  s_cmp_eq_u32 s91, 147456
  s_cselect_b32 s91, 0, s91
  s_waitcnt vmcnt(26)
  s_barrier
  s_add_u32 m0, s90, 1024
  s_nop 0
  buffer_load_dwordx4 v16, s[24:27], s55 offen sc1 lds
  s_add_u32 m0, s90, 4096
  s_nop 0
  buffer_load_dwordx4 v17, s[24:27], s55 offen sc1 lds
  s_add_u32 m0, s90, 7168
  s_nop 0
  buffer_load_dwordx4 v18, s[24:27], s55 offen sc1 lds
  s_add_u32 m0, s90, 10240
  s_nop 0
  buffer_load_dwordx4 v19, s[24:27], s55 offen sc1 lds
  s_add_u32 m0, s90, 13312
  s_nop 0
  buffer_load_dwordx4 v20, s[24:27], s55 offen sc1 lds
  s_add_u32 s55, s55, 16384
  s_add_u32 s90, s90, 24576
  s_cmp_eq_u32 s90, 147456
  s_cselect_b32 s90, 0, s90
  s_add_u32 m0, s91, 16384
  s_nop 0
  buffer_load_dwordx4 v21, s[28:31], s56 offen  lds
  s_add_u32 m0, s91, 19456
  s_nop 0
  buffer_load_dwordx4 v22, s[28:31], s56 offen  lds
  s_add_u32 m0, s91, 22528
  s_nop 0
  buffer_load_dwordx4 v23, s[28:31], s56 offen  lds
  s_add_u32 s56, s56, 131072
  s_add_u32 s91, s91, 24576
  s_cmp_eq_u32 s91, 147456
  s_cselect_b32 s91, 0, s91
  s_waitcnt vmcnt(29)
  s_barrier
  s_add_u32 m0, s90, 1024
  s_nop 0
  buffer_load_dwordx4 v16, s[24:27], s55 offen sc1 lds
  s_add_u32 m0, s90, 4096
  s_nop 0
  buffer_load_dwordx4 v17, s[24:27], s55 offen sc1 lds
  s_add_u32 m0, s90, 7168
  s_nop 0
  buffer_load_dwordx4 v18, s[24:27], s55 offen sc1 lds
  s_add_u32 m0, s90, 10240
  s_nop 0
  buffer_load_dwordx4 v19, s[24:27], s55 offen sc1 lds
  s_add_u32 m0, s90, 13312
  s_nop 0
  buffer_load_dwordx4 v20, s[24:27], s55 offen sc1 lds
  s_add_u32 s55, s55, 16384
  s_add_u32 s90, s90, 24576
  s_cmp_eq_u32 s90, 147456
  s_cselect_b32 s90, 0, s90
  s_add_u32 m0, s91, 16384
  s_nop 0
  buffer_load_dwordx4 v21, s[28:31], s56 offen  lds
  s_add_u32 m0, s91, 19456
  s_nop 0
  buffer_load_dwordx4 v22, s[28:31], s56 offen  lds
  s_add_u32 m0, s91, 22528
  s_nop 0
  buffer_load_dwordx4 v23, s[28:31], s56 offen  lds
  s_add_u32 s56, s56, 131072
  s_add_u32 s91, s91, 24576
  s_cmp_eq_u32 s91, 147456
  s_cselect_b32 s91, 0, s91
  s_mov_b32 s52, 18
p5_l1_0:
  s_waitcnt vmcnt(32)
  s_barrier
  s_add_u32 m0, s90, 1024
  s_nop 0
  buffer_load_dwordx4 v16, s[24:27], s55 offen sc1 lds
  s_add_u32 m0, s90, 4096
  s_nop 0
  buffer_load_dwordx4 v17, s[24:27], s55 offen sc1 lds
  s_add_u32 m0, s90, 7168
  s_nop 0
  buffer_load_dwordx4 v18, s[24:27], s55 offen sc1 lds
  s_add_u32 m0, s90, 10240
  s_nop 0
  buffer_load_dwordx4 v19, s[24:27], s55 offen sc1 lds
  s_add_u32 m0, s90, 13312
  s_nop 0
  buffer_load_dwordx4 v20, s[24:27], s55 offen sc1 lds
  s_add_u32 s55, s55, 16384
  s_add_u32 s90, s90, 24576
  s_cmp_eq_u32 s90, 147456
  s_cselect_b32 s90, 0, s90
  s_add_u32 m0, s91, 16384
  s_nop 0
  buffer_load_dwordx4 v21, s[28:31], s56 offen  lds
  s_add_u32 m0, s91, 19456
  s_nop 0
  buffer_load_dwordx4 v22, s[28:31], s56 offen  lds
  s_add_u32 m0, s91, 22528
  s_nop 0
  buffer_load_dwordx4 v23, s[28:31], s56 offen  lds
  s_add_u32 s56, s56, 131072
  s_add_u32 s91, s91, 24576
  s_cmp_eq_u32 s91, 147456
  s_cselect_b32 s91, 0, s91
  s_sub_u32 s52, s52, 1
  s_cmp_lg_u32 s52, 0
  s_cbranch_scc1 p5_l1_0
  s_waitcnt vmcnt(32)
  s_barrier
  s_waitcnt vmcnt(24)
  s_barrier
  s_waitcnt vmcnt(16)
  s_barrier
  s_waitcnt vmcnt(8)
  s_barrier
  s_waitcnt vmcnt(0)
  s_barrier
  s_barrier
  s_barrier
  s_endpgm
mk_ld2:
  s_mov_b32 s44, s57
  s_mov_b32 s45, s58
  v_lshrrev_b32 v1, 3, v0
  v_and_b32 v2, 7, v0
  v_and_b32 v3, 6, v1
  v_xor_b32 v3, v2, v3
  v_lshlrev_b32 v3, 4, v3
  s_mov_b32 s47, 2048
  v_mul_lo_u32 v8, v1, s47
  v_add_u32 v8, v8, v3
  v_and_b32 v3, 2, v1
  v_xor_b32 v3, v2, v3
  v_lshlrev_b32 v3, 4, v3
  s_mov_b32 s47, 6144
  v_mul_lo_u32 v9, v1, s47
  v_add_u32 v9, v9, v3
  v_and_b32 v10, 0x7f, v8
  s_lshl_b32 s49, s44, 18
  s_sub_u32 s49, s49, 32768
  v_add_u32 v8, s49, v8
  s_lshl_b32 s49, s45, 7
  v_add_u32 v9, s49, v9
  v_add_u32 v16, 32768, v8
  v_add_u32 v17, 81920, v8
  v_add_u32 v18, 131072, v8
  v_add_u32 v19, 180224, v8
  v_add_u32 v20, 229376, v8
  v_add_u32 v21, 278528, v8
  v_add_u32 v22, 98304, v9
  v_add_u32 v23, 245760, v9
  v_xor_b32 v23, 64, v23
  v_add_u32 v24, 2048, v9
  v_add_u32 v25, 149504, v9
  v_xor_b32 v25, 64, v25
  v_add_u32 v26, 296960, v9
  v_add_u32 v27, 53248, v9
  v_xor_b32 v27, 64, v27
  v_add_u32 v28, 200704, v9
  v_add_u32 v29, 348160, v9
  v_xor_b32 v29, 64, v29
  s_waitcnt lgkmcnt(0)
  s_mov_b32 s24, s72
  s_mov_b32 s25, s73
  s_mov_b32 s26, 0x400000
  s_mov_b32 s27, 0x20000
  s_mov_b32 s28, s74
  s_mov_b32 s29, s75
  s_mov_b32 s30, 0x600000
  s_mov_b32 s31, 0x20000
  s_mov_b32 s55, 0
  s_mov_b32 s56, 0
  s_mov_b32 s90, 0
  s_mov_b32 s91, 0
  s_mul_i32 s55, s44, 128
  s_mul_i32 s56, s44, 393216
  s_add_u32 m0, s90, 2048
  s_nop 0
  buffer_load_dwordx4 v16, s[24:27], s55 offen  lds
  s_add_u32 m0, s90, 5120
  s_nop 0
  buffer_load_dwordx4 v17, s[24:27], s55 offen  lds
  s_add_u32 m0, s90, 8192
  s_nop 0
  buffer_load_dwordx4 v18, s[24:27], s55 offen  lds
  s_add_u32 m0, s90, 11264
  s_nop 0
  buffer_load_dwordx4 v19, s[24:27], s55 offen  lds
  s_add_u32 m0, s90, 14336
  s_nop 0
  buffer_load_dwordx4 v20, s[24:27], s55 offen  lds
  s_add_u32 m0, s90, 17408
  s_nop 0
  buffer_load_dwordx4 v21, s[24:27], s55 offen  lds
  s_add_u32 s55, s55, 128
  s_add_u32 s90, s90, 43008
  s_cmp_eq_u32 s90, 129024
  s_cselect_b32 s90, 0, s90
  s_cmp_eq_u32 s55, 2048
  s_cselect_b32 s55, 0, s55
  s_add_u32 m0, s91, 20480
  s_nop 0
  buffer_load_dwordx4 v22, s[28:31], s56 offen  lds
  s_add_u32 m0, s91, 23552
  s_nop 0
  buffer_load_dwordx4 v23, s[28:31], s56 offen  lds
  s_add_u32 m0, s91, 26624
  s_nop 0
  buffer_load_dwordx4 v24, s[28:31], s56 offen  lds
  s_add_u32 m0, s91, 29696
  s_nop 0
  buffer_load_dwordx4 v25, s[28:31], s56 offen  lds
  s_add_u32 m0, s91, 32768
  s_nop 0
  buffer_load_dwordx4 v26, s[28:31], s56 offen  lds
  s_add_u32 m0, s91, 35840
  s_nop 0
  buffer_load_dwordx4 v27, s[28:31], s56 offen  lds
  s_add_u32 m0, s91, 38912
  s_nop 0
  buffer_load_dwordx4 v28, s[28:31], s56 offen  lds
  s_add_u32 m0, s91, 41984
  s_nop 0
  buffer_load_dwordx4 v29, s[28:31], s56 offen  lds
  s_add_u32 s56, s56, 393216
  s_add_u32 s91, s91, 43008
  s_cmp_eq_u32 s91, 129024
  s_cselect_b32 s91, 0, s91
  s_cmp_eq_u32 s56, 6291456
  s_cselect_b32 s56, 0, s56
  s_add_u32 m0, s90, 2048
  s_nop 0
  buffer_load_dwordx4 v16, s[24:27], s55 offen  lds
  s_add_u32 m0, s90, 5120
  s_nop 0
  buffer_load_dwordx4 v17, s[24:27], s55 offen  lds
  s_add_u32 m0, s90, 8192
  s_nop 0
  buffer_load_dwordx4 v18, s[24:27], s55 offen  lds
  s_add_u32 m0, s90, 11264
  s_nop 0
  buffer_load_dwordx4 v19, s[24:27], s55 offen  lds
  s_add_u32 m0, s90, 14336
  s_nop 0
  buffer_load_dwordx4 v20, s[24:27], s55 offen  lds
  s_add_u32 m0, s90, 17408
  s_nop 0
  buffer_load_dwordx4 v21, s[24:27], s55 offen  lds
  s_add_u32 s55, s55, 128
  s_add_u32 s90, s90, 43008
  s_cmp_eq_u32 s90, 129024
  s_cselect_b32 s90, 0, s90
  s_cmp_eq_u32 s55, 2048
  s_cselect_b32 s55, 0, s55
  s_add_u32 m0, s91, 20480
  s_nop 0
  buffer_load_dwordx4 v22, s[28:31], s56 offen  lds
  s_add_u32 m0, s91, 23552
  s_nop 0
  buffer_load_dwordx4 v23, s[28:31], s56 offen  lds
  s_add_u32 m0, s91, 26624
  s_nop 0
  buffer_load_dwordx4 v24, s[28:31], s56 offen  lds
  s_add_u32 m0, s91, 29696
  s_nop 0
  buffer_load_dwordx4 v25, s[28:31], s56 offen  lds
  s_add_u32 m0, s91, 32768
  s_nop 0
  buffer_load_dwordx4 v26, s[28:31], s56 offen  lds
  s_add_u32 m0, s91, 35840
  s_nop 0
  buffer_load_dwordx4 v27, s[28:31], s56 offen  lds
  s_add_u32 m0, s91, 38912
  s_nop 0
  buffer_load_dwordx4 v28, s[28:31], s56 offen  lds
  s_add_u32 m0, s91, 41984
  s_nop 0
  buffer_load_dwordx4 v29, s[28:31], s56 offen  lds
  s_add_u32 s56, s56, 393216
  s_add_u32 s91, s91, 43008
  s_cmp_eq_u32 s91, 129024
  s_cselect_b32 s91, 0, s91
  s_cmp_eq_u32 s56, 6291456
  s_cselect_b32 s56, 0, s56
  s_add_u32 m0, s90, 2048
  s_nop 0
  buffer_load_dwordx4 v16, s[24:27], s55 offen  lds
  s_add_u32 m0, s90, 5120
  s_nop 0
  buffer_load_dwordx4 v17, s[24:27], s55 offen  lds
  s_add_u32 m0, s90, 8192
  s_nop 0
  buffer_load_dwordx4 v18, s[24:27], s55 offen  lds
  s_add_u32 m0, s90, 11264
  s_nop 0
  buffer_load_dwordx4 v19, s[24:27], s55 offen  lds
  s_add_u32 m0, s90, 14336
  s_nop 0
  buffer_load_dwordx4 v20, s[24:27], s55 offen  lds
  s_add_u32 m0, s90, 17408
  s_nop 0
  buffer_load_dwordx4 v21, s[24:27], s55 offen  lds
  s_add_u32 s55, s55, 128
  s_add_u32 s90, s90, 43008
  s_cmp_eq_u32 s90, 129024
  s_cselect_b32 s90, 0, s90
  s_cmp_eq_u32 s55, 2048
  s_cselect_b32 s55, 0, s55
  s_add_u32 m0, s91, 20480
  s_nop 0
  buffer_load_dwordx4 v22, s[28:31], s56 offen  lds
  s_add_u32 m0, s91, 23552
  s_nop 0
  buffer_load_dwordx4 v23, s[28:31], s56 offen  lds
  s_add_u32 m0, s91, 26624
  s_nop 0
  buffer_load_dwordx4 v24, s[28:31], s56 offen  lds
  s_add_u32 m0, s91, 29696
  s_nop 0
  buffer_load_dwordx4 v25, s[28:31], s56 offen  lds
  s_add_u32 m0, s91, 32768
  s_nop 0
  buffer_load_dwordx4 v26, s[28:31], s56 offen  lds
  s_add_u32 m0, s91, 35840
  s_nop 0
  buffer_load_dwordx4 v27, s[28:31], s56 offen  lds
  s_add_u32 m0, s91, 38912
  s_nop 0
  buffer_load_dwordx4 v28, s[28:31], s56 offen  lds
  s_add_u32 m0, s91, 41984
  s_nop 0
  buffer_load_dwordx4 v29, s[28:31], s56 offen  lds
  s_add_u32 s56, s56, 393216
  s_add_u32 s91, s91, 43008
  s_cmp_eq_u32 s91, 129024
  s_cselect_b32 s91, 0, s91
  s_cmp_eq_u32 s56, 6291456
  s_cselect_b32 s56, 0, s56
  s_waitcnt vmcnt(28)
  s_barrier
  s_mov_b32 s52, 13
p1_l2_0:
  s_waitcnt vmcnt(14)
  s_barrier
  s_add_u32 m0, s90, 2048
  s_nop 0
  buffer_load_dwordx4 v16, s[24:27], s55 offen  lds
  s_add_u32 m0, s90, 5120
  s_nop 0
  buffer_load_dwordx4 v17, s[24:27], s55 offen  lds
  s_add_u32 m0, s90, 8192
  s_nop 0
  buffer_load_dwordx4 v18, s[24:27], s55 offen  lds
  s_add_u32 m0, s90, 11264
  s_nop 0
  buffer_load_dwordx4 v19, s[24:27], s55 offen  lds
  s_add_u32 m0, s90, 14336
  s_nop 0
  buffer_load_dwordx4 v20, s[24:27], s55 offen  lds
  s_add_u32 m0, s90, 17408
  s_nop 0
  buffer_load_dwordx4 v21, s[24:27], s55 offen  lds
  s_add_u32 s55, s55, 128
  s_add_u32 s90, s90, 43008
  s_cmp_eq_u32 s90, 129024
  s_cselect_b32 s90, 0, s90
  s_cmp_eq_u32 s55, 2048
  s_cselect_b32 s55, 0, s55
  s_add_u32 m0, s91, 20480
  s_nop 0
  buffer_load_dwordx4 v22, s[28:31], s56 offen  lds
  s_add_u32 m0, s91, 23552
  s_nop 0
  buffer_load_dwordx4 v23, s[28:31], s56 offen  lds
  s_add_u32 m0, s91, 26624
  s_nop 0
  buffer_load_dwordx4 v24, s[28:31], s56 offen  lds
  s_add_u32 m0, s91, 29696
  s_nop 0
  buffer_load_dwordx4 v25, s[28:31], s56 offen  lds
  s_add_u32 m0, s91, 32768
  s_nop 0
  buffer_load_dwordx4 v26, s[28:31], s56 offen  lds
  s_add_u32 m0, s91, 35840
  s_nop 0
  buffer_load_dwordx4 v27, s[28:31], s56 offen  lds
  s_add_u32 m0, s91, 38912
  s_nop 0
  buffer_load_dwordx4 v28, s[28:31], s56 offen  lds
  s_add_u32 m0, s91, 41984
  s_nop 0
  buffer_load_dwordx4 v29, s[28:31], s56 offen  lds
  s_add_u32 s56, s56, 393216
  s_add_u32 s91, s91, 43008
  s_cmp_eq_u32 s91, 129024
  s_cselect_b32 s91, 0, s91
  s_cmp_eq_u32 s56, 6291456
  s_cselect_b32 s56, 0, s56
  s_sub_u32 s52, s52, 1
  s_cmp_lg_u32 s52, 0
  s_cbranch_scc1 p1_l2_0
  s_waitcnt vmcnt(14)
  s_barrier
  s_waitcnt vmcnt(0)
  s_barrier
  s_barrier
  s_barrier
  s_mov_b32 s40, s12
  s_mov_b32 s41, s13
  s_mov_b32 s42, 0x700000
  s_mov_b32 s43, 0x20000
  s_mul_i32 s50, s2, 28672
  s_add_u32 s50, s50, 14336
  v_min_u32 v60, 55, v0
  v_lshlrev_b32 v60, 7, v60
  buffer_load_dword v61, v60, s[40:43], s50 offen
  s_barrier
  s_call_b64 s[84:85], attn_sub
  s_barrier
  s_mov_b32 s44, s59
  s_mov_b32 s45, s60
  s_add_u32 s24, s4, 0x400000
  s_addc_u32 s25, s5, 0x0
  s_mov_b32 s26, 0x400000
  s_mov_b32 s27, 0x20000
  s_mov_b32 s28, s10
  s_mov_b32 s29, s11
  s_mov_b32 s30, 0x200000
  s_mov_b32 s31, 0x20000
  v_lshrrev_b32 v1, 3, v0
  v_and_b32 v2, 7, v0
  v_and_b32 v3, 2, v1
  v_xor_b32 v3, v2, v3
  v_lshlrev_b32 v3, 4, v3
  s_mov_b32 s47, 2048
  v_mul_lo_u32 v9, v1, s47
  v_add_u32 v9, v9, v3
  v_lshrrev_b32 v1, 3, v0
  v_and_b32 v2, 7, v0
  v_and_b32 v3, 6, v1
  v_xor_b32 v2, v2, v3
  v_lshrrev_b32 v3, 2, v2
  v_lshlrev_b32 v8, 13, v3
  v_and_b32 v3, 1, v1
  v_lshl_add_u32 v8, v3, 12, v8
  v_lshrrev_b32 v3, 4, v0
  v_lshl_add_u32 v8, v3, 6, v8
  v_and_b32 v3, 3, v2
  v_lshl_add_u32 v8, v3, 4, v8
  s_mul_i32 s49, s44, 262144
  v_add_u32 v8, s49, v8
  s_lshl_b32 s49, s45, 7
  v_add_u32 v9, s49, v9
  v_add_u32 v16, 512, v8
  v_add_u32 v17, 1280, v8
  v_add_u32 v18, 2048, v8
  v_add_u32 v19, 2816, v8
  v_add_u32 v20, 3584, v8
  v_add_u32 v21, 16384, v9
  v_xor_b32 v21, 64, v21
  v_add_u32 v22, 65536, v9
  v_add_u32 v23, 114688, v9
  v_xor_b32 v23, 64, v23
  s_mov_b32 s55, 0
  s_mov_b32 s56, 0
  s_mov_b32 s90, 0
  s_mov_b32 s91, 0
  s_add_u32 m0, s91, 17408
  s_nop 0
  buffer_load_dwordx4 v21, s[28:31], s56 offen  lds
  s_add_u32 m0, s91, 20480
  s_nop 0
  buffer_load_dwordx4 v22, s[28:31], s56 offen  lds
  s_add_u32 m0, s91, 23552
  s_nop 0
  buffer_load_dwordx4 v23, s[28:31], s56 offen  lds
  s_add_u32 s56, s56, 131072
  s_add_u32 s91, s91, 24576
  s_cmp_eq_u32 s91, 147456
  s_cselect_b32 s91, 0, s91
  s_add_u32 m0, s91, 17408
  s_nop 0
  buffer_load_dwordx4 v21, s[28:31], s56 offen  lds
  s_add_u32 m0, s91, 20480
  s_nop 0
  buffer_load_dwordx4 v22, s[28:31], s56 offen  lds
  s_add_u32 m0, s91, 23552
  s_nop 0
  buffer_load_dwordx4 v23, s[28:31], s56 offen  lds
  s_add_u32 s56, s56, 131072
  s_add_u32 s91, s91, 24576
  s_cmp_eq_u32 s91, 147456
  s_cselect_b32 s91, 0, s91
  s_add_u32 m0, s91, 17408
  s_nop 0
  buffer_load_dwordx4 v21, s[28:31], s56 offen  lds
  s_add_u32 m0, s91, 20480
  s_nop 0
  buffer_load_dwordx4 v22, s[28:31], s56 offen  lds
  s_add_u32 m0, s91, 23552
  s_nop 0
  buffer_load_dwordx4 v23, s[28:31], s56 offen  lds
  s_add_u32 s56, s56, 131072
  s_add_u32 s91, s91, 24576
  s_cmp_eq_u32 s91, 147456
  s_cselect_b32 s91, 0, s91
  s_add_u32 m0, s91, 17408
  s_nop 0
  buffer_load_dwordx4 v21, s[28:31], s56 offen  lds
  s_add_u32 m0, s91, 20480
  s_nop 0
  buffer_load_dwordx4 v22, s[28:31], s56 offen  lds
  s_add_u32 m0, s91, 23552
  s_nop 0
  buffer_load_dwordx4 v23, s[28:31], s56 offen  lds
  s_add_u32 s56, s56, 131072
  s_add_u32 s91, s91, 24576
  s_cmp_eq_u32 s91, 147456
  s_cselect_b32 s91, 0, s91
  s_add_u32 m0, s91, 17408
  s_nop 0
  buffer_load_dwordx4 v21, s[28:31], s56 offen  lds
  s_add_u32 m0, s91, 20480
  s_nop 0
  buffer_load_dwordx4 v22, s[28:31], s56 offen  lds
  s_add_u32 m0, s91, 23552
  s_nop 0
  buffer_load_dwordx4 v23, s[28:31], s56 offen  lds
  s_add_u32 s56, s56, 131072
  s_add_u32 s91, s91, 24576
  s_cmp_eq_u32 s91, 147456
  s_cselect_b32 s91, 0, s91
  s_add_u32 m0, s91, 17408
  s_nop 0
  buffer_load_dwordx4 v21, s[28:31], s56 offen  lds
  s_add_u32 m0, s91, 20480
  s_nop 0
  buffer_load_dwordx4 v22, s[28:31], s56 offen  lds
  s_add_u32 m0, s91, 23552
  s_nop 0
  buffer_load_dwordx4 v23, s[28:31], s56 offen  lds
  s_add_u32 s56, s56, 131072
  s_add_u32 s91, s91, 24576
  s_cmp_eq_u32 s91, 147456
  s_cselect_b32 s91, 0, s91
  s_waitcnt vmcnt(18)
  s_barrier
  s_barrier
  s_add_u32 m0, s90, 2048
  s_nop 0
  buffer_load_dwordx4 v16, s[24:27], s55 offen sc1 lds
  s_add_u32 m0, s90, 5120
  s_nop 0
  buffer_load_dwordx4 v17, s[24:27], s55 offen sc1 lds
  s_add_u32 m0, s90, 8192
  s_nop 0
  buffer_load_dwordx4 v18, s[24:27], s55 offen sc1 lds
  s_add_u32 m0, s90, 11264
  s_nop 0
  buffer_load_dwordx4 v19, s[24:27], s55 offen sc1 lds
  s_add_u32 m0, s90, 14336
  s_nop 0
  buffer_load_dwordx4 v20, s[24:27], s55 offen sc1 lds
  s_add_u32 s55, s55, 16384
  s_add_u32 s90, s90, 24576
  s_cmp_eq_u32 s90, 147456
  s_cselect_b32 s90, 0, s90
  s_add_u32 m0, s90, 2048
  s_nop 0
  buffer_load_dwordx4 v16, s[24:27], s55 offen sc1 lds
  s_add_u32 m0, s90, 5120
  s_nop 0
  buffer_load_dwordx4 v17, s[24:27], s55 offen sc1 lds
  s_add_u32 m0, s90, 8192
  s_nop 0
  buffer_load_dwordx4 v18, s[24:27], s55 offen sc1 lds
  s_add_u32 m0, s90, 11264
  s_nop 0
  buffer_load_dwordx4 v19, s[24:27], s55 offen sc1 lds
  s_add_u32 m0, s90, 14336
  s_nop 0
  buffer_load_dwordx4 v20, s[24:27], s55 offen sc1 lds
  s_add_u32 s55, s55, 16384
  s_add_u32 s90, s90, 24576
  s_cmp_eq_u32 s90, 147456
  s_cselect_b32 s90, 0, s90
  s_add_u32 m0, s90, 2048
  s_nop 0
  buffer_load_dwordx4 v16, s[24:27], s55 offen sc1 lds
  s_add_u32 m0, s90, 5120
  s_nop 0
  buffer_load_dwordx4 v17, s[24:27], s55 offen sc1 lds
  s_add_u32 m0, s90, 8192
  s_nop 0
  buffer_load_dwordx4 v18, s[24:27], s55 offen sc1 lds
  s_add_u32 m0, s90, 11264
  s_nop 0
  buffer_load_dwordx4 v19, s[24:27], s55 offen sc1 lds
  s_add_u32 m0, s90, 14336
  s_nop 0
  buffer_load_dwordx4 v20, s[24:27], s55 offen sc1 lds
  s_add_u32 s55, s55, 16384
  s_add_u32 s90, s90, 24576
  s_cmp_eq_u32 s90, 147456
  s_cselect_b32 s90, 0, s90
  s_add_u32 m0, s90, 2048
  s_nop 0
  buffer_load_dwordx4 v16, s[24:27], s55 offen sc1 lds
  s_add_u32 m0, s90, 5120
  s_nop 0
  buffer_load_dwordx4 v17, s[24:27], s55 offen sc1 lds
  s_add_u32 m0, s90, 8192
  s_nop 0
  buffer_load_dwordx4 v18, s[24:27], s55 offen sc1 lds
  s_add_u32 m0, s90, 11264
  s_nop 0
  buffer_load_dwordx4 v19, s[24:27], s55 offen sc1 lds
  s_add_u32 m0, s90, 14336
  s_nop 0
  buffer_load_dwordx4 v20, s[24:27], s55 offen sc1 lds
  s_add_u32 s55, s55, 16384
  s_add_u32 s90, s90, 24576
  s_cmp_eq_u32 s90, 147456
  s_cselect_b32 s90, 0, s90
  s_add_u32 m0, s90, 2048
  s_nop 0
  buffer_load_dwordx4 v16, s[24:27], s55 offen sc1 lds
  s_add_u32 m0, s90, 5120
  s_nop 0
  buffer_load_dwordx4 v17, s[24:27], s55 offen sc1 lds
  s_add_u32 m0, s90, 8192
  s_nop 0
  buffer_load_dwordx4 v18, s[24:27], s55 offen sc1 lds
  s_add_u32 m0, s90, 11264
  s_nop 0
  buffer_load_dwordx4 v19, s[24:27], s55 offen sc1 lds
  s_add_u32 m0, s90, 14336
  s_nop 0
  buffer_load_dwordx4 v20, s[24:27], s55 offen sc1 lds
  s_add_u32 s55, s55, 16384
  s_add_u32 s90, s90, 24576
  s_cmp_eq_u32 s90, 147456
  s_cselect_b32 s90, 0, s90
  s_add_u32 m0, s90, 2048
  s_nop 0
  buffer_load_dwordx4 v16, s[24:27], s55 offen sc1 lds
  s_add_u32 m0, s90, 5120
  s_nop 0
  buffer_load_dwordx4 v17, s[24:27], s55 offen sc1 lds
  s_add_u32 m0, s90, 8192
  s_nop 0
  buffer_load_dwordx4 v18, s[24:27], s55 offen sc1 lds
  s_add_u32 m0, s90, 11264
  s_nop 0
  buffer_load_dwordx4 v19, s[24:27], s55 offen sc1 lds
  s_add_u32 m0, s90, 14336
  s_nop 0
  buffer_load_dwordx4 v20, s[24:27], s55 offen sc1 lds
  s_add_u32 s55, s55, 16384
  s_add_u32 s90, s90, 24576
  s_cmp_eq_u32 s90, 147456
  s_cselect_b32 s90, 0, s90
  s_waitcnt vmcnt(25)
  s_barrier
  s_waitcnt vmcnt(20)
  s_barrier
  s_add_u32 m0, s90, 2048
  s_nop 0
  buffer_load_dwordx4 v16, s[24:27], s55 offen sc1 lds
  s_add_u32 m0, s90, 5120
  s_nop 0
  buffer_load_dwordx4 v17, s[24:27], s55 offen sc1 lds
  s_add_u32 m0, s90, 8192
  s_nop 0
  buffer_load_dwordx4 v18, s[24:27], s55 offen sc1 lds
  s_add_u32 m0, s90, 11264
  s_nop 0
  buffer_load_dwordx4 v19, s[24:27], s55 offen sc1 lds
  s_add_u32 m0, s90, 14336
  s_nop 0
  buffer_load_dwordx4 v20, s[24:27], s55 offen sc1 lds
  s_add_u32 s55, s55, 16384
  s_add_u32 s90, s90, 24576
  s_cmp_eq_u32 s90, 147456
  s_cselect_b32 s90, 0, s90
  s_add_u32 m0, s91, 17408
  s_nop 0
  buffer_load_dwordx4 v21, s[28:31], s56 offen  lds
  s_add_u32 m0, s91, 20480
  s_nop 0
  buffer_load_dwordx4 v22, s[28:31], s56 offen  lds
  s_add_u32 m0, s91, 23552
  s_nop 0
  buffer_load_dwordx4 v23, s[28:31], s56 offen  lds
  s_add_u32 s56, s56, 131072
  s_add_u32 s91, s91, 24576
  s_cmp_eq_u32 s91, 147456
  s_cselect_b32 s91, 0, s91
  s_waitcnt vmcnt(23)
  s_barrier
  s_add_u32 m0, s90, 2048
  s_nop 0
  buffer_load_dwordx4 v16, s[24:27], s55 offen sc1 lds
  s_add_u32 m0, s90, 5120
  s_nop 0
  buffer_load_dwordx4 v17, s[24:27], s55 offen sc1 lds
  s_add_u32 m0, s90, 8192
  s_nop 0
  buffer_load_dwordx4 v18, s[24:27], s55 offen sc1 lds
  s_add_u32 m0, s90, 11264
  s_nop 0
  buffer_load_dwordx4 v19, s[24:27], s55 offen sc1 lds
  s_add_u32 m0, s90, 14336
  s_nop 0
  buffer_load_dwordx4 v20, s[24:27], s55 offen sc1 lds
  s_add_u32 s55, s55, 16384
  s_add_u32 s90, s90, 24576
  s_cmp_eq_u32 s90, 147456
  s_cselect_b32 s90, 0, s90
  s_add_u32 m0, s91, 17408
  s_nop 0
  buffer_load_dwordx4 v21, s[28:31], s56 offen  lds
  s_add_u32 m0, s91, 20480
  s_nop 0
  buffer_load_dwordx4 v22, s[28:31], s56 offen  lds
  s_add_u32 m0, s91, 23552
  s_nop 0
  buffer_load_dwordx4 v23, s[28:31], s56 offen  lds
  s_add_u32 s56, s56, 131072
  s_add_u32 s91, s91, 24576
  s_cmp_eq_u32 s91, 147456
  s_cselect_b32 s91, 0, s91
  s_waitcnt vmcnt(26)
  s_barrier
  s_add_u32 m0, s90, 2048
  s_nop 0
  buffer_load_dwordx4 v16, s[24:27], s55 offen sc1 lds
  s_add_u32 m0, s90, 5120
  s_nop 0
  buffer_load_dwordx4 v17, s[24:27], s55 offen sc1 lds
  s_add_u32 m0, s90, 8192
  s_nop 0
  buffer_load_dwordx4 v18, s[24:27], s55 offen sc1 lds
  s_add_u32 m0, s90, 11264
  s_nop 0
  buffer_load_dwordx4 v19, s[24:27], s55 offen sc1 lds
  s_add_u32 m0, s90, 14336
  s_nop 0
  buffer_load_dwordx4 v20, s[24:27], s55 offen sc1 lds
  s_add_u32 s55, s55, 16384
  s_add_u32 s90, s90, 24576
  s_cmp_eq_u32 s90, 147456
  s_cselect_b32 s90, 0, s90
  s_add_u32 m0, s91, 17408
  s_nop 0
  buffer_load_dwordx4 v21, s[28:31], s56 offen  lds
  s_add_u32 m0, s91, 20480
  s_nop 0
  buffer_load_dwordx4 v22, s[28:31], s56 offen  lds
  s_add_u32 m0, s91, 23552
  s_nop 0
  buffer_load_dwordx4 v23, s[28:31], s56 offen  lds
  s_add_u32 s56, s56, 131072
  s_add_u32 s91, s91, 24576
  s_cmp_eq_u32 s91, 147456
  s_cselect_b32 s91, 0, s91
  s_waitcnt vmcnt(29)
  s_barrier
  s_add_u32 m0, s90, 2048
  s_nop 0
  buffer_load_dwordx4 v16, s[24:27], s55 offen sc1 lds
  s_add_u32 m0, s90, 5120
  s_nop 0
  buffer_load_dwordx4 v17, s[24:27], s55 offen sc1 lds
  s_add_u32 m0, s90, 8192
  s_nop 0
  buffer_load_dwordx4 v18, s[24:27], s55 offen sc1 lds
  s_add_u32 m0, s90, 11264
  s_nop 0
  buffer_load_dwordx4 v19, s[24:27], s55 offen sc1 lds
  s_add_u32 m0, s90, 14336
  s_nop 0
  buffer_load_dwordx4 v20, s[24:27], s55 offen sc1 lds
  s_add_u32 s55, s55, 16384
  s_add_u32 s90, s90, 24576
  s_cmp_eq_u32 s90, 147456
  s_cselect_b32 s90, 0, s90
  s_add_u32 m0, s91, 17408
  s_nop 0
  buffer_load_dwordx4 v21, s[28:31], s56 offen  lds
  s_add_u32 m0, s91, 20480
  s_nop 0
  buffer_load_dwordx4 v22, s[28:31], s56 offen  lds
  s_add_u32 m0, s91, 23552
  s_nop 0
  buffer_load_dwordx4 v23, s[28:31], s56 offen  lds
  s_add_u32 s56, s56, 131072
  s_add_u32 s91, s91, 24576
  s_cmp_eq_u32 s91, 147456
  s_cselect_b32 s91, 0, s91
  s_mov_b32 s52, 6
p2_l2_0:
  s_waitcnt vmcnt(32)
  s_barrier
  s_add_u32 m0, s90, 2048
  s_nop 0
  buffer_load_dwordx4 v16, s[24:27], s55 offen sc1 lds
  s_add_u32 m0, s90, 5120
  s_nop 0
  buffer_load_dwordx4 v17, s[24:27], s55 offen sc1 lds
  s_add_u32 m0, s90, 8192
  s_nop 0
  buffer_load_dwordx4 v18, s[24:27], s55 offen sc1 lds
  s_add_u32 m0, s90, 11264
  s_nop 0
  buffer_load_dwordx4 v19, s[24:27], s55 offen sc1 lds
  s_add_u32 m0, s90, 14336
  s_nop 0
  buffer_load_dwordx4 v20, s[24:27], s55 offen sc1 lds
  s_add_u32 s55, s55, 16384
  s_add_u32 s90, s90, 24576
  s_cmp_eq_u32 s90, 147456
  s_cselect_b32 s90, 0, s90
  s_add_u32 m0, s91, 17408
  s_nop 0
  buffer_load_dwordx4 v21, s[28:31], s56 offen  lds
  s_add_u32 m0, s91, 20480
  s_nop 0
  buffer_load_dwordx4 v22, s[28:31], s56 offen  lds
  s_add_u32 m0, s91, 23552
  s_nop 0
  buffer_load_dwordx4 v23, s[28:31], s56 offen  lds
  s_add_u32 s56, s56, 131072
  s_add_u32 s91, s91, 24576
  s_cmp_eq_u32 s91, 147456
  s_cselect_b32 s91, 0, s91
  s_sub_u32 s52, s52, 1
  s_cmp_lg_u32 s52, 0
  s_cbranch_scc1 p2_l2_0
  s_waitcnt vmcnt(32)
  s_barrier
  s_waitcnt vmcnt(24)
  s_barrier
  s_waitcnt vmcnt(16)
  s_barrier
  s_waitcnt vmcnt(8)
  s_barrier
  s_waitcnt vmcnt(0)
  s_barrier
  s_barrier
  s_mov_b32 s44, s57
  s_mov_b32 s45, s58
  s_add_u32 s24, s4, 0x800000
  s_addc_u32 s25, s5, 0x0
  s_mov_b32 s26, 0x400000
  s_mov_b32 s27, 0x20000
  s_add_u32 s28, s4, 0x2800000
  s_addc_u32 s29, s5, 0x0
  s_mov_b32 s30, 0x700000
  s_mov_b32 s31, 0x20000
  s_mov_b32 s32, s14
  s_mov_b32 s33, s15
  s_mov_b32 s34, 0x800000
  s_mov_b32 s35, 0x20000
  s_add_u32 s36, s4, 0x1400000
  s_addc_u32 s37, s5, 0x0
  s_mov_b32 s38, 0x700000
  s_mov_b32 s39, 0x20000
  v_lshrrev_b32 v1, 3, v0
  v_and_b32 v2, 7, v0
  v_and_b32 v3, 6, v1
  v_xor_b32 v2, v2, v3
  v_lshrrev_b32 v3, 2, v2
  v_lshlrev_b32 v8, 13, v3
  v_lshl_add_u32 v8, v1, 6, v8
  v_and_b32 v3, 3, v2
  v_lshl_add_u32 v8, v3, 4, v8
  s_lshl_b32 s49, s44, 18
  v_add_u32 v8, s49, v8
  v_lshrrev_b32 v1, 3, v0
  v_and_b32 v2, 7, v0
  v_and_b32 v3, 6, v1
  v_xor_b32 v3, v2, v3
  v_lshlrev_b32 v3, 4, v3
  s_mov_b32 s47, 4096
  v_mul_lo_u32 v9, v1, s47
  v_add_u32 v9, v9, v3
  s_lshl_b32 s49, s44, 19
  v_add_u32 v9, s49, v9
  v_add_u32 v16, 1024, v8
  v_add_u32 v17, 2560, v8
  v_add_u32 v18, 4096, v8
  v_add_u32 v19, 5632, v8
  v_add_u32 v20, 7168, v8
  v_add_u32 v21, 65536, v9
  v_add_u32 v22, 163840, v9
  v_add_u32 v23, 262144, v9
  v_add_u32 v24, 360448, v9
  v_add_u32 v25, 458752, v9
  v_lshlrev_b32 v26, 4, v0
  v_add_u32 v26, 1024, v26
  v_lshlrev_b32 v27, 4, v0
  v_add_u32 v27, 4096, v27
  v_lshlrev_b32 v28, 4, v0
  v_add_u32 v28, 7168, v28
  v_lshlrev_b32 v29, 4, v0
  v_add_u32 v29, 10240, v29
  v_lshlrev_b32 v30, 4, v0
  v_add_u32 v30, 13312, v30
  s_mov_b32 s28, s12
  s_mov_b32 s29, s13
  s_mov_b32 s30, 0x700000
  s_mov_b32 s31, 0x20000
  s_mul_i32 s49, s45, 224
  s_mov_b32 s47, 4682
  s_mov_b32 s48, 7168
  v_add_u32 v1, 64, v0
  v_mul_lo_u32 v2, v1, s47
  v_lshrrev_b32 v2, 16, v2
  v_mul_u32_u24 v3, 14, v2
  v_sub_u32 v3, v1, v3
  v_and_b32 v4, 0x33, v2
  v_bfe_u32 v5, v2, 2, 1
  v_lshl_or_b32 v4, v5, 3, v4
  v_bfe_u32 v5, v2, 3, 1
  v_lshl_or_b32 v4, v5, 2, v4
  v_mul_lo_u32 v4, v4, s48
  v_lshl_add_u32 v4, v3, 4, v4
  v_add_u32 v31, s49, v4
  v_add_u32 v1, 256, v0
  v_mul_lo_u32 v2, v1, s47
  v_lshrrev_b32 v2, 16, v2
  v_mul_u32_u24 v3, 14, v2
  v_sub_u32 v3, v1, v3
  v_and_b32 v4, 0x33, v2
  v_bfe_u32 v5, v2, 2, 1
  v_lshl_or_b32 v4, v5, 3, v4
  v_bfe_u32 v5, v2, 3, 1
  v_lshl_or_b32 v4, v5, 2, v4
  v_mul_lo_u32 v4, v4, s48
  v_lshl_add_u32 v4, v3, 4, v4
  v_add_u32 v32, s49, v4
  v_add_u32 v1, 448, v0
  v_mul_lo_u32 v2, v1, s47
  v_lshrrev_b32 v2, 16, v2
  v_mul_u32_u24 v3, 14, v2
  v_sub_u32 v3, v1, v3
  v_and_b32 v4, 0x33, v2
  v_bfe_u32 v5, v2, 2, 1
  v_lshl_or_b32 v4, v5, 3, v4
  v_bfe_u32 v5, v2, 3, 1
  v_lshl_or_b32 v4, v5, 2, v4
  v_mul_lo_u32 v4, v4, s48
  v_lshl_add_u32 v4, v3, 4, v4
  v_add_u32 v33, s49, v4
  v_add_u32 v1, 640, v0
  v_mul_lo_u32 v2, v1, s47
  v_lshrrev_b32 v2, 16, v2
  v_mul_u32_u24 v3, 14, v2
  v_sub_u32 v3, v1, v3
  v_and_b32 v4, 0x33, v2
  v_bfe_u32 v5, v2, 2, 1
  v_lshl_or_b32 v4, v5, 3, v4
  v_bfe_u32 v5, v2, 3, 1
  v_lshl_or_b32 v4, v5, 2, v4
  v_mul_lo_u32 v4, v4, s48
  v_lshl_add_u32 v4, v3, 4, v4
  v_add_u32 v34, s49, v4
  v_add_u32 v1, 832, v0
  v_mul_lo_u32 v2, v1, s47
  v_lshrrev_b32 v2, 16, v2
  v_mul_u32_u24 v3, 14, v2
  v_sub_u32 v3, v1, v3
  v_and_b32 v4, 0x33, v2
  v_bfe_u32 v5, v2, 2, 1
  v_lshl_or_b32 v4, v5, 3, v4
  v_bfe_u32 v5, v2, 3, 1
  v_lshl_or_b32 v4, v5, 2, v4
  v_mul_lo_u32 v4, v4, s48
  v_lshl_add_u32 v4, v3, 4, v4
  v_add_u32 v35, s49, v4
  s_barrier
  s_barrier
  s_mov_b32 s55, 0
  s_mov_b32 s90, 0
  s_mov_b32 s91, 0
  s_mov_b32 s56, 3584
  s_add_u32 m0, s91, 17408
  s_nop 0
  buffer_load_dwordx4 v31, s[28:31], s56 offen  lds
  s_add_u32 m0, s91, 20480
  s_nop 0
  buffer_load_dwordx4 v32, s[28:31], s56 offen  lds
  s_add_u32 m0, s91, 23552
  s_nop 0
  buffer_load_dwordx4 v33, s[28:31], s56 offen  lds
  s_add_u32 m0, s91, 26624
  s_nop 0
  buffer_load_dwordx4 v34, s[28:31], s56 offen  lds
  s_add_u32 m0, s91, 29696
  s_nop 0
  buffer_load_dwordx4 v35, s[28:31], s56 offen  lds
  s_add_u32 s56, s56, 458752
  s_add_u32 s91, s91, 30720
  s_cmp_eq_u32 s91, 153600
  s_cselect_b32 s91, 0, s91
  s_add_u32 m0, s91, 17408
  s_nop 0
  buffer_load_dwordx4 v31, s[28:31], s56 offen  lds
  s_add_u32 m0, s91, 20480
  s_nop 0
  buffer_load_dwordx4 v32, s[28:31], s56 offen  lds
  s_add_u32 m0, s91, 23552
  s_nop 0
  buffer_load_dwordx4 v33, s[28:31], s56 offen  lds
  s_add_u32 m0, s91, 26624
  s_nop 0
  buffer_load_dwordx4 v34, s[28:31], s56 offen  lds
  s_add_u32 m0, s91, 29696
  s_nop 0
  buffer_load_dwordx4 v35, s[28:31], s56 offen  lds
  s_add_u32 s56, s56, 458752
  s_add_u32 s91, s91, 30720
  s_cmp_eq_u32 s91, 153600
  s_cselect_b32 s91, 0, s91
  s_add_u32 m0, s91, 17408
  s_nop 0
  buffer_load_dwordx4 v31, s[28:31], s56 offen  lds
  s_add_u32 m0, s91, 20480
  s_nop 0
  buffer_load_dwordx4 v32, s[28:31], s56 offen  lds
  s_add_u32 m0, s91, 23552
  s_nop 0
  buffer_load_dwordx4 v33, s[28:31], s56 offen  lds
  s_add_u32 m0, s91, 26624
  s_nop 0
  buffer_load_dwordx4 v34, s[28:31], s56 offen  lds
  s_add_u32 m0, s91, 29696
  s_nop 0
  buffer_load_dwordx4 v35, s[28:31], s56 offen  lds
  s_add_u32 s56, s56, 458752
  s_add_u32 s91, s91, 30720
  s_cmp_eq_u32 s91, 153600
  s_cselect_b32 s91, 0, s91
  s_add_u32 m0, s91, 17408
  s_nop 0
  buffer_load_dwordx4 v31, s[28:31], s56 offen  lds
  s_add_u32 m0, s91, 20480
  s_nop 0
  buffer_load_dwordx4 v32, s[28:31], s56 offen  lds
  s_add_u32 m0, s91, 23552
  s_nop 0
  buffer_load_dwordx4 v33, s[28:31], s56 offen  lds
  s_add_u32 m0, s91, 26624
  s_nop 0
  buffer_load_dwordx4 v34, s[28:31], s56 offen  lds
  s_add_u32 m0, s91, 29696
  s_nop 0
  buffer_load_dwordx4 v35, s[28:31], s56 offen  lds
  s_add_u32 s56, s56, 458752
  s_add_u32 s91, s91, 30720
  s_cmp_eq_u32 s91, 153600
  s_cselect_b32 s91, 0, s91
  s_add_u32 m0, s91, 17408
  s_nop 0
  buffer_load_dwordx4 v31, s[28:31], s56 offen  lds
  s_add_u32 m0, s91, 20480
  s_nop 0
  buffer_load_dwordx4 v32, s[28:31], s56 offen  lds
  s_add_u32 m0, s91, 23552
  s_nop 0
  buffer_load_dwordx4 v33, s[28:31], s56 offen  lds
  s_add_u32 m0, s91, 26624
  s_nop 0
  buffer_load_dwordx4 v34, s[28:31], s56 offen  lds
  s_add_u32 m0, s91, 29696
  s_nop 0
  buffer_load_dwordx4 v35, s[28:31], s56 offen  lds
  s_add_u32 s56, s56, 458752
  s_add_u32 s91, s91, 30720
  s_cmp_eq_u32 s91, 153600
  s_cselect_b32 s91, 0, s91
  s_barrier
  s_barrier
  s_barrier
  s_add_u32 m0, s90, 2048
  s_nop 0
  buffer_load_dwordx4 v16, s[24:27], s55 offen sc1 lds
  s_add_u32 m0, s90, 5120
  s_nop 0
  buffer_load_dwordx4 v17, s[24:27], s55 offen sc1 lds
  s_add_u32 m0, s90, 8192
  s_nop 0
  buffer_load_dwordx4 v18, s[24:27], s55 offen sc1 lds
  s_add_u32 m0, s90, 11264
  s_nop 0
  buffer_load_dwordx4 v19, s[24:27], s55 offen sc1 lds
  s_add_u32 m0, s90, 14336
  s_nop 0
  buffer_load_dwordx4 v20, s[24:27], s55 offen sc1 lds
  s_add_u32 s55, s55, 16384
  s_add_u32 s90, s90, 30720
  s_cmp_eq_u32 s90, 153600
  s_cselect_b32 s90, 0, s90
  s_add_u32 m0, s90, 2048
  s_nop 0
  buffer_load_dwordx4 v16, s[24:27], s55 offen sc1 lds
  s_add_u32 m0, s90, 5120
  s_nop 0
  buffer_load_dwordx4 v17, s[24:27], s55 offen sc1 lds
  s_add_u32 m0, s90, 8192
  s_nop 0
  buffer_load_dwordx4 v18, s[24:27], s55 offen sc1 lds
  s_add_u32 m0, s90, 11264
  s_nop 0
  buffer_load_dwordx4 v19, s[24:27], s55 offen sc1 lds
  s_add_u32 m0, s90, 14336
  s_nop 0
  buffer_load_dwordx4 v20, s[24:27], s55 offen sc1 lds
  s_add_u32 s55, s55, 16384
  s_add_u32 s90, s90, 30720
  s_cmp_eq_u32 s90, 153600
  s_cselect_b32 s90, 0, s90
  s_add_u32 m0, s90, 2048
  s_nop 0
  buffer_load_dwordx4 v16, s[24:27], s55 offen sc1 lds
  s_add_u32 m0, s90, 5120
  s_nop 0
  buffer_load_dwordx4 v17, s[24:27], s55 offen sc1 lds
  s_add_u32 m0, s90, 8192
  s_nop 0
  buffer_load_dwordx4 v18, s[24:27], s55 offen sc1 lds
  s_add_u32 m0, s90, 11264
  s_nop 0
  buffer_load_dwordx4 v19, s[24:27], s55 offen sc1 lds
  s_add_u32 m0, s90, 14336
  s_nop 0
  buffer_load_dwordx4 v20, s[24:27], s55 offen sc1 lds
  s_add_u32 s55, s55, 16384
  s_add_u32 s90, s90, 30720
  s_cmp_eq_u32 s90, 153600
  s_cselect_b32 s90, 0, s90
  s_add_u32 m0, s90, 2048
  s_nop 0
  buffer_load_dwordx4 v16, s[24:27], s55 offen sc1 lds
  s_add_u32 m0, s90, 5120
  s_nop 0
  buffer_load_dwordx4 v17, s[24:27], s55 offen sc1 lds
  s_add_u32 m0, s90, 8192
  s_nop 0
  buffer_load_dwordx4 v18, s[24:27], s55 offen sc1 lds
  s_add_u32 m0, s90, 11264
  s_nop 0
  buffer_load_dwordx4 v19, s[24:27], s55 offen sc1 lds
  s_add_u32 m0, s90, 14336
  s_nop 0
  buffer_load_dwordx4 v20, s[24:27], s55 offen sc1 lds
  s_add_u32 s55, s55, 16384
  s_add_u32 s90, s90, 30720
  s_cmp_eq_u32 s90, 153600
  s_cselect_b32 s90, 0, s90
  s_add_u32 m0, s90, 2048
  s_nop 0
  buffer_load_dwordx4 v16, s[24:27], s55 offen sc1 lds
  s_add_u32 m0, s90, 5120
  s_nop 0
  buffer_load_dwordx4 v17, s[24:27], s55 offen sc1 lds
  s_add_u32 m0, s90, 8192
  s_nop 0
  buffer_load_dwordx4 v18, s[24:27], s55 offen sc1 lds
  s_add_u32 m0, s90, 11264
  s_nop 0
  buffer_load_dwordx4 v19, s[24:27], s55 offen sc1 lds
  s_add_u32 m0, s90, 14336
  s_nop 0
  buffer_load_dwordx4 v20, s[24:27], s55 offen sc1 lds
  s_add_u32 s55, s55, 16384
  s_add_u32 s90, s90, 30720
  s_cmp_eq_u32 s90, 153600
  s_cselect_b32 s90, 0, s90
  s_waitcnt vmcnt(20)
  s_barrier
  s_waitcnt vmcnt(15)
  s_barrier
  s_add_u32 m0, s90, 2048
  s_nop 0
  buffer_load_dwordx4 v16, s[24:27], s55 offen sc1 lds
  s_add_u32 m0, s90, 5120
  s_nop 0
  buffer_load_dwordx4 v17, s[24:27], s55 offen sc1 lds
  s_add_u32 m0, s90, 8192
  s_nop 0
  buffer_load_dwordx4 v18, s[24:27], s55 offen sc1 lds
  s_add_u32 m0, s90, 11264
  s_nop 0
  buffer_load_dwordx4 v19, s[24:27], s55 offen sc1 lds
  s_add_u32 m0, s90, 14336
  s_nop 0
  buffer_load_dwordx4 v20, s[24:27], s55 offen sc1 lds
  s_add_u32 s55, s55, 16384
  s_add_u32 s90, s90, 30720
  s_cmp_eq_u32 s90, 153600
  s_cselect_b32 s90, 0, s90
  s_add_u32 m0, s91, 17408
  s_nop 0
  buffer_load_dwordx4 v31, s[28:31], s56 offen  lds
  s_add_u32 m0, s91, 20480
  s_nop 0
  buffer_load_dwordx4 v32, s[28:31], s56 offen  lds
  s_add_u32 m0, s91, 23552
  s_nop 0
  buffer_load_dwordx4 v33, s[28:31], s56 offen  lds
  s_add_u32 m0, s91, 26624
  s_nop 0
  buffer_load_dwordx4 v34, s[28:31], s56 offen  lds
  s_add_u32 m0, s91, 29696
  s_nop 0
  buffer_load_dwordx4 v35, s[28:31], s56 offen  lds
  s_add_u32 s56, s56, 458752
  s_add_u32 s91, s91, 30720
  s_cmp_eq_u32 s91, 153600
  s_cselect_b32 s91, 0, s91
  s_waitcnt vmcnt(20)
  s_barrier
  s_add_u32 m0, s90, 2048
  s_nop 0
  buffer_load_dwordx4 v16, s[24:27], s55 offen sc1 lds
  s_add_u32 m0, s90, 5120
  s_nop 0
  buffer_load_dwordx4 v17, s[24:27], s55 offen sc1 lds
  s_add_u32 m0, s90, 8192
  s_nop 0
  buffer_load_dwordx4 v18, s[24:27], s55 offen sc1 lds
  s_add_u32 m0, s90, 11264
  s_nop 0
  buffer_load_dwordx4 v19, s[24:27], s55 offen sc1 lds
  s_add_u32 m0, s90, 14336
  s_nop 0
  buffer_load_dwordx4 v20, s[24:27], s55 offen sc1 lds
  s_add_u32 s55, s55, 16384
  s_add_u32 s90, s90, 30720
  s_cmp_eq_u32 s90, 153600
  s_cselect_b32 s90, 0, s90
  s_add_u32 m0, s91, 17408
  s_nop 0
  buffer_load_dwordx4 v31, s[28:31], s56 offen  lds
  s_add_u32 m0, s91, 20480
  s_nop 0
  buffer_load_dwordx4 v32, s[28:31], s56 offen  lds
  s_add_u32 m0, s91, 23552
  s_nop 0
  buffer_load_dwordx4 v33, s[28:31], s56 offen  lds
  s_add_u32 m0, s91, 26624
  s_nop 0
  buffer_load_dwordx4 v34, s[28:31], s56 offen  lds
  s_add_u32 m0, s91, 29696
  s_nop 0
  buffer_load_dwordx4 v35, s[28:31], s56 offen  lds
  s_add_u32 s56, s56, 458752
  s_add_u32 s91, s91, 30720
  s_cmp_eq_u32 s91, 153600
  s_cselect_b32 s91, 0, s91
  s_waitcnt vmcnt(25)
  s_barrier
  s_add_u32 m0, s90, 2048
  s_nop 0
  buffer_load_dwordx4 v16, s[24:27], s55 offen sc1 lds
  s_add_u32 m0, s90, 5120
  s_nop 0
  buffer_load_dwordx4 v17, s[24:27], s55 offen sc1 lds
  s_add_u32 m0, s90, 8192
  s_nop 0
  buffer_load_dwordx4 v18, s[24:27], s55 offen sc1 lds
  s_add_u32 m0, s90, 11264
  s_nop 0
  buffer_load_dwordx4 v19, s[24:27], s55 offen sc1 lds
  s_add_u32 m0, s90, 14336
  s_nop 0
  buffer_load_dwordx4 v20, s[24:27], s55 offen sc1 lds
  s_add_u32 s55, s55, 16384
  s_add_u32 s90, s90, 30720
  s_cmp_eq_u32 s90, 153600
  s_cselect_b32 s90, 0, s90
  s_add_u32 m0, s91, 17408
  s_nop 0
  buffer_load_dwordx4 v31, s[28:31], s56 offen  lds
  s_add_u32 m0, s91, 20480
  s_nop 0
  buffer_load_dwordx4 v32, s[28:31], s56 offen  lds
  s_add_u32 m0, s91, 23552
  s_nop 0
  buffer_load_dwordx4 v33, s[28:31], s56 offen  lds
  s_add_u32 m0, s91, 26624
  s_nop 0
  buffer_load_dwordx4 v34, s[28:31], s56 offen  lds
  s_add_u32 m0, s91, 29696
  s_nop 0
  buffer_load_dwordx4 v35, s[28:31], s56 offen  lds
  s_add_u32 s56, s56, 458752
  s_add_u32 s91, s91, 30720
  s_cmp_eq_u32 s91, 153600
  s_cselect_b32 s91, 0, s91
  s_mov_b32 s52, 8
p34_l2_0:
  s_waitcnt vmcnt(30)
  s_barrier
  s_add_u32 m0, s90, 2048
  s_nop 0
  buffer_load_dwordx4 v16, s[24:27], s55 offen sc1 lds
  s_add_u32 m0, s90, 5120
  s_nop 0
  buffer_load_dwordx4 v17, s[24:27], s55 offen sc1 lds
  s_add_u32 m0, s90, 8192
  s_nop 0
  buffer_load_dwordx4 v18, s[24:27], s55 offen sc1 lds
  s_add_u32 m0, s90, 11264
  s_nop 0
  buffer_load_dwordx4 v19, s[24:27], s55 offen sc1 lds
  s_add_u32 m0, s90, 14336
  s_nop 0
  buffer_load_dwordx4 v20, s[24:27], s55 offen sc1 lds
  s_add_u32 s55, s55, 16384
  s_add_u32 s90, s90, 30720
  s_cmp_eq_u32 s90, 153600
  s_cselect_b32 s90, 0, s90
  s_add_u32 m0, s91, 17408
  s_nop 0
  buffer_load_dwordx4 v31, s[28:31], s56 offen  lds
  s_add_u32 m0, s91, 20480
  s_nop 0
  buffer_load_dwordx4 v32, s[28:31], s56 offen  lds
  s_add_u32 m0, s91, 23552
  s_nop 0
  buffer_load_dwordx4 v33, s[28:31], s56 offen  lds
  s_add_u32 m0, s91, 26624
  s_nop 0
  buffer_load_dwordx4 v34, s[28:31], s56 offen  lds
  s_add_u32 m0, s91, 29696
  s_nop 0
  buffer_load_dwordx4 v35, s[28:31], s56 offen  lds
  s_add_u32 s56, s56, 458752
  s_add_u32 s91, s91, 30720
  s_cmp_eq_u32 s91, 153600
  s_cselect_b32 s91, 0, s91
  s_sub_u32 s52, s52, 1
  s_cmp_lg_u32 s52, 0
  s_cbranch_scc1 p34_l2_0
  s_waitcnt vmcnt(30)
  s_barrier
  s_mov_b32 s55, 0
  s_mov_b32 s56, 0
  s_add_u32 m0, s90, 2048
  s_nop 0
  buffer_load_dwordx4 v16, s[24:27], s55 offen sc1 lds
  s_add_u32 m0, s90, 5120
  s_nop 0
  buffer_load_dwordx4 v17, s[24:27], s55 offen sc1 lds
  s_add_u32 m0, s90, 8192
  s_nop 0
  buffer_load_dwordx4 v18, s[24:27], s55 offen sc1 lds
  s_add_u32 m0, s90, 11264
  s_nop 0
  buffer_load_dwordx4 v19, s[24:27], s55 offen sc1 lds
  s_add_u32 m0, s90, 14336
  s_nop 0
  buffer_load_dwordx4 v20, s[24:27], s55 offen sc1 lds
  s_add_u32 s55, s55, 16384
  s_add_u32 s90, s90, 30720
  s_cmp_eq_u32 s90, 153600
  s_cselect_b32 s90, 0, s90
  s_add_u32 m0, s91, 17408
  s_nop 0
  buffer_load_dwordx4 v31, s[28:31], s56 offen  lds
  s_add_u32 m0, s91, 20480
  s_nop 0
  buffer_load_dwordx4 v32, s[28:31], s56 offen  lds
  s_add_u32 m0, s91, 23552
  s_nop 0
  buffer_load_dwordx4 v33, s[28:31], s56 offen  lds
  s_add_u32 m0, s91, 26624
  s_nop 0
  buffer_load_dwordx4 v34, s[28:31], s56 offen  lds
  s_add_u32 m0, s91, 29696
  s_nop 0
  buffer_load_dwordx4 v35, s[28:31], s56 offen  lds
  s_add_u32 s56, s56, 458752
  s_add_u32 s91, s91, 30720
  s_cmp_eq_u32 s91, 153600
  s_cselect_b32 s91, 0, s91
  s_mov_b32 s52, 3
p34_l2_1:
  s_waitcnt vmcnt(30)
  s_barrier
  s_add_u32 m0, s90, 2048
  s_nop 0
  buffer_load_dwordx4 v16, s[24:27], s55 offen sc1 lds
  s_add_u32 m0, s90, 5120
  s_nop 0
  buffer_load_dwordx4 v17, s[24:27], s55 offen sc1 lds
  s_add_u32 m0, s90, 8192
  s_nop 0
  buffer_load_dwordx4 v18, s[24:27], s55 offen sc1 lds
  s_add_u32 m0, s90, 11264
  s_nop 0
  buffer_load_dwordx4 v19, s[24:27], s55 offen sc1 lds
  s_add_u32 m0, s90, 14336
  s_nop 0
  buffer_load_dwordx4 v20, s[24:27], s55 offen sc1 lds
  s_add_u32 s55, s55, 16384
  s_add_u32 s90, s90, 30720
  s_cmp_eq_u32 s90, 153600
  s_cselect_b32 s90, 0, s90
  s_add_u32 m0, s91, 17408
  s_nop 0
  buffer_load_dwordx4 v31, s[28:31], s56 offen  lds
  s_add_u32 m0, s91, 20480
  s_nop 0
  buffer_load_dwordx4 v32, s[28:31], s56 offen  lds
  s_add_u32 m0, s91, 23552
  s_nop 0
  buffer_load_dwordx4 v33, s[28:31], s56 offen  lds
  s_add_u32 m0, s91, 26624
  s_nop 0
  buffer_load_dwordx4 v34, s[28:31], s56 offen  lds
  s_add_u32 m0, s91, 29696
  s_nop 0
  buffer_load_dwordx4 v35, s[28:31], s56 offen  lds
  s_add_u32 s56, s56, 458752
  s_add_u32 s91, s91, 30720
  s_cmp_eq_u32 s91, 153600
  s_cselect_b32 s91, 0, s91
  s_sub_u32 s52, s52, 1
  s_cmp_lg_u32 s52, 0
  s_cbranch_scc1 p34_l2_1
  s_waitcnt vmcnt(30)
  s_barrier
  s_add_u32 m0, s90, 2048
  s_nop 0
  buffer_load_dwordx4 v16, s[24:27], s55 offen sc1 lds
  s_add_u32 m0, s90, 5120
  s_nop 0
  buffer_load_dwordx4 v17, s[24:27], s55 offen sc1 lds
  s_add_u32 m0, s90, 8192
  s_nop 0
  buffer_load_dwordx4 v18, s[24:27], s55 offen sc1 lds
  s_add_u32 m0, s90, 11264
  s_nop 0
  buffer_load_dwordx4 v19, s[24:27], s55 offen sc1 lds
  s_add_u32 m0, s90, 14336
  s_nop 0
  buffer_load_dwordx4 v20, s[24:27], s55 offen sc1 lds
  s_add_u32 s55, s55, 16384
  s_add_u32 s90, s90, 30720
  s_cmp_eq_u32 s90, 153600
  s_cselect_b32 s90, 0, s90
  s_add_u32 m0, s91, 17408
  s_nop 0
  buffer_load_dwordx4 v31, s[28:31], s56 offen  lds
  s_add_u32 m0, s91, 20480
  s_nop 0
  buffer_load_dwordx4 v32, s[28:31], s56 offen  lds
  s_add_u32 m0, s91, 23552
  s_nop 0
  buffer_load_dwordx4 v33, s[28:31], s56 offen  lds
  s_add_u32 m0, s91, 26624
  s_nop 0
  buffer_load_dwordx4 v34, s[28:31], s56 offen  lds
  s_add_u32 m0, s91, 29696
  s_nop 0
  buffer_load_dwordx4 v35, s[28:31], s56 offen  lds
  s_add_u32 s56, s56, 458752
  s_add_u32 s91, s91, 30720
  s_cmp_eq_u32 s91, 153600
  s_cselect_b32 s91, 0, s91
  s_mov_b32 s40, s14
  s_mov_b32 s41, s15
  s_mov_b32 s42, 0x800000
  s_mov_b32 s43, 0x20000
  s_mul_i32 s50, s2, 32768
  s_add_u32 s50, s50, 16384
  v_min_u32 v60, 63, v0
  v_lshlrev_b32 v60, 7, v60
  buffer_load_dword v61, v60, s[40:43], s50 offen
  s_mov_b32 s52, 4
p34_l2_2:
  s_waitcnt vmcnt(31)
  s_barrier
  s_add_u32 m0, s90, 2048
  s_nop 0
  buffer_load_dwordx4 v16, s[24:27], s55 offen sc1 lds
  s_add_u32 m0, s90, 5120
  s_nop 0
  buffer_load_dwordx4 v17, s[24:27], s55 offen sc1 lds
  s_add_u32 m0, s90, 8192
  s_nop 0
  buffer_load_dwordx4 v18, s[24:27], s55 offen sc1 lds
  s_add_u32 m0, s90, 11264
  s_nop 0
  buffer_load_dwordx4 v19, s[24:27], s55 offen sc1 lds
  s_add_u32 m0, s90, 14336
  s_nop 0
  buffer_load_dwordx4 v20, s[24:27], s55 offen sc1 lds
  s_add_u32 s55, s55, 16384
  s_add_u32 s90, s90, 30720
  s_cmp_eq_u32 s90, 153600
  s_cselect_b32 s90, 0, s90
  s_add_u32 m0, s91, 17408
  s_nop 0
  buffer_load_dwordx4 v31, s[28:31], s56 offen  lds
  s_add_u32 m0, s91, 20480
  s_nop 0
  buffer_load_dwordx4 v32, s[28:31], s56 offen  lds
  s_add_u32 m0, s91, 23552
  s_nop 0
  buffer_load_dwordx4 v33, s[28:31], s56 offen  lds
  s_add_u32 m0, s91, 26624
  s_nop 0
  buffer_load_dwordx4 v34, s[28:31], s56 offen  lds
  s_add_u32 m0, s91, 29696
  s_nop 0
  buffer_load_dwordx4 v35, s[28:31], s56 offen  lds
  s_add_u32 s56, s56, 458752
  s_add_u32 s91, s91, 30720
  s_cmp_eq_u32 s91, 153600
  s_cselect_b32 s91, 0, s91
  s_sub_u32 s52, s52, 1
  s_cmp_lg_u32 s52, 0
  s_cbranch_scc1 p34_l2_2
  s_mov_b32 s52, 7
p34_l2_3:
  s_waitcnt vmcnt(30)
  s_barrier
  s_add_u32 m0, s90, 2048
  s_nop 0
  buffer_load_dwordx4 v16, s[24:27], s55 offen sc1 lds
  s_add_u32 m0, s90, 5120
  s_nop 0
  buffer_load_dwordx4 v17, s[24:27], s55 offen sc1 lds
  s_add_u32 m0, s90, 8192
  s_nop 0
  buffer_load_dwordx4 v18, s[24:27], s55 offen sc1 lds
  s_add_u32 m0, s90, 11264
  s_nop 0
  buffer_load_dwordx4 v19, s[24:27], s55 offen sc1 lds
  s_add_u32 m0, s90, 14336
  s_nop 0
  buffer_load_dwordx4 v20, s[24:27], s55 offen sc1 lds
  s_add_u32 s55, s55, 16384
  s_add_u32 s90, s90, 30720
  s_cmp_eq_u32 s90, 153600
  s_cselect_b32 s90, 0, s90
  s_add_u32 m0, s91, 17408
  s_nop 0
  buffer_load_dwordx4 v31, s[28:31], s56 offen  lds
  s_add_u32 m0, s91, 20480
  s_nop 0
  buffer_load_dwordx4 v32, s[28:31], s56 offen  lds
  s_add_u32 m0, s91, 23552
  s_nop 0
  buffer_load_dwordx4 v33, s[28:31], s56 offen  lds
  s_add_u32 m0, s91, 26624
  s_nop 0
  buffer_load_dwordx4 v34, s[28:31], s56 offen  lds
  s_add_u32 m0, s91, 29696
  s_nop 0
  buffer_load_dwordx4 v35, s[28:31], s56 offen  lds
  s_add_u32 s56, s56, 458752
  s_add_u32 s91, s91, 30720
  s_cmp_eq_u32 s91, 153600
  s_cselect_b32 s91, 0, s91
  s_sub_u32 s52, s52, 1
  s_cmp_lg_u32 s52, 0
  s_cbranch_scc1 p34_l2_3
  s_waitcnt vmcnt(30)
  s_barrier
  s_lshl_b32 s55, s44, 8
  s_mul_i32 s94, s45, 458752
  s_add_u32 s95, s94, 458752
  s_mul_i32 s56, s44, 28672
  s_add_u32 s56, s56, s94
  s_add_u32 m0, s90, 2048
  s_nop 0
  buffer_load_dwordx4 v21, s[32:35], s55 offen  lds
  s_add_u32 m0, s90, 5120
  s_nop 0
  buffer_load_dwordx4 v22, s[32:35], s55 offen  lds
  s_add_u32 m0, s90, 8192
  s_nop 0
  buffer_load_dwordx4 v23, s[32:35], s55 offen  lds
  s_add_u32 m0, s90, 11264
  s_nop 0
  buffer_load_dwordx4 v24, s[32:35], s55 offen  lds
  s_add_u32 m0, s90, 14336
  s_nop 0
  buffer_load_dwordx4 v25, s[32:35], s55 offen  lds
  s_add_u32 s55, s55, 128
  s_add_u32 s90, s90, 30720
  s_cmp_eq_u32 s90, 153600
  s_cselect_b32 s90, 0, s90
  s_and_b32 s55, s55, 4095
  s_waitcnt vmcnt(25)
  s_barrier
  s_add_u32 m0, s90, 2048
  s_nop 0
  buffer_load_dwordx4 v21, s[32:35], s55 offen  lds
  s_add_u32 m0, s90, 5120
  s_nop 0
  buffer_load_dwordx4 v22, s[32:35], s55 offen  lds
  s_add_u32 m0, s90, 8192
  s_nop 0
  buffer_load_dwordx4 v23, s[32:35], s55 offen  lds
  s_add_u32 m0, s90, 11264
  s_nop 0
  buffer_load_dwordx4 v24, s[32:35], s55 offen  lds
  s_add_u32 m0, s90, 14336
  s_nop 0
  buffer_load_dwordx4 v25, s[32:35], s55 offen  lds
  s_add_u32 s55, s55, 128
  s_add_u32 s90, s90, 30720
  s_cmp_eq_u32 s90, 153600
  s_cselect_b32 s90, 0, s90
  s_and_b32 s55, s55, 4095
  s_waitcnt vmcnt(20)
  s_barrier
  s_add_u32 m0, s90, 2048
  s_nop 0
  buffer_load_dwordx4 v21, s[32:35], s55 offen  lds
  s_add_u32 m0, s90, 5120
  s_nop 0
  buffer_load_dwordx4 v22, s[32:35], s55 offen  lds
  s_add_u32 m0, s90, 8192
  s_nop 0
  buffer_load_dwordx4 v23, s[32:35], s55 offen  lds
  s_add_u32 m0, s90, 11264
  s_nop 0
  buffer_load_dwordx4 v24, s[32:35], s55 offen  lds
  s_add_u32 m0, s90, 14336
  s_nop 0
  buffer_load_dwordx4 v25, s[32:35], s55 offen  lds
  s_add_u32 s55, s55, 128
  s_add_u32 s90, s90, 30720
  s_cmp_eq_u32 s90, 153600
  s_cselect_b32 s90, 0, s90
  s_and_b32 s55, s55, 4095
  s_waitcnt vmcnt(15)
  s_barrier
  s_add_u32 m0, s90, 2048
  s_nop 0
  buffer_load_dwordx4 v21, s[32:35], s55 offen  lds
  s_add_u32 m0, s90, 5120
  s_nop 0
  buffer_load_dwordx4 v22, s[32:35], s55 offen  lds
  s_add_u32 m0, s90, 8192
  s_nop 0
  buffer_load_dwordx4 v23, s[32:35], s55 offen  lds
  s_add_u32 m0, s90, 11264
  s_nop 0
  buffer_load_dwordx4 v24, s[32:35], s55 offen  lds
  s_add_u32 m0, s90, 14336
  s_nop 0
  buffer_load_dwordx4 v25, s[32:35], s55 offen  lds
  s_add_u32 s55, s55, 128
  s_add_u32 s90, s90, 30720
  s_cmp_eq_u32 s90, 153600
  s_cselect_b32 s90, 0, s90
  s_and_b32 s55, s55, 4095
  s_mov_b32 s40, s18
  s_mov_b32 s41, s19
  s_mov_b32 s42, 0x380000
  s_mov_b32 s43, 0x20000
  s_mul_i32 s50, s2, 14336
  s_add_u32 s50, s50, 9728
  v_min_u32 v60, 35, v0
  v_lshlrev_b32 v60, 7, v60
  buffer_load_dword v61, v60, s[40:43], s50 offen
  s_barrier
  s_add_u32 m0, s91, 17408
  s_nop 0
  buffer_load_dwordx4 v26, s[36:39], s56 offen sc1 lds
  s_add_u32 m0, s91, 20480
  s_nop 0
  buffer_load_dwordx4 v27, s[36:39], s56 offen sc1 lds
  s_add_u32 m0, s91, 23552
  s_nop 0
  buffer_load_dwordx4 v28, s[36:39], s56 offen sc1 lds
  s_add_u32 m0, s91, 26624
  s_nop 0
  buffer_load_dwordx4 v29, s[36:39], s56 offen sc1 lds
  s_add_u32 m0, s91, 29696
  s_nop 0
  buffer_load_dwordx4 v30, s[36:39], s56 offen sc1 lds
  s_add_u32 s56, s56, 14336
  s_add_u32 s91, s91, 30720
  s_cmp_eq_u32 s91, 153600
  s_cselect_b32 s91, 0, s91
  s_cmp_eq_u32 s56, s95
  s_cselect_b32 s56, s94, s56
  s_add_u32 m0, s91, 17408
  s_nop 0
  buffer_load_dwordx4 v26, s[36:39], s56 offen sc1 lds
  s_add_u32 m0, s91, 20480
  s_nop 0
  buffer_load_dwordx4 v27, s[36:39], s56 offen sc1 lds
  s_add_u32 m0, s91, 23552
  s_nop 0
  buffer_load_dwordx4 v28, s[36:39], s56 offen sc1 lds
  s_add_u32 m0, s91, 26624
  s_nop 0
  buffer_load_dwordx4 v29, s[36:39], s56 offen sc1 lds
  s_add_u32 m0, s91, 29696
  s_nop 0
  buffer_load_dwordx4 v30, s[36:39], s56 offen sc1 lds
  s_add_u32 s56, s56, 14336
  s_add_u32 s91, s91, 30720
  s_cmp_eq_u32 s91, 153600
  s_cselect_b32 s91, 0, s91
  s_cmp_eq_u32 s56, s95
  s_cselect_b32 s56, s94, s56
  s_add_u32 m0, s91, 17408
  s_nop 0
  buffer_load_dwordx4 v26, s[36:39], s56 offen sc1 lds
  s_add_u32 m0, s91, 20480
  s_nop 0
  buffer_load_dwordx4 v27, s[36:39], s56 offen sc1 lds
  s_add_u32 m0, s91, 23552
  s_nop 0
  buffer_load_dwordx4 v28, s[36:39], s56 offen sc1 lds
  s_add_u32 m0, s91, 26624
  s_nop 0
  buffer_load_dwordx4 v29, s[36:39], s56 offen sc1 lds
  s_add_u32 m0, s91, 29696
  s_nop 0
  buffer_load_dwordx4 v30, s[36:39], s56 offen sc1 lds
  s_add_u32 s56, s56, 14336
  s_add_u32 s91, s91, 30720
  s_cmp_eq_u32 s91, 153600
  s_cselect_b32 s91, 0, s91
  s_cmp_eq_u32 s56, s95
  s_cselect_b32 s56, s94, s56
  s_add_u32 m0, s91, 17408
  s_nop 0
  buffer_load_dwordx4 v26, s[36:39], s56 offen sc1 lds
  s_add_u32 m0, s91, 20480
  s_nop 0
  buffer_load_dwordx4 v27, s[36:39], s56 offen sc1 lds
  s_add_u32 m0, s91, 23552
  s_nop 0
  buffer_load_dwordx4 v28, s[36:39], s56 offen sc1 lds
  s_add_u32 m0, s91, 26624
  s_nop 0
  buffer_load_dwordx4 v29, s[36:39], s56 offen sc1 lds
  s_add_u32 m0, s91, 29696
  s_nop 0
  buffer_load_dwordx4 v30, s[36:39], s56 offen sc1 lds
  s_add_u32 s56, s56, 14336
  s_add_u32 s91, s91, 30720
  s_cmp_eq_u32 s91, 153600
  s_cselect_b32 s91, 0, s91
  s_cmp_eq_u32 s56, s95
  s_cselect_b32 s56, s94, s56
  s_add_u32 m0, s90, 2048
  s_nop 0
  buffer_load_dwordx4 v21, s[32:35], s55 offen  lds
  s_add_u32 m0, s90, 5120
  s_nop 0
  buffer_load_dwordx4 v22, s[32:35], s55 offen  lds
  s_add_u32 m0, s90, 8192
  s_nop 0
  buffer_load_dwordx4 v23, s[32:35], s55 offen  lds
  s_add_u32 m0, s90, 11264
  s_nop 0
  buffer_load_dwordx4 v24, s[32:35], s55 offen  lds
  s_add_u32 m0, s90, 14336
  s_nop 0
  buffer_load_dwordx4 v25, s[32:35], s55 offen  lds
  s_add_u32 s55, s55, 128
  s_add_u32 s90, s90, 30720
  s_cmp_eq_u32 s90, 153600
  s_cselect_b32 s90, 0, s90
  s_and_b32 s55, s55, 4095
  s_add_u32 m0, s91, 17408
  s_nop 0
  buffer_load_dwordx4 v26, s[36:39], s56 offen sc1 lds
  s_add_u32 m0, s91, 20480
  s_nop 0
  buffer_load_dwordx4 v27, s[36:39], s56 offen sc1 lds
  s_add_u32 m0, s91, 23552
  s_nop 0
  buffer_load_dwordx4 v28, s[36:39], s56 offen sc1 lds
  s_add_u32 m0, s91, 26624
  s_nop 0
  buffer_load_dwordx4 v29, s[36:39], s56 offen sc1 lds
  s_add_u32 m0, s91, 29696
  s_nop 0
  buffer_load_dwordx4 v30, s[36:39], s56 offen sc1 lds
  s_add_u32 s56, s56, 14336
  s_add_u32 s91, s91, 30720
  s_cmp_eq_u32 s91, 153600
  s_cselect_b32 s91, 0, s91
  s_cmp_eq_u32 s56, s95
  s_cselect_b32 s56, s94, s56
  s_waitcnt vmcnt(25)
  s_barrier
  s_waitcnt vmcnt(20)
  s_barrier
  s_add_u32 m0, s90, 2048
  s_nop 0
  buffer_load_dwordx4 v21, s[32:35], s55 offen  lds
  s_add_u32 m0, s90, 5120
  s_nop 0
  buffer_load_dwordx4 v22, s[32:35], s55 offen  lds
  s_add_u32 m0, s90, 8192
  s_nop 0
  buffer_load_dwordx4 v23, s[32:35], s55 offen  lds
  s_add_u32 m0, s90, 11264
  s_nop 0
  buffer_load_dwordx4 v24, s[32:35], s55 offen  lds
  s_add_u32 m0, s90, 14336
  s_nop 0
  buffer_load_dwordx4 v25, s[32:35], s55 offen  lds
  s_add_u32 s55, s55, 128
  s_add_u32 s90, s90, 30720
  s_cmp_eq_u32 s90, 153600
  s_cselect_b32 s90, 0, s90
  s_and_b32 s55, s55, 4095
  s_add_u32 m0, s91, 17408
  s_nop 0
  buffer_load_dwordx4 v26, s[36:39], s56 offen sc1 lds
  s_add_u32 m0, s91, 20480
  s_nop 0
  buffer_load_dwordx4 v27, s[36:39], s56 offen sc1 lds
  s_add_u32 m0, s91, 23552
  s_nop 0
  buffer_load_dwordx4 v28, s[36:39], s56 offen sc1 lds
  s_add_u32 m0, s91, 26624
  s_nop 0
  buffer_load_dwordx4 v29, s[36:39], s56 offen sc1 lds
  s_add_u32 m0, s91, 29696
  s_nop 0
  buffer_load_dwordx4 v30, s[36:39], s56 offen sc1 lds
  s_add_u32 s56, s56, 14336
  s_add_u32 s91, s91, 30720
  s_cmp_eq_u32 s91, 153600
  s_cselect_b32 s91, 0, s91
  s_cmp_eq_u32 s56, s95
  s_cselect_b32 s56, s94, s56
  s_waitcnt vmcnt(25)
  s_barrier
  s_add_u32 m0, s90, 2048
  s_nop 0
  buffer_load_dwordx4 v21, s[32:35], s55 offen  lds
  s_add_u32 m0, s90, 5120
  s_nop 0
  buffer_load_dwordx4 v22, s[32:35], s55 offen  lds
  s_add_u32 m0, s90, 8192
  s_nop 0
  buffer_load_dwordx4 v23, s[32:35], s55 offen  lds
  s_add_u32 m0, s90, 11264
  s_nop 0
  buffer_load_dwordx4 v24, s[32:35], s55 offen  lds
  s_add_u32 m0, s90, 14336
  s_nop 0
  buffer_load_dwordx4 v25, s[32:35], s55 offen  lds
  s_add_u32 s55, s55, 128
  s_add_u32 s90, s90, 30720
  s_cmp_eq_u32 s90, 153600
  s_cselect_b32 s90, 0, s90
  s_and_b32 s55, s55, 4095
  s_add_u32 m0, s91, 17408
  s_nop 0
  buffer_load_dwordx4 v26, s[36:39], s56 offen sc1 lds
  s_add_u32 m0, s91, 20480
  s_nop 0
  buffer_load_dwordx4 v27, s[36:39], s56 offen sc1 lds
  s_add_u32 m0, s91, 23552
  s_nop 0
  buffer_load_dwordx4 v28, s[36:39], s56 offen sc1 lds
  s_add_u32 m0, s91, 26624
  s_nop 0
  buffer_load_dwordx4 v29, s[36:39], s56 offen sc1 lds
  s_add_u32 m0, s91, 29696
  s_nop 0
  buffer_load_dwordx4 v30, s[36:39], s56 offen sc1 lds
  s_add_u32 s56, s56, 14336
  s_add_u32 s91, s91, 30720
  s_cmp_eq_u32 s91, 153600
  s_cselect_b32 s91, 0, s91
  s_cmp_eq_u32 s56, s95
  s_cselect_b32 s56, s94, s56
  s_mov_b32 s52, 25
p34_l2_4:
  s_waitcnt vmcnt(30)
  s_barrier
  s_add_u32 m0, s90, 2048
  s_nop 0
  buffer_load_dwordx4 v21, s[32:35], s55 offen  lds
  s_add_u32 m0, s90, 5120
  s_nop 0
  buffer_load_dwordx4 v22, s[32:35], s55 offen  lds
  s_add_u32 m0, s90, 8192
  s_nop 0
  buffer_load_dwordx4 v23, s[32:35], s55 offen  lds
  s_add_u32 m0, s90, 11264
  s_nop 0
  buffer_load_dwordx4 v24, s[32:35], s55 offen  lds
  s_add_u32 m0, s90, 14336
  s_nop 0
  buffer_load_dwordx4 v25, s[32:35], s55 offen  lds
  s_add_u32 s55, s55, 128
  s_add_u32 s90, s90, 30720
  s_cmp_eq_u32 s90, 153600
  s_cselect_b32 s90, 0, s90
  s_and_b32 s55, s55, 4095
  s_add_u32 m0, s91, 17408
  s_nop 0
  buffer_load_dwordx4 v26, s[36:39], s56 offen sc1 lds
  s_add_u32 m0, s91, 20480
  s_nop 0
  buffer_load_dwordx4 v27, s[36:39], s56 offen sc1 lds
  s_add_u32 m0, s91, 23552
  s_nop 0
  buffer_load_dwordx4 v28, s[36:39], s56 offen sc1 lds
  s_add_u32 m0, s91, 26624
  s_nop 0
  buffer_load_dwordx4 v29, s[36:39], s56 offen sc1 lds
  s_add_u32 m0, s91, 29696
  s_nop 0
  buffer_load_dwordx4 v30, s[36:39], s56 offen sc1 lds
  s_add_u32 s56, s56, 14336
  s_add_u32 s91, s91, 30720
  s_cmp_eq_u32 s91, 153600
  s_cselect_b32 s91, 0, s91
  s_cmp_eq_u32 s56, s95
  s_cselect_b32 s56, s94, s56
  s_sub_u32 s52, s52, 1
  s_cmp_lg_u32 s52, 0
  s_cbranch_scc1 p34_l2_4
  s_waitcnt vmcnt(30)
  s_barrier
  s_waitcnt vmcnt(20)
  s_barrier
  s_waitcnt vmcnt(10)
  s_barrier
  s_waitcnt vmcnt(0)
  s_barrier
  s_barrier
  s_mov_b32 s44, s59
  s_mov_b32 s45, s60
  s_add_u32 s24, s4, 0x1c00000
  s_addc_u32 s25, s5, 0x0
  s_mov_b32 s26, 0x700000
  s_mov_b32 s27, 0x20000
  s_mov_b32 s28, s18
  s_mov_b32 s29, s19
  s_mov_b32 s30, 0x380000
  s_mov_b32 s31, 0x20000
  v_lshrrev_b32 v1, 3, v0
  v_and_b32 v2, 7, v0
  v_and_b32 v3, 2, v1
  v_xor_b32 v3, v2, v3
  v_lshlrev_b32 v3, 4, v3
  s_mov_b32 s47, 2048
  v_mul_lo_u32 v9, v1, s47
  v_add_u32 v9, v9, v3
  v_lshrrev_b32 v1, 3, v0
  v_and_b32 v2, 7, v0
  v_and_b32 v3, 6, v1
  v_xor_b32 v2, v2, v3
  v_lshrrev_b32 v3, 2, v2
  v_lshlrev_b32 v8, 13, v3
  v_lshl_add_u32 v8, v1, 6, v8
  v_and_b32 v3, 3, v2
  v_lshl_add_u32 v8, v3, 4, v8
  s_mul_i32 s49, s44, 458752
  v_add_u32 v8, s49, v8
  s_lshl_b32 s49, s45, 7
  v_add_u32 v9, s49, v9
  v_add_u32 v16, 1024, v8
  v_add_u32 v17, 2560, v8
  v_add_u32 v18, 4096, v8
  v_add_u32 v19, 5632, v8
  v_add_u32 v20, 7168, v8
  v_add_u32 v21, 16384, v9
  v_xor_b32 v21, 64, v21
  v_add_u32 v22, 65536, v9
  v_add_u32 v23, 114688, v9
  v_xor_b32 v23, 64, v23
  s_barrier
  s_barrier
  s_mov_b32 s55, 0
  s_mov_b32 s56, 0
  s_mov_b32 s90, 0
  s_mov_b32 s91, 0
  s_add_u32 m0, s91, 17408
  s_nop 0
  buffer_load_dwordx4 v21, s[28:31], s56 offen  lds
  s_add_u32 m0, s91, 20480
  s_nop 0
  buffer_load_dwordx4 v22, s[28:31], s56 offen  lds
  s_add_u32 m0, s91, 23552
  s_nop 0
  buffer_load_dwordx4 v23, s[28:31], s56 offen  lds
  s_add_u32 s56, s56, 131072
  s_add_u32 s91, s91, 24576
  s_cmp_eq_u32 s91, 147456
  s_cselect_b32 s91, 0, s91
  s_add_u32 m0, s91, 17408
  s_nop 0
  buffer_load_dwordx4 v21, s[28:31], s56 offen  lds
  s_add_u32 m0, s91, 20480
  s_nop 0
  buffer_load_dwordx4 v22, s[28:31], s56 offen  lds
  s_add_u32 m0, s91, 23552
  s_nop 0
  buffer_load_dwordx4 v23, s[28:31], s56 offen  lds
  s_add_u32 s56, s56, 131072
  s_add_u32 s91, s91, 24576
  s_cmp_eq_u32 s91, 147456
  s_cselect_b32 s91, 0, s91
  s_add_u32 m0, s91, 17408
  s_nop 0
  buffer_load_dwordx4 v21, s[28:31], s56 offen  lds
  s_add_u32 m0, s91, 20480
  s_nop 0
  buffer_load_dwordx4 v22, s[28:31], s56 offen  lds
  s_add_u32 m0, s91, 23552
  s_nop 0
  buffer_load_dwordx4 v23, s[28:31], s56 offen  lds
  s_add_u32 s56, s56, 131072
  s_add_u32 s91, s91, 24576
  s_cmp_eq_u32 s91, 147456
  s_cselect_b32 s91, 0, s91
  s_add_u32 m0, s91, 17408
  s_nop 0
  buffer_load_dwordx4 v21, s[28:31], s56 offen  lds
  s_add_u32 m0, s91, 20480
  s_nop 0
  buffer_load_dwordx4 v22, s[28:31], s56 offen  lds
  s_add_u32 m0, s91, 23552
  s_nop 0
  buffer_load_dwordx4 v23, s[28:31], s56 offen  lds
  s_add_u32 s56, s56, 131072
  s_add_u32 s91, s91, 24576
  s_cmp_eq_u32 s91, 147456
  s_cselect_b32 s91, 0, s91
  s_add_u32 m0, s91, 17408
  s_nop 0
  buffer_load_dwordx4 v21, s[28:31], s56 offen  lds
  s_add_u32 m0, s91, 20480
  s_nop 0
  buffer_load_dwordx4 v22, s[28:31], s56 offen  lds
  s_add_u32 m0, s91, 23552
  s_nop 0
  buffer_load_dwordx4 v23, s[28:31], s56 offen  lds
  s_add_u32 s56, s56, 131072
  s_add_u32 s91, s91, 24576
  s_cmp_eq_u32 s91, 147456
  s_cselect_b32 s91, 0, s91
  s_add_u32 m0, s91, 17408
  s_nop 0
  buffer_load_dwordx4 v21, s[28:31], s56 offen  lds
  s_add_u32 m0, s91, 20480
  s_nop 0
  buffer_load_dwordx4 v22, s[28:31], s56 offen  lds
  s_add_u32 m0, s91, 23552
  s_nop 0
  buffer_load_dwordx4 v23, s[28:31], s56 offen  lds
  s_add_u32 s56, s56, 131072
  s_add_u32 s91, s91, 24576
  s_cmp_eq_u32 s91, 147456
  s_cselect_b32 s91, 0, s91
  s_barrier
  s_barrier
  s_add_u32 m0, s90, 2048
  s_nop 0
  buffer_load_dwordx4 v16, s[24:27], s55 offen sc1 lds
  s_add_u32 m0, s90, 5120
  s_nop 0
  buffer_load_dwordx4 v17, s[24:27], s55 offen sc1 lds
  s_add_u32 m0, s90, 8192
  s_nop 0
  buffer_load_dwordx4 v18, s[24:27], s55 offen sc1 lds
  s_add_u32 m0, s90, 11264
  s_nop 0
  buffer_load_dwordx4 v19, s[24:27], s55 offen sc1 lds
  s_add_u32 m0, s90, 14336
  s_nop 0
  buffer_load_dwordx4 v20, s[24:27], s55 offen sc1 lds
  s_add_u32 s55, s55, 16384
  s_add_u32 s90, s90, 24576
  s_cmp_eq_u32 s90, 147456
  s_cselect_b32 s90, 0, s90
  s_add_u32 m0, s90, 2048
  s_nop 0
  buffer_load_dwordx4 v16, s[24:27], s55 offen sc1 lds
  s_add_u32 m0, s90, 5120
  s_nop 0
  buffer_load_dwordx4 v17, s[24:27], s55 offen sc1 lds
  s_add_u32 m0, s90, 8192
  s_nop 0
  buffer_load_dwordx4 v18, s[24:27], s55 offen sc1 lds
  s_add_u32 m0, s90, 11264
  s_nop 0
  buffer_load_dwordx4 v19, s[24:27], s55 offen sc1 lds
  s_add_u32 m0, s90, 14336
  s_nop 0
  buffer_load_dwordx4 v20, s[24:27], s55 offen sc1 lds
  s_add_u32 s55, s55, 16384
  s_add_u32 s90, s90, 24576
  s_cmp_eq_u32 s90, 147456
  s_cselect_b32 s90, 0, s90
  s_add_u32 m0, s90, 2048
  s_nop 0
  buffer_load_dwordx4 v16, s[24:27], s55 offen sc1 lds
  s_add_u32 m0, s90, 5120
  s_nop 0
  buffer_load_dwordx4 v17, s[24:27], s55 offen sc1 lds
  s_add_u32 m0, s90, 8192
  s_nop 0
  buffer_load_dwordx4 v18, s[24:27], s55 offen sc1 lds
  s_add_u32 m0, s90, 11264
  s_nop 0
  buffer_load_dwordx4 v19, s[24:27], s55 offen sc1 lds
  s_add_u32 m0, s90, 14336
  s_nop 0
  buffer_load_dwordx4 v20, s[24:27], s55 offen sc1 lds
  s_add_u32 s55, s55, 16384
  s_add_u32 s90, s90, 24576
  s_cmp_eq_u32 s90, 147456
  s_cselect_b32 s90, 0, s90
  s_add_u32 m0, s90, 2048
  s_nop 0
  buffer_load_dwordx4 v16, s[24:27], s55 offen sc1 lds
  s_add_u32 m0, s90, 5120
  s_nop 0
  buffer_load_dwordx4 v17, s[24:27], s55 offen sc1 lds
  s_add_u32 m0, s90, 8192
  s_nop 0
  buffer_load_dwordx4 v18, s[24:27], s55 offen sc1 lds
  s_add_u32 m0, s90, 11264
  s_nop 0
  buffer_load_dwordx4 v19, s[24:27], s55 offen sc1 lds
  s_add_u32 m0, s90, 14336
  s_nop 0
  buffer_load_dwordx4 v20, s[24:27], s55 offen sc1 lds
  s_add_u32 s55, s55, 16384
  s_add_u32 s90, s90, 24576
  s_cmp_eq_u32 s90, 147456
  s_cselect_b32 s90, 0, s90
  s_add_u32 m0, s90, 2048
  s_nop 0
  buffer_load_dwordx4 v16, s[24:27], s55 offen sc1 lds
  s_add_u32 m0, s90, 5120
  s_nop 0
  buffer_load_dwordx4 v17, s[24:27], s55 offen sc1 lds
  s_add_u32 m0, s90, 8192
  s_nop 0
  buffer_load_dwordx4 v18, s[24:27], s55 offen sc1 lds
  s_add_u32 m0, s90, 11264
  s_nop 0
  buffer_load_dwordx4 v19, s[24:27], s55 offen sc1 lds
  s_add_u32 m0, s90, 14336
  s_nop 0
  buffer_load_dwordx4 v20, s[24:27], s55 offen sc1 lds
  s_add_u32 s55, s55, 16384
  s_add_u32 s90, s90, 24576
  s_cmp_eq_u32 s90, 147456
  s_cselect_b32 s90, 0, s90
  s_add_u32 m0, s90, 2048
  s_nop 0
  buffer_load_dwordx4 v16, s[24:27], s55 offen sc1 lds
  s_add_u32 m0, s90, 5120
  s_nop 0
  buffer_load_dwordx4 v17, s[24:27], s55 offen sc1 lds
  s_add_u32 m0, s90, 8192
  s_nop 0
  buffer_load_dwordx4 v18, s[24:27], s55 offen sc1 lds
  s_add_u32 m0, s90, 11264
  s_nop 0
  buffer_load_dwordx4 v19, s[24:27], s55 offen sc1 lds
  s_add_u32 m0, s90, 14336
  s_nop 0
  buffer_load_dwordx4 v20, s[24:27], s55 offen sc1 lds
  s_add_u32 s55, s55, 16384
  s_add_u32 s90, s90, 24576
  s_cmp_eq_u32 s90, 147456
  s_cselect_b32 s90, 0, s90
  s_waitcnt vmcnt(25)
  s_barrier
  s_waitcnt vmcnt(20)
  s_barrier
  s_add_u32 m0, s90, 2048
  s_nop 0
  buffer_load_dwordx4 v16, s[24:27], s55 offen sc1 lds
  s_add_u32 m0, s90, 5120
  s_nop 0
  buffer_load_dwordx4 v17, s[24:27], s55 offen sc1 lds
  s_add_u32 m0, s90, 8192
  s_nop 0
  buffer_load_dwordx4 v18, s[24:27], s55 offen sc1 lds
  s_add_u32 m0, s90, 11264
  s_nop 0
  buffer_load_dwordx4 v19, s[24:27], s55 offen sc1 lds
  s_add_u32 m0, s90, 14336
  s_nop 0
  buffer_load_dwordx4 v20, s[24:27], s55 offen sc1 lds
  s_add_u32 s55, s55, 16384
  s_add_u32 s90, s90, 24576
  s_cmp_eq_u32 s90, 147456
  s_cselect_b32 s90, 0, s90
  s_add_u32 m0, s91, 17408
  s_nop 0
  buffer_load_dwordx4 v21, s[28:31], s56 offen  lds
  s_add_u32 m0, s91, 20480
  s_nop 0
  buffer_load_dwordx4 v22, s[28:31], s56 offen  lds
  s_add_u32 m0, s91, 23552
  s_nop 0
  buffer_load_dwordx4 v23, s[28:31], s56 offen  lds
  s_add_u32 s56, s56, 131072
  s_add_u32 s91, s91, 24576
  s_cmp_eq_u32 s91, 147456
  s_cselect_b32 s91, 0, s91
  s_waitcnt vmcnt(23)
  s_barrier
  s_add_u32 m0, s90, 2048
  s_nop 0
  buffer_load_dwordx4 v16, s[24:27], s55 offen sc1 lds
  s_add_u32 m0, s90, 5120
  s_nop 0
  buffer_load_dwordx4 v17, s[24:27], s55 offen sc1 lds
  s_add_u32 m0, s90, 8192
  s_nop 0
  buffer_load_dwordx4 v18, s[24:27], s55 offen sc1 lds
  s_add_u32 m0, s90, 11264
  s_nop 0
  buffer_load_dwordx4 v19, s[24:27], s55 offen sc1 lds
  s_add_u32 m0, s90, 14336
  s_nop 0
  buffer_load_dwordx4 v20, s[24:27], s55 offen sc1 lds
  s_add_u32 s55, s55, 16384
  s_add_u32 s90, s90, 24576
  s_cmp_eq_u32 s90, 147456
  s_cselect_b32 s90, 0, s90
  s_add_u32 m0, s91, 17408
  s_nop 0
  buffer_load_dwordx4 v21, s[28:31], s56 offen  lds
  s_add_u32 m0, s91, 20480
  s_nop 0
  buffer_load_dwordx4 v22, s[28:31], s56 offen  lds
  s_add_u32 m0, s91, 23552
  s_nop 0
  buffer_load_dwordx4 v23, s[28:31], s56 offen  lds
  s_add_u32 s56, s56, 131072
  s_add_u32 s91, s91, 24576
  s_cmp_eq_u32 s91, 147456
  s_cselect_b32 s91, 0, s91
  s_waitcnt vmcnt(26)
  s_barrier
  s_add_u32 m0, s90, 2048
  s_nop 0
  buffer_load_dwordx4 v16, s[24:27], s55 offen sc1 lds
  s_add_u32 m0, s90, 5120
  s_nop 0
  buffer_load_dwordx4 v17, s[24:27], s55 offen sc1 lds
  s_add_u32 m0, s90, 8192
  s_nop 0
  buffer_load_dwordx4 v18, s[24:27], s55 offen sc1 lds
  s_add_u32 m0, s90, 11264
  s_nop 0
  buffer_load_dwordx4 v19, s[24:27], s55 offen sc1 lds
  s_add_u32 m0, s90, 14336
  s_nop 0
  buffer_load_dwordx4 v20, s[24:27], s55 offen sc1 lds
  s_add_u32 s55, s55, 16384
  s_add_u32 s90, s90, 24576
  s_cmp_eq_u32 s90, 147456
  s_cselect_b32 s90, 0, s90
  s_add_u32 m0, s91, 17408
  s_nop 0
  buffer_load_dwordx4 v21, s[28:31], s56 offen  lds
  s_add_u32 m0, s91, 20480
  s_nop 0
  buffer_load_dwordx4 v22, s[28:31], s56 offen  lds
  s_add_u32 m0, s91, 23552
  s_nop 0
  buffer_load_dwordx4 v23, s[28:31], s56 offen  lds
  s_add_u32 s56, s56, 131072
  s_add_u32 s91, s91, 24576
  s_cmp_eq_u32 s91, 147456
  s_cselect_b32 s91, 0, s91
  s_waitcnt vmcnt(29)
  s_barrier
  s_add_u32 m0, s90, 2048
  s_nop 0
  buffer_load_dwordx4 v16, s[24:27], s55 offen sc1 lds
  s_add_u32 m0, s90, 5120
  s_nop 0
  buffer_load_dwordx4 v17, s[24:27], s55 offen sc1 lds
  s_add_u32 m0, s90, 8192
  s_nop 0
  buffer_load_dwordx4 v18, s[24:27], s55 offen sc1 lds
  s_add_u32 m0, s90, 11264
  s_nop 0
  buffer_load_dwordx4 v19, s[24:27], s55 offen sc1 lds
  s_add_u32 m0, s90, 14336
  s_nop 0
  buffer_load_dwordx4 v20, s[24:27], s55 offen sc1 lds
  s_add_u32 s55, s55, 16384
  s_add_u32 s90, s90, 24576
  s_cmp_eq_u32 s90, 147456
  s_cselect_b32 s90, 0, s90
  s_add_u32 m0, s91, 17408
  s_nop 0
  buffer_load_dwordx4 v21, s[28:31], s56 offen  lds
  s_add_u32 m0, s91, 20480
  s_nop 0
  buffer_load_dwordx4 v22, s[28:31], s56 offen  lds
  s_add_u32 m0, s91, 23552
  s_nop 0
  buffer_load_dwordx4 v23, s[28:31], s56 offen  lds
  s_add_u32 s56, s56, 131072
  s_add_u32 s91, s91, 24576
  s_cmp_eq_u32 s91, 147456
  s_cselect_b32 s91, 0, s91
  s_mov_b32 s52, 18
p5_l2_0:
  s_waitcnt vmcnt(32)
  s_barrier
  s_add_u32 m0, s90, 2048
  s_nop 0
  buffer_load_dwordx4 v16, s[24:27], s55 offen sc1 lds
  s_add_u32 m0, s90, 5120
  s_nop 0
  buffer_load_dwordx4 v17, s[24:27], s55 offen sc1 lds
  s_add_u32 m0, s90, 8192
  s_nop 0
  buffer_load_dwordx4 v18, s[24:27], s55 offen sc1 lds
  s_add_u32 m0, s90, 11264
  s_nop 0
  buffer_load_dwordx4 v19, s[24:27], s55 offen sc1 lds
  s_add_u32 m0, s90, 14336
  s_nop 0
  buffer_load_dwordx4 v20, s[24:27], s55 offen sc1 lds
  s_add_u32 s55, s55, 16384
  s_add_u32 s90, s90, 24576
  s_cmp_eq_u32 s90, 147456
  s_cselect_b32 s90, 0, s90
  s_add_u32 m0, s91, 17408
  s_nop 0
  buffer_load_dwordx4 v21, s[28:31], s56 offen  lds
  s_add_u32 m0, s91, 20480
  s_nop 0
  buffer_load_dwordx4 v22, s[28:31], s56 offen  lds
  s_add_u32 m0, s91, 23552
  s_nop 0
  buffer_load_dwordx4 v23, s[28:31], s56 offen  lds
  s_add_u32 s56, s56, 131072
  s_add_u32 s91, s91, 24576
  s_cmp_eq_u32 s91, 147456
  s_cselect_b32 s91, 0, s91
  s_sub_u32 s52, s52, 1
  s_cmp_lg_u32 s52, 0
  s_cbranch_scc1 p5_l2_0
  s_waitcnt vmcnt(32)
  s_barrier
  s_waitcnt vmcnt(24)
  s_barrier
  s_waitcnt vmcnt(16)
  s_barrier
  s_waitcnt vmcnt(8)
  s_barrier
  s_waitcnt vmcnt(0)
  s_barrier
  s_barrier
  s_barrier
  s_endpgm
mk_common:
  s_cmp_lg_u32 s46, 7
  s_cbranch_scc1 mk_common2
  s_mov_b32 s98, mk_code_end-sequential_preLN__sliding_local_dilated__mixer_gmlp__prompt_kernel-8
  s_mov_b32 s99, 0x20000
  s_lshr_b32 s47, s2, 3
  s_mul_i32 s47, s47, 3072
  v_min_u32 v60, 23, v0
  v_lshlrev_b32 v60, 7, v60
  buffer_load_dword v61, v60, s[96:99], s47 offen
mk_common2:
  s_waitcnt lgkmcnt(0)
  s_mov_b32 s6, s72
  s_mov_b32 s7, s73
  s_mov_b32 s8, s74
  s_mov_b32 s9, s75
  s_add_u32 s26, s4, 0x2640000
  s_addc_u32 s27, s5, 0
  s_load_dword s22, s[26:27], 0
  s_add_u32 s64, s4, 0x2600000
  s_addc_u32 s65, s5, 0x0
  s_mov_b32 s66, 0x20000
  s_mov_b32 s67, 0x20000
  s_cmp_ge_u32 s46, 4
  s_cbranch_scc1 mk_loaders
  s_mov_b32 s44, s57
  s_mov_b32 s45, s58
  s_mov_b32 s32, s6
  s_mov_b32 s33, s7
  s_mov_b32 s34, 0x400000
  s_mov_b32 s35, 0x20000
  s_add_u32 s36, s4, 0x2580000
  s_addc_u32 s37, s5, 0x0
  s_mov_b32 s38, 0x9000
  s_mov_b32 s39, 0x20000
  s_mul_i32 s47, s45, 9
  s_add_u32 s48, s47, s46
  s_add_u32 s49, s48, 4
  s_add_u32 s50, s46, 8
  s_min_u32 s50, s50, 8
  s_add_u32 s50, s50, s47
  v_lshlrev_b32 v4, 4, v0
  s_lshl_b32 s63, s44, 7
  s_add_u32 s63, s63, s48
  s_sub_i32 s63, s63, 16
  s_max_i32 s63, s63, 0
  s_lshl_b32 s63, s63, 11
  buffer_load_dwordx4 v[116:119], v4, s[32:35], s63 offen
  buffer_load_dwordx4 v[120:123], v4, s[32:35], s63 offen offset:1024
  s_lshl_b32 s63, s44, 7
  s_add_u32 s63, s63, s49
  s_sub_i32 s63, s63, 16
  s_max_i32 s63, s63, 0
  s_lshl_b32 s63, s63, 11
  buffer_load_dwordx4 v[124:127], v4, s[32:35], s63 offen
  buffer_load_dwordx4 v[128:131], v4, s[32:35], s63 offen offset:1024
  s_lshl_b32 s63, s44, 7
  s_add_u32 s63, s63, s50
  s_sub_i32 s63, s63, 16
  s_max_i32 s63, s63, 0
  s_lshl_b32 s63, s63, 11
  buffer_load_dwordx4 v[132:135], v4, s[32:35], s63 offen
  buffer_load_dwordx4 v[136:139], v4, s[32:35], s63 offen offset:1024
  s_lshl_b32 s63, s2, 2
  s_add_u32 s63, s63, s46
  v_mov_b32 v217, 0x3f803f80
  v_mov_b32 v218, 0x3f803f80
  v_mov_b32 v219, 0x3f803f80
  v_mov_b32 v216, 0x3f803f80
  v_and_b32 v5, 7, v0
  v_lshlrev_b32 v5, 4, v5
  v_add_u32 v6, 0, v5
  ds_write_b128 v6, v[216:219]
  v_add_u32 v6, 43008, v5
  ds_write_b128 v6, v[216:219]
  v_add_u32 v6, 86016, v5
  ds_write_b128 v6, v[216:219]
  v_and_b32 v4, 15, v0
  v_lshlrev_b32 v1, 7, v4
  v_lshrrev_b32 v4, 4, v0
  v_and_b32 v2, 6, v0
  v_xor_b32 v4, v4, v2
  v_lshlrev_b32 v4, 4, v4
  v_add_u32 v1, v1, v4
  v_xor_b32 v2, 64, v1
  v_lshrrev_b32 v4, 4, v0
  v_lshlrev_b32 v5, 10, v4
  v_and_b32 v6, 1, v4
  v_lshlrev_b32 v6, 2, v6
  v_bfe_u32 v4, v0, 2, 2
  v_lshl_add_u32 v5, v4, 7, v5
  v_and_b32 v4, 2, v4
  v_or_b32 v6, v6, v4
  v_bfe_u32 v4, v0, 1, 1
  v_xor_b32 v6, v6, v4
  v_and_b32 v4, 1, v0
  v_lshl_add_u32 v5, v4, 3, v5
  s_lshl_b32 s63, s46, 1
  v_xor_b32 v4, s63, v6
  v_lshl_add_u32 v3, v4, 4, v5
  v_add_u32 v3, 18432, v3
  v_mov_b32 v8, 0
  v_mov_b32 v9, 0
  v_mov_b32 v10, 0
  v_mov_b32 v11, 0
  v_mov_b32 v12, 0
  v_mov_b32 v13, 0
  v_mov_b32 v14, 0
  v_mov_b32 v15, 0
  v_mov_b32 v16, 0
  v_mov_b32 v17, 0
  v_mov_b32 v18, 0
  v_mov_b32 v19, 0
  v_mov_b32 v20, 0
  v_mov_b32 v21, 0
  v_mov_b32 v22, 0
  v_mov_b32 v23, 0
  v_mov_b32 v24, 0
  v_mov_b32 v25, 0
  v_mov_b32 v26, 0
  v_mov_b32 v27, 0
  v_mov_b32 v28, 0
  v_mov_b32 v29, 0
  v_mov_b32 v30, 0
  v_mov_b32 v31, 0
  v_mov_b32 v32, 0
  v_mov_b32 v33, 0
  v_mov_b32 v34, 0
  v_mov_b32 v35, 0
  v_mov_b32 v36, 0
  v_mov_b32 v37, 0
  v_mov_b32 v38, 0
  v_mov_b32 v39, 0
  v_mov_b32 v40, 0
  v_mov_b32 v41, 0
  v_mov_b32 v42, 0
  v_mov_b32 v43, 0
  v_mov_b32 v44, 0
  v_mov_b32 v45, 0
  v_mov_b32 v46, 0
  v_mov_b32 v47, 0
  v_mov_b32 v48, 0
  v_mov_b32 v49, 0
  v_mov_b32 v50, 0
  v_mov_b32 v51, 0
  v_mov_b32 v52, 0
  v_mov_b32 v53, 0
  v_mov_b32 v54, 0
  v_mov_b32 v55, 0
  v_mov_b32 v56, 0
  v_mov_b32 v57, 0
  v_mov_b32 v58, 0
  v_mov_b32 v59, 0
  v_mov_b32 v60, 0
  v_mov_b32 v61, 0
  v_mov_b32 v62, 0
  v_mov_b32 v63, 0
  v_mov_b32 v64, 0
  v_mov_b32 v65, 0
  v_mov_b32 v66, 0
  v_mov_b32 v67, 0
  v_mov_b32 v68, 0
  v_mov_b32 v69, 0
  v_mov_b32 v70, 0
  v_mov_b32 v71, 0
  v_mov_b32 v72, 0
  v_mov_b32 v73, 0
  v_mov_b32 v74, 0
  v_mov_b32 v75, 0
  v_mov_b32 v76, 0
  v_mov_b32 v77, 0
  v_mov_b32 v78, 0
  v_mov_b32 v79, 0
  v_mov_b32 v80, 0
  v_mov_b32 v81, 0
  v_mov_b32 v82, 0
  v_mov_b32 v83, 0
  v_mov_b32 v84, 0
  v_mov_b32 v85, 0
  v_mov_b32 v86, 0
  v_mov_b32 v87, 0
  v_mov_b32 v88, 0
  v_mov_b32 v89, 0
  v_mov_b32 v90, 0
  v_mov_b32 v91, 0
  v_mov_b32 v92, 0
  v_mov_b32 v93, 0
  v_mov_b32 v94, 0
  v_mov_b32 v95, 0
  v_mov_b32 v96, 0
  v_mov_b32 v97, 0
  v_mov_b32 v98, 0
  v_mov_b32 v99, 0
  v_mov_b32 v100, 0
  v_mov_b32 v101, 0
  v_mov_b32 v102, 0
  v_mov_b32 v103, 0
  v_mov_b32 v104, 0
  v_mov_b32 v105, 0
  v_mov_b32 v106, 0
  v_mov_b32 v107, 0
  v_mov_b32 v108, 0
  v_mov_b32 v109, 0
  v_mov_b32 v110, 0
  v_mov_b32 v111, 0
  v_mov_b32 v112, 0
  v_mov_b32 v113, 0
  v_mov_b32 v114, 0
  v_mov_b32 v115, 0
  s_waitcnt vmcnt(0) lgkmcnt(0)
  s_add_u32 s22, s22, 1
  s_mov_b32 s47, 0x3f803f80
  v_mov_b32 v140, 0
  v_mov_b32 v142, 0
  v_mov_b32 v144, 0
  v_mov_b32 v146, 0
  v_mov_b32 v148, 0
  v_mov_b32 v150, 0
  v_dot2_f32_bf16 v140, v116, s47, v140
  v_dot2_f32_bf16 v142, v116, v116, v142
  v_dot2_f32_bf16 v144, v124, s47, v144
  v_dot2_f32_bf16 v146, v124, v124, v146
  v_dot2_f32_bf16 v148, v132, s47, v148
  v_dot2_f32_bf16 v150, v132, v132, v150
  v_dot2_f32_bf16 v140, v117, s47, v140
  v_dot2_f32_bf16 v142, v117, v117, v142
  v_dot2_f32_bf16 v144, v125, s47, v144
  v_dot2_f32_bf16 v146, v125, v125, v146
  v_dot2_f32_bf16 v148, v133, s47, v148
  v_dot2_f32_bf16 v150, v133, v133, v150
  v_dot2_f32_bf16 v140, v118, s47, v140
  v_dot2_f32_bf16 v142, v118, v118, v142
  v_dot2_f32_bf16 v144, v126, s47, v144
  v_dot2_f32_bf16 v146, v126, v126, v146
  v_dot2_f32_bf16 v148, v134, s47, v148
  v_dot2_f32_bf16 v150, v134, v134, v150
  v_dot2_f32_bf16 v140, v119, s47, v140
  v_dot2_f32_bf16 v142, v119, v119, v142
  v_dot2_f32_bf16 v144, v127, s47, v144
  v_dot2_f32_bf16 v146, v127, v127, v146
  v_dot2_f32_bf16 v148, v135, s47, v148
  v_dot2_f32_bf16 v150, v135, v135, v150
  v_dot2_f32_bf16 v140, v120, s47, v140
  v_dot2_f32_bf16 v142, v120, v120, v142
  v_dot2_f32_bf16 v144, v128, s47, v144
  v_dot2_f32_bf16 v146, v128, v128, v146
  v_dot2_f32_bf16 v148, v136, s47, v148
  v_dot2_f32_bf16 v150, v136, v136, v150
  v_dot2_f32_bf16 v140, v121, s47, v140
  v_dot2_f32_bf16 v142, v121, v121, v142
  v_dot2_f32_bf16 v144, v129, s47, v144
  v_dot2_f32_bf16 v146, v129, v129, v146
  v_dot2_f32_bf16 v148, v137, s47, v148
  v_dot2_f32_bf16 v150, v137, v137, v150
  v_dot2_f32_bf16 v140, v122, s47, v140
  v_dot2_f32_bf16 v142, v122, v122, v142
  v_dot2_f32_bf16 v144, v130, s47, v144
  v_dot2_f32_bf16 v146, v130, v130, v146
  v_dot2_f32_bf16 v148, v138, s47, v148
  v_dot2_f32_bf16 v150, v138, v138, v150
  v_dot2_f32_bf16 v140, v123, s47, v140
  v_dot2_f32_bf16 v142, v123, v123, v142
  v_dot2_f32_bf16 v144, v131, s47, v144
  v_dot2_f32_bf16 v146, v131, v131, v146
  v_dot2_f32_bf16 v148, v139, s47, v148
  v_dot2_f32_bf16 v150, v139, v139, v150
  v_add_f32_dpp v140, v140, v140 row_ror:8 row_mask:0xf bank_mask:0xf
  v_add_f32_dpp v142, v142, v142 row_ror:8 row_mask:0xf bank_mask:0xf
  v_add_f32_dpp v144, v144, v144 row_ror:8 row_mask:0xf bank_mask:0xf
  v_add_f32_dpp v146, v146, v146 row_ror:8 row_mask:0xf bank_mask:0xf
  v_add_f32_dpp v148, v148, v148 row_ror:8 row_mask:0xf bank_mask:0xf
  v_add_f32_dpp v150, v150, v150 row_ror:8 row_mask:0xf bank_mask:0xf
  v_add_f32_dpp v140, v140, v140 row_ror:4 row_mask:0xf bank_mask:0xf
  v_add_f32_dpp v142, v142, v142 row_ror:4 row_mask:0xf bank_mask:0xf
  v_add_f32_dpp v144, v144, v144 row_ror:4 row_mask:0xf bank_mask:0xf
  v_add_f32_dpp v146, v146, v146 row_ror:4 row_mask:0xf bank_mask:0xf
  v_add_f32_dpp v148, v148, v148 row_ror:4 row_mask:0xf bank_mask:0xf
  v_add_f32_dpp v150, v150, v150 row_ror:4 row_mask:0xf bank_mask:0xf
  v_add_f32_dpp v140, v140, v140 row_ror:2 row_mask:0xf bank_mask:0xf
  v_add_f32_dpp v142, v142, v142 row_ror:2 row_mask:0xf bank_mask:0xf
  v_add_f32_dpp v144, v144, v144 row_ror:2 row_mask:0xf bank_mask:0xf
  v_add_f32_dpp v146, v146, v146 row_ror:2 row_mask:0xf bank_mask:0xf
  v_add_f32_dpp v148, v148, v148 row_ror:2 row_mask:0xf bank_mask:0xf
  v_add_f32_dpp v150, v150, v150 row_ror:2 row_mask:0xf bank_mask:0xf
  v_add_f32_dpp v140, v140, v140 row_ror:1 row_mask:0xf bank_mask:0xf
  v_add_f32_dpp v142, v142, v142 row_ror:1 row_mask:0xf bank_mask:0xf
  v_add_f32_dpp v144, v144, v144 row_ror:1 row_mask:0xf bank_mask:0xf
  v_add_f32_dpp v146, v146, v146 row_ror:1 row_mask:0xf bank_mask:0xf
  v_add_f32_dpp v148, v148, v148 row_ror:1 row_mask:0xf bank_mask:0xf
  v_add_f32_dpp v150, v150, v150 row_ror:1 row_mask:0xf bank_mask:0xf
  v_mov_b32 v152, v140
  v_mov_b32 v153, v142
  v_mov_b32 v154, v144
  v_mov_b32 v155, v146
  v_mov_b32 v156, v148
  v_mov_b32 v157, v150
  v_permlane16_swap_b32 v140, v152
  v_permlane16_swap_b32 v142, v153
  v_permlane16_swap_b32 v144, v154
  v_permlane16_swap_b32 v146, v155
  v_permlane16_swap_b32 v148, v156
  v_permlane16_swap_b32 v150, v157
  v_add_f32 v140, v140, v152
  v_add_f32 v142, v142, v153
  v_add_f32 v144, v144, v154
  v_add_f32 v146, v146, v155
  v_add_f32 v148, v148, v156
  v_add_f32 v150, v150, v157
  v_mov_b32 v152, v140
  v_mov_b32 v153, v142
  v_mov_b32 v154, v144
  v_mov_b32 v155, v146
  v_mov_b32 v156, v148
  v_mov_b32 v157, v150
  v_permlane32_swap_b32 v140, v152
  v_permlane32_swap_b32 v142, v153
  v_permlane32_swap_b32 v144, v154
  v_permlane32_swap_b32 v146, v155
  v_permlane32_swap_b32 v148, v156
  v_permlane32_swap_b32 v150, v157
  v_add_f32 v140, v140, v152
  v_add_f32 v142, v142, v153
  v_add_f32 v144, v144, v154
  v_add_f32 v146, v146, v155
  v_add_f32 v148, v148, v156
  v_add_f32 v150, v150, v157
  v_mul_f32 v140, 0x3a800000, v140
  v_mul_f32 v142, 0x3a800000, v142
  v_fma_f32 v142, -v140, v140, v142
  v_max_f32 v142, 0, v142
  v_add_f32 v142, 0x3727c5ac, v142
  v_rsq_f32 v142, v142
  v_mov_b32 v141, s22
  v_mov_b32 v143, s22
  v_mul_f32 v144, 0x3a800000, v144
  v_mul_f32 v146, 0x3a800000, v146
  v_fma_f32 v146, -v144, v144, v146
  v_max_f32 v146, 0, v146
  v_add_f32 v146, 0x3727c5ac, v146
  v_rsq_f32 v146, v146
  v_mov_b32 v145, s22
  v_mov_b32 v147, s22
  v_mul_f32 v148, 0x3a800000, v148
  v_mul_f32 v150, 0x3a800000, v150
  v_fma_f32 v150, -v148, v148, v150
  v_max_f32 v150, 0, v150
  v_add_f32 v150, 0x3727c5ac, v150
  v_rsq_f32 v150, v150
  v_mov_b32 v149, s22
  v_mov_b32 v151, s22
  v_mov_b32 v4, 0
  s_mov_b64 exec, 1
  s_mul_i32 s63, s44, 144
  s_add_u32 s63, s63, s48
  s_lshl_b32 s63, s63, 4
  buffer_store_dwordx4 v[140:143], v4, s[36:39], s63 offen sc1
  s_mul_i32 s63, s44, 144
  s_add_u32 s63, s63, s49
  s_lshl_b32 s63, s63, 4
  buffer_store_dwordx4 v[144:147], v4, s[36:39], s63 offen sc1
  s_mul_i32 s63, s44, 144
  s_add_u32 s63, s63, s50
  s_lshl_b32 s63, s63, 4
  buffer_store_dwordx4 v[148:151], v4, s[36:39], s63 offen sc1
  s_mov_b64 exec, -1
  s_mov_b32 s53, 0
  s_mov_b32 s52, 16
  s_waitcnt lgkmcnt(0)
  s_barrier
  ds_read_b64_tr_b16 v[152:153], v3 offset:0
  ds_read_b64_tr_b16 v[154:155], v3 offset:512
  ds_read_b128 v[116:119], v1 offset:0
  ds_read_b128 v[120:123], v1 offset:2048
  ds_read_b128 v[124:127], v1 offset:4096
  ds_read_b128 v[128:131], v1 offset:6144
  ds_read_b128 v[132:135], v1 offset:8192
  ds_read_b128 v[136:139], v1 offset:10240
  ds_read_b128 v[140:143], v1 offset:12288
  ds_read_b128 v[144:147], v1 offset:14336
  ds_read_b128 v[148:151], v1 offset:16384
  ds_read_b64_tr_b16 v[156:157], v3 offset:8192
  ds_read_b64_tr_b16 v[158:159], v3 offset:8704
  ds_read_b64_tr_b16 v[160:161], v3 offset:16384
  ds_read_b64_tr_b16 v[162:163], v3 offset:16896
p1_loop:
  s_waitcnt lgkmcnt(0)
  v_mfma_f32_16x16x32_bf16 v[8:11], v[152:155], v[116:119], v[8:11]
  s_add_u32 s53, s53, 43008
  ds_read_b64_tr_b16 v[200:201], v3 offset:4096
  v_mfma_f32_16x16x32_bf16 v[12:15], v[152:155], v[120:123], v[12:15]
  s_cmp_eq_u32 s53, 129024
  ds_read_b64_tr_b16 v[202:203], v3 offset:4608
  v_mfma_f32_16x16x32_bf16 v[16:19], v[152:155], v[124:127], v[16:19]
  s_cselect_b32 s54, 129024, 0
  ds_read_b128 v[164:167], v2 offset:0
  v_mfma_f32_16x16x32_bf16 v[20:23], v[152:155], v[128:131], v[20:23]
  s_cselect_b32 s53, 0, s53
  ds_read_b128 v[168:171], v2 offset:2048
  v_mfma_f32_16x16x32_bf16 v[24:27], v[152:155], v[132:135], v[24:27]
  s_sub_u32 s54, 43008, s54
  ds_read_b128 v[172:175], v2 offset:4096
  v_mfma_f32_16x16x32_bf16 v[28:31], v[152:155], v[136:139], v[28:31]
  s_sub_u32 s52, s52, 1
  ds_read_b128 v[176:179], v2 offset:6144
  v_mfma_f32_16x16x32_bf16 v[32:35], v[152:155], v[140:143], v[32:35]
  ds_read_b128 v[180:183], v2 offset:8192
  v_mfma_f32_16x16x32_bf16 v[36:39], v[152:155], v[144:147], v[36:39]
  ds_read_b128 v[184:187], v2 offset:10240
  v_mfma_f32_16x16x32_bf16 v[40:43], v[152:155], v[148:151], v[40:43]
  ds_read_b128 v[188:191], v2 offset:12288
  v_mfma_f32_16x16x32_bf16 v[44:47], v[156:159], v[116:119], v[44:47]
  ds_read_b128 v[192:195], v2 offset:14336
  v_mfma_f32_16x16x32_bf16 v[48:51], v[156:159], v[120:123], v[48:51]
  ds_read_b128 v[196:199], v2 offset:16384
  v_mfma_f32_16x16x32_bf16 v[52:55], v[156:159], v[124:127], v[52:55]
  ds_read_b64_tr_b16 v[204:205], v3 offset:12288
  v_mfma_f32_16x16x32_bf16 v[56:59], v[156:159], v[128:131], v[56:59]
  ds_read_b64_tr_b16 v[206:207], v3 offset:12800
  v_mfma_f32_16x16x32_bf16 v[60:63], v[156:159], v[132:135], v[60:63]
  ds_read_b64_tr_b16 v[208:209], v3 offset:20480
  v_mfma_f32_16x16x32_bf16 v[64:67], v[156:159], v[136:139], v[64:67]
  ds_read_b64_tr_b16 v[210:211], v3 offset:20992
  v_mfma_f32_16x16x32_bf16 v[68:71], v[156:159], v[140:143], v[68:71]
  v_mfma_f32_16x16x32_bf16 v[72:75], v[156:159], v[144:147], v[72:75]
  v_mfma_f32_16x16x32_bf16 v[76:79], v[156:159], v[148:151], v[76:79]
  v_mfma_f32_16x16x32_bf16 v[80:83], v[160:163], v[116:119], v[80:83]
  v_mfma_f32_16x16x32_bf16 v[84:87], v[160:163], v[120:123], v[84:87]
  v_mfma_f32_16x16x32_bf16 v[88:91], v[160:163], v[124:127], v[88:91]
  v_mfma_f32_16x16x32_bf16 v[92:95], v[160:163], v[128:131], v[92:95]
  v_mfma_f32_16x16x32_bf16 v[96:99], v[160:163], v[132:135], v[96:99]
  v_mfma_f32_16x16x32_bf16 v[100:103], v[160:163], v[136:139], v[100:103]
  v_mfma_f32_16x16x32_bf16 v[104:107], v[160:163], v[140:143], v[104:107]
  v_mfma_f32_16x16x32_bf16 v[108:111], v[160:163], v[144:147], v[108:111]
  v_mfma_f32_16x16x32_bf16 v[112:115], v[160:163], v[148:151], v[112:115]
  s_waitcnt lgkmcnt(0)
  s_barrier
  v_mfma_f32_16x16x32_bf16 v[8:11], v[200:203], v[164:167], v[8:11]
  v_add_u32 v3, s54, v3
  v_mfma_f32_16x16x32_bf16 v[12:15], v[200:203], v[168:171], v[12:15]
  v_add_u32 v1, s54, v1
  ds_read_b64_tr_b16 v[152:153], v3 offset:0
  v_mfma_f32_16x16x32_bf16 v[16:19], v[200:203], v[172:175], v[16:19]
  v_add_u32 v2, s54, v2
  ds_read_b64_tr_b16 v[154:155], v3 offset:512
  v_mfma_f32_16x16x32_bf16 v[20:23], v[200:203], v[176:179], v[20:23]
  s_cmp_lg_u32 s52, 0
  ds_read_b128 v[116:119], v1 offset:0
  v_mfma_f32_16x16x32_bf16 v[24:27], v[200:203], v[180:183], v[24:27]
  ds_read_b128 v[120:123], v1 offset:2048
  v_mfma_f32_16x16x32_bf16 v[28:31], v[200:203], v[184:187], v[28:31]
  ds_read_b128 v[124:127], v1 offset:4096
  v_mfma_f32_16x16x32_bf16 v[32:35], v[200:203], v[188:191], v[32:35]
  ds_read_b128 v[128:131], v1 offset:6144
  v_mfma_f32_16x16x32_bf16 v[36:39], v[200:203], v[192:195], v[36:39]
  ds_read_b128 v[132:135], v1 offset:8192
  v_mfma_f32_16x16x32_bf16 v[40:43], v[200:203], v[196:199], v[40:43]
  ds_read_b128 v[136:139], v1 offset:10240
  v_mfma_f32_16x16x32_bf16 v[44:47], v[204:207], v[164:167], v[44:47]
  ds_read_b128 v[140:143], v1 offset:12288
  v_mfma_f32_16x16x32_bf16 v[48:51], v[204:207], v[168:171], v[48:51]
  ds_read_b128 v[144:147], v1 offset:14336
  v_mfma_f32_16x16x32_bf16 v[52:55], v[204:207], v[172:175], v[52:55]
  ds_read_b128 v[148:151], v1 offset:16384
  v_mfma_f32_16x16x32_bf16 v[56:59], v[204:207], v[176:179], v[56:59]
  ds_read_b64_tr_b16 v[156:157], v3 offset:8192
  v_mfma_f32_16x16x32_bf16 v[60:63], v[204:207], v[180:183], v[60:63]
  ds_read_b64_tr_b16 v[158:159], v3 offset:8704
  v_mfma_f32_16x16x32_bf16 v[64:67], v[204:207], v[184:187], v[64:67]
  ds_read_b64_tr_b16 v[160:161], v3 offset:16384
  v_mfma_f32_16x16x32_bf16 v[68:71], v[204:207], v[188:191], v[68:71]
  ds_read_b64_tr_b16 v[162:163], v3 offset:16896
  v_mfma_f32_16x16x32_bf16 v[72:75], v[204:207], v[192:195], v[72:75]
  v_mfma_f32_16x16x32_bf16 v[76:79], v[204:207], v[196:199], v[76:79]
  v_mfma_f32_16x16x32_bf16 v[80:83], v[208:211], v[164:167], v[80:83]
  v_mfma_f32_16x16x32_bf16 v[84:87], v[208:211], v[168:171], v[84:87]
  v_mfma_f32_16x16x32_bf16 v[88:91], v[208:211], v[172:175], v[88:91]
  v_mfma_f32_16x16x32_bf16 v[92:95], v[208:211], v[176:179], v[92:95]
  v_mfma_f32_16x16x32_bf16 v[96:99], v[208:211], v[180:183], v[96:99]
  v_mfma_f32_16x16x32_bf16 v[100:103], v[208:211], v[184:187], v[100:103]
  v_mfma_f32_16x16x32_bf16 v[104:107], v[208:211], v[188:191], v[104:107]
  v_mfma_f32_16x16x32_bf16 v[108:111], v[208:211], v[192:195], v[108:111]
  v_mfma_f32_16x16x32_bf16 v[112:115], v[208:211], v[196:199], v[112:115]
  s_cbranch_scc1 p1_loop
  s_waitcnt lgkmcnt(0)
  s_nop 7
  s_barrier
  v_and_b32 v4, 15, v0
  v_lshlrev_b32 v5, 3, v4
  v_add_u32 v5, 153600, v5
  ds_read_b64 v[116:117], v5 offset:0
  ds_read_b64 v[118:119], v5 offset:128
  ds_read_b64 v[120:121], v5 offset:256
  ds_read_b64 v[122:123], v5 offset:384
  ds_read_b64 v[124:125], v5 offset:512
  ds_read_b64 v[126:127], v5 offset:640
  ds_read_b64 v[128:129], v5 offset:768
  ds_read_b64 v[130:131], v5 offset:896
  ds_read_b64 v[132:133], v5 offset:1024
  v_mov_b32_dpp v136, v8 row_newbcast:0 row_mask:0xf bank_mask:0xf
  v_mov_b32_dpp v137, v9 row_newbcast:0 row_mask:0xf bank_mask:0xf
  v_mov_b32_dpp v138, v10 row_newbcast:0 row_mask:0xf bank_mask:0xf
  v_mov_b32_dpp v139, v11 row_newbcast:0 row_mask:0xf bank_mask:0xf
  v_mov_b32_dpp v140, v44 row_newbcast:0 row_mask:0xf bank_mask:0xf
  v_mov_b32_dpp v141, v45 row_newbcast:0 row_mask:0xf bank_mask:0xf
  v_mov_b32_dpp v142, v46 row_newbcast:0 row_mask:0xf bank_mask:0xf
  v_mov_b32_dpp v143, v47 row_newbcast:0 row_mask:0xf bank_mask:0xf
  v_mov_b32_dpp v144, v80 row_newbcast:0 row_mask:0xf bank_mask:0xf
  v_mov_b32_dpp v145, v81 row_newbcast:0 row_mask:0xf bank_mask:0xf
  v_mov_b32_dpp v146, v82 row_newbcast:0 row_mask:0xf bank_mask:0xf
  v_mov_b32_dpp v147, v83 row_newbcast:0 row_mask:0xf bank_mask:0xf
  v_mul_u32_u24 v4, 144, v4
  v_lshrrev_b32 v5, 4, v0
  v_lshl_add_u32 v4, v5, 3, v4
  s_lshl_b32 s63, s46, 5
  s_add_u32 s63, s63, 93696
  v_add_u32 v4, s63, v4
  s_waitcnt lgkmcnt(0)
  v_pk_fma_f32 v[12:13], v[136:137], v[118:119], v[12:13] op_sel_hi:[1,0,1] neg_lo:[0,1,0] neg_hi:[0,1,0]
  v_pk_fma_f32 v[14:15], v[138:139], v[118:119], v[14:15] op_sel_hi:[1,0,1] neg_lo:[0,1,0] neg_hi:[0,1,0]
  v_pk_mul_f32 v[12:13], v[12:13], v[118:119] op_sel:[0,1] op_sel_hi:[1,1]
  v_pk_mul_f32 v[14:15], v[14:15], v[118:119] op_sel:[0,1] op_sel_hi:[1,1]
  v_cvt_pk_bf16_f32 v156, v12, v13
  v_cvt_pk_bf16_f32 v157, v14, v15
  ds_write_b64 v4, v[156:157] offset:0
  v_pk_fma_f32 v[16:17], v[136:137], v[120:121], v[16:17] op_sel_hi:[1,0,1] neg_lo:[0,1,0] neg_hi:[0,1,0]
  v_pk_fma_f32 v[18:19], v[138:139], v[120:121], v[18:19] op_sel_hi:[1,0,1] neg_lo:[0,1,0] neg_hi:[0,1,0]
  v_pk_mul_f32 v[16:17], v[16:17], v[120:121] op_sel:[0,1] op_sel_hi:[1,1]
  v_pk_mul_f32 v[18:19], v[18:19], v[120:121] op_sel:[0,1] op_sel_hi:[1,1]
  v_cvt_pk_bf16_f32 v158, v16, v17
  v_cvt_pk_bf16_f32 v159, v18, v19
  ds_write_b64 v4, v[158:159] offset:2304
  v_pk_fma_f32 v[20:21], v[136:137], v[122:123], v[20:21] op_sel_hi:[1,0,1] neg_lo:[0,1,0] neg_hi:[0,1,0]
  v_pk_fma_f32 v[22:23], v[138:139], v[122:123], v[22:23] op_sel_hi:[1,0,1] neg_lo:[0,1,0] neg_hi:[0,1,0]
  v_pk_mul_f32 v[20:21], v[20:21], v[122:123] op_sel:[0,1] op_sel_hi:[1,1]
  v_pk_mul_f32 v[22:23], v[22:23], v[122:123] op_sel:[0,1] op_sel_hi:[1,1]
  v_cvt_pk_bf16_f32 v160, v20, v21
  v_cvt_pk_bf16_f32 v161, v22, v23
  ds_write_b64 v4, v[160:161] offset:4608
  v_pk_fma_f32 v[24:25], v[136:137], v[124:125], v[24:25] op_sel_hi:[1,0,1] neg_lo:[0,1,0] neg_hi:[0,1,0]
  v_pk_fma_f32 v[26:27], v[138:139], v[124:125], v[26:27] op_sel_hi:[1,0,1] neg_lo:[0,1,0] neg_hi:[0,1,0]
  v_pk_mul_f32 v[24:25], v[24:25], v[124:125] op_sel:[0,1] op_sel_hi:[1,1]
  v_pk_mul_f32 v[26:27], v[26:27], v[124:125] op_sel:[0,1] op_sel_hi:[1,1]
  v_cvt_pk_bf16_f32 v162, v24, v25
  v_cvt_pk_bf16_f32 v163, v26, v27
  ds_write_b64 v4, v[162:163] offset:6912
  v_pk_fma_f32 v[28:29], v[136:137], v[126:127], v[28:29] op_sel_hi:[1,0,1] neg_lo:[0,1,0] neg_hi:[0,1,0]
  v_pk_fma_f32 v[30:31], v[138:139], v[126:127], v[30:31] op_sel_hi:[1,0,1] neg_lo:[0,1,0] neg_hi:[0,1,0]
  v_pk_mul_f32 v[28:29], v[28:29], v[126:127] op_sel:[0,1] op_sel_hi:[1,1]
  v_pk_mul_f32 v[30:31], v[30:31], v[126:127] op_sel:[0,1] op_sel_hi:[1,1]
  v_cvt_pk_bf16_f32 v164, v28, v29
  v_cvt_pk_bf16_f32 v165, v30, v31
  ds_write_b64 v4, v[164:165] offset:9216
  v_pk_fma_f32 v[32:33], v[136:137], v[128:129], v[32:33] op_sel_hi:[1,0,1] neg_lo:[0,1,0] neg_hi:[0,1,0]
  v_pk_fma_f32 v[34:35], v[138:139], v[128:129], v[34:35] op_sel_hi:[1,0,1] neg_lo:[0,1,0] neg_hi:[0,1,0]
  v_pk_mul_f32 v[32:33], v[32:33], v[128:129] op_sel:[0,1] op_sel_hi:[1,1]
  v_pk_mul_f32 v[34:35], v[34:35], v[128:129] op_sel:[0,1] op_sel_hi:[1,1]
  v_cvt_pk_bf16_f32 v166, v32, v33
  v_cvt_pk_bf16_f32 v167, v34, v35
  ds_write_b64 v4, v[166:167] offset:11520
  v_pk_fma_f32 v[36:37], v[136:137], v[130:131], v[36:37] op_sel_hi:[1,0,1] neg_lo:[0,1,0] neg_hi:[0,1,0]
  v_pk_fma_f32 v[38:39], v[138:139], v[130:131], v[38:39] op_sel_hi:[1,0,1] neg_lo:[0,1,0] neg_hi:[0,1,0]
  v_pk_mul_f32 v[36:37], v[36:37], v[130:131] op_sel:[0,1] op_sel_hi:[1,1]
  v_pk_mul_f32 v[38:39], v[38:39], v[130:131] op_sel:[0,1] op_sel_hi:[1,1]
  v_cvt_pk_bf16_f32 v168, v36, v37
  v_cvt_pk_bf16_f32 v169, v38, v39
  ds_write_b64 v4, v[168:169] offset:13824
  v_pk_fma_f32 v[40:41], v[136:137], v[132:133], v[40:41] op_sel_hi:[1,0,1] neg_lo:[0,1,0] neg_hi:[0,1,0]
  v_pk_fma_f32 v[42:43], v[138:139], v[132:133], v[42:43] op_sel_hi:[1,0,1] neg_lo:[0,1,0] neg_hi:[0,1,0]
  v_pk_mul_f32 v[40:41], v[40:41], v[132:133] op_sel:[0,1] op_sel_hi:[1,1]
  v_pk_mul_f32 v[42:43], v[42:43], v[132:133] op_sel:[0,1] op_sel_hi:[1,1]
  v_cvt_pk_bf16_f32 v170, v40, v41
  v_cvt_pk_bf16_f32 v171, v42, v43
  ds_write_b64 v4, v[170:171] offset:16128
  v_pk_fma_f32 v[44:45], v[140:141], v[116:117], v[44:45] op_sel_hi:[1,0,1] neg_lo:[0,1,0] neg_hi:[0,1,0]
  v_pk_fma_f32 v[46:47], v[142:143], v[116:117], v[46:47] op_sel_hi:[1,0,1] neg_lo:[0,1,0] neg_hi:[0,1,0]
  v_pk_mul_f32 v[44:45], v[44:45], v[116:117] op_sel:[0,1] op_sel_hi:[1,1]
  v_pk_mul_f32 v[46:47], v[46:47], v[116:117] op_sel:[0,1] op_sel_hi:[1,1]
  v_cvt_pk_bf16_f32 v156, v44, v45
  v_cvt_pk_bf16_f32 v157, v46, v47
  ds_write_b64 v4, v[156:157] offset:18432
  v_pk_fma_f32 v[48:49], v[140:141], v[118:119], v[48:49] op_sel_hi:[1,0,1] neg_lo:[0,1,0] neg_hi:[0,1,0]
  v_pk_fma_f32 v[50:51], v[142:143], v[118:119], v[50:51] op_sel_hi:[1,0,1] neg_lo:[0,1,0] neg_hi:[0,1,0]
  v_pk_mul_f32 v[48:49], v[48:49], v[118:119] op_sel:[0,1] op_sel_hi:[1,1]
  v_pk_mul_f32 v[50:51], v[50:51], v[118:119] op_sel:[0,1] op_sel_hi:[1,1]
  v_cvt_pk_bf16_f32 v158, v48, v49
  v_cvt_pk_bf16_f32 v159, v50, v51
  ds_write_b64 v4, v[158:159] offset:20736
  v_pk_fma_f32 v[52:53], v[140:141], v[120:121], v[52:53] op_sel_hi:[1,0,1] neg_lo:[0,1,0] neg_hi:[0,1,0]
  v_pk_fma_f32 v[54:55], v[142:143], v[120:121], v[54:55] op_sel_hi:[1,0,1] neg_lo:[0,1,0] neg_hi:[0,1,0]
  v_pk_mul_f32 v[52:53], v[52:53], v[120:121] op_sel:[0,1] op_sel_hi:[1,1]
  v_pk_mul_f32 v[54:55], v[54:55], v[120:121] op_sel:[0,1] op_sel_hi:[1,1]
  v_cvt_pk_bf16_f32 v160, v52, v53
  v_cvt_pk_bf16_f32 v161, v54, v55
  ds_write_b64 v4, v[160:161] offset:23040
  v_pk_fma_f32 v[56:57], v[140:141], v[122:123], v[56:57] op_sel_hi:[1,0,1] neg_lo:[0,1,0] neg_hi:[0,1,0]
  v_pk_fma_f32 v[58:59], v[142:143], v[122:123], v[58:59] op_sel_hi:[1,0,1] neg_lo:[0,1,0] neg_hi:[0,1,0]
  v_pk_mul_f32 v[56:57], v[56:57], v[122:123] op_sel:[0,1] op_sel_hi:[1,1]
  v_pk_mul_f32 v[58:59], v[58:59], v[122:123] op_sel:[0,1] op_sel_hi:[1,1]
  v_cvt_pk_bf16_f32 v162, v56, v57
  v_cvt_pk_bf16_f32 v163, v58, v59
  ds_write_b64 v4, v[162:163] offset:25344
  v_pk_fma_f32 v[60:61], v[140:141], v[124:125], v[60:61] op_sel_hi:[1,0,1] neg_lo:[0,1,0] neg_hi:[0,1,0]
  v_pk_fma_f32 v[62:63], v[142:143], v[124:125], v[62:63] op_sel_hi:[1,0,1] neg_lo:[0,1,0] neg_hi:[0,1,0]
  v_pk_mul_f32 v[60:61], v[60:61], v[124:125] op_sel:[0,1] op_sel_hi:[1,1]
  v_pk_mul_f32 v[62:63], v[62:63], v[124:125] op_sel:[0,1] op_sel_hi:[1,1]
  v_cvt_pk_bf16_f32 v164, v60, v61
  v_cvt_pk_bf16_f32 v165, v62, v63
  ds_write_b64 v4, v[164:165] offset:27648
  v_pk_fma_f32 v[64:65], v[140:141], v[126:127], v[64:65] op_sel_hi:[1,0,1] neg_lo:[0,1,0] neg_hi:[0,1,0]
  v_pk_fma_f32 v[66:67], v[142:143], v[126:127], v[66:67] op_sel_hi:[1,0,1] neg_lo:[0,1,0] neg_hi:[0,1,0]
  v_pk_mul_f32 v[64:65], v[64:65], v[126:127] op_sel:[0,1] op_sel_hi:[1,1]
  v_pk_mul_f32 v[66:67], v[66:67], v[126:127] op_sel:[0,1] op_sel_hi:[1,1]
  v_cvt_pk_bf16_f32 v166, v64, v65
  v_cvt_pk_bf16_f32 v167, v66, v67
  ds_write_b64 v4, v[166:167] offset:29952
  v_pk_fma_f32 v[68:69], v[140:141], v[128:129], v[68:69] op_sel_hi:[1,0,1] neg_lo:[0,1,0] neg_hi:[0,1,0]
  v_pk_fma_f32 v[70:71], v[142:143], v[128:129], v[70:71] op_sel_hi:[1,0,1] neg_lo:[0,1,0] neg_hi:[0,1,0]
  v_pk_mul_f32 v[68:69], v[68:69], v[128:129] op_sel:[0,1] op_sel_hi:[1,1]
  v_pk_mul_f32 v[70:71], v[70:71], v[128:129] op_sel:[0,1] op_sel_hi:[1,1]
  v_cvt_pk_bf16_f32 v168, v68, v69
  v_cvt_pk_bf16_f32 v169, v70, v71
  ds_write_b64 v4, v[168:169] offset:32256
  v_pk_fma_f32 v[72:73], v[140:141], v[130:131], v[72:73] op_sel_hi:[1,0,1] neg_lo:[0,1,0] neg_hi:[0,1,0]
  v_pk_fma_f32 v[74:75], v[142:143], v[130:131], v[74:75] op_sel_hi:[1,0,1] neg_lo:[0,1,0] neg_hi:[0,1,0]
  v_pk_mul_f32 v[72:73], v[72:73], v[130:131] op_sel:[0,1] op_sel_hi:[1,1]
  v_pk_mul_f32 v[74:75], v[74:75], v[130:131] op_sel:[0,1] op_sel_hi:[1,1]
  v_cvt_pk_bf16_f32 v170, v72, v73
  v_cvt_pk_bf16_f32 v171, v74, v75
  ds_write_b64 v4, v[170:171] offset:34560
  v_pk_fma_f32 v[76:77], v[140:141], v[132:133], v[76:77] op_sel_hi:[1,0,1] neg_lo:[0,1,0] neg_hi:[0,1,0]
  v_pk_fma_f32 v[78:79], v[142:143], v[132:133], v[78:79] op_sel_hi:[1,0,1] neg_lo:[0,1,0] neg_hi:[0,1,0]
  v_pk_mul_f32 v[76:77], v[76:77], v[132:133] op_sel:[0,1] op_sel_hi:[1,1]
  v_pk_mul_f32 v[78:79], v[78:79], v[132:133] op_sel:[0,1] op_sel_hi:[1,1]
  v_cvt_pk_bf16_f32 v156, v76, v77
  v_cvt_pk_bf16_f32 v157, v78, v79
  ds_write_b64 v4, v[156:157] offset:36864
  v_pk_fma_f32 v[80:81], v[144:145], v[116:117], v[80:81] op_sel_hi:[1,0,1] neg_lo:[0,1,0] neg_hi:[0,1,0]
  v_pk_fma_f32 v[82:83], v[146:147], v[116:117], v[82:83] op_sel_hi:[1,0,1] neg_lo:[0,1,0] neg_hi:[0,1,0]
  v_pk_mul_f32 v[80:81], v[80:81], v[116:117] op_sel:[0,1] op_sel_hi:[1,1]
  v_pk_mul_f32 v[82:83], v[82:83], v[116:117] op_sel:[0,1] op_sel_hi:[1,1]
  v_cvt_pk_bf16_f32 v158, v80, v81
  v_cvt_pk_bf16_f32 v159, v82, v83
  ds_write_b64 v4, v[158:159] offset:39168
  v_pk_fma_f32 v[84:85], v[144:145], v[118:119], v[84:85] op_sel_hi:[1,0,1] neg_lo:[0,1,0] neg_hi:[0,1,0]
  v_pk_fma_f32 v[86:87], v[146:147], v[118:119], v[86:87] op_sel_hi:[1,0,1] neg_lo:[0,1,0] neg_hi:[0,1,0]
  v_pk_mul_f32 v[84:85], v[84:85], v[118:119] op_sel:[0,1] op_sel_hi:[1,1]
  v_pk_mul_f32 v[86:87], v[86:87], v[118:119] op_sel:[0,1] op_sel_hi:[1,1]
  v_cvt_pk_bf16_f32 v160, v84, v85
  v_cvt_pk_bf16_f32 v161, v86, v87
  ds_write_b64 v4, v[160:161] offset:41472
  v_pk_fma_f32 v[88:89], v[144:145], v[120:121], v[88:89] op_sel_hi:[1,0,1] neg_lo:[0,1,0] neg_hi:[0,1,0]
  v_pk_fma_f32 v[90:91], v[146:147], v[120:121], v[90:91] op_sel_hi:[1,0,1] neg_lo:[0,1,0] neg_hi:[0,1,0]
  v_pk_mul_f32 v[88:89], v[88:89], v[120:121] op_sel:[0,1] op_sel_hi:[1,1]
  v_pk_mul_f32 v[90:91], v[90:91], v[120:121] op_sel:[0,1] op_sel_hi:[1,1]
  v_cvt_pk_bf16_f32 v162, v88, v89
  v_cvt_pk_bf16_f32 v163, v90, v91
  ds_write_b64 v4, v[162:163] offset:43776
  v_pk_fma_f32 v[92:93], v[144:145], v[122:123], v[92:93] op_sel_hi:[1,0,1] neg_lo:[0,1,0] neg_hi:[0,1,0]
  v_pk_fma_f32 v[94:95], v[146:147], v[122:123], v[94:95] op_sel_hi:[1,0,1] neg_lo:[0,1,0] neg_hi:[0,1,0]
  v_pk_mul_f32 v[92:93], v[92:93], v[122:123] op_sel:[0,1] op_sel_hi:[1,1]
  v_pk_mul_f32 v[94:95], v[94:95], v[122:123] op_sel:[0,1] op_sel_hi:[1,1]
  v_cvt_pk_bf16_f32 v164, v92, v93
  v_cvt_pk_bf16_f32 v165, v94, v95
  ds_write_b64 v4, v[164:165] offset:46080
  v_pk_fma_f32 v[96:97], v[144:145], v[124:125], v[96:97] op_sel_hi:[1,0,1] neg_lo:[0,1,0] neg_hi:[0,1,0]
  v_pk_fma_f32 v[98:99], v[146:147], v[124:125], v[98:99] op_sel_hi:[1,0,1] neg_lo:[0,1,0] neg_hi:[0,1,0]
  v_pk_mul_f32 v[96:97], v[96:97], v[124:125] op_sel:[0,1] op_sel_hi:[1,1]
  v_pk_mul_f32 v[98:99], v[98:99], v[124:125] op_sel:[0,1] op_sel_hi:[1,1]
  v_cvt_pk_bf16_f32 v166, v96, v97
  v_cvt_pk_bf16_f32 v167, v98, v99
  ds_write_b64 v4, v[166:167] offset:48384
  v_pk_fma_f32 v[100:101], v[144:145], v[126:127], v[100:101] op_sel_hi:[1,0,1] neg_lo:[0,1,0] neg_hi:[0,1,0]
  v_pk_fma_f32 v[102:103], v[146:147], v[126:127], v[102:103] op_sel_hi:[1,0,1] neg_lo:[0,1,0] neg_hi:[0,1,0]
  v_pk_mul_f32 v[100:101], v[100:101], v[126:127] op_sel:[0,1] op_sel_hi:[1,1]
  v_pk_mul_f32 v[102:103], v[102:103], v[126:127] op_sel:[0,1] op_sel_hi:[1,1]
  v_cvt_pk_bf16_f32 v168, v100, v101
  v_cvt_pk_bf16_f32 v169, v102, v103
  ds_write_b64 v4, v[168:169] offset:50688
  v_pk_fma_f32 v[104:105], v[144:145], v[128:129], v[104:105] op_sel_hi:[1,0,1] neg_lo:[0,1,0] neg_hi:[0,1,0]
  v_pk_fma_f32 v[106:107], v[146:147], v[128:129], v[106:107] op_sel_hi:[1,0,1] neg_lo:[0,1,0] neg_hi:[0,1,0]
  v_pk_mul_f32 v[104:105], v[104:105], v[128:129] op_sel:[0,1] op_sel_hi:[1,1]
  v_pk_mul_f32 v[106:107], v[106:107], v[128:129] op_sel:[0,1] op_sel_hi:[1,1]
  v_cvt_pk_bf16_f32 v170, v104, v105
  v_cvt_pk_bf16_f32 v171, v106, v107
  ds_write_b64 v4, v[170:171] offset:52992
  v_pk_fma_f32 v[108:109], v[144:145], v[130:131], v[108:109] op_sel_hi:[1,0,1] neg_lo:[0,1,0] neg_hi:[0,1,0]
  v_pk_fma_f32 v[110:111], v[146:147], v[130:131], v[110:111] op_sel_hi:[1,0,1] neg_lo:[0,1,0] neg_hi:[0,1,0]
  v_pk_mul_f32 v[108:109], v[108:109], v[130:131] op_sel:[0,1] op_sel_hi:[1,1]
  v_pk_mul_f32 v[110:111], v[110:111], v[130:131] op_sel:[0,1] op_sel_hi:[1,1]
  v_cvt_pk_bf16_f32 v156, v108, v109
  v_cvt_pk_bf16_f32 v157, v110, v111
  ds_write_b64 v4, v[156:157] offset:55296
  v_pk_fma_f32 v[112:113], v[144:145], v[132:133], v[112:113] op_sel_hi:[1,0,1] neg_lo:[0,1,0] neg_hi:[0,1,0]
  v_pk_fma_f32 v[114:115], v[146:147], v[132:133], v[114:115] op_sel_hi:[1,0,1] neg_lo:[0,1,0] neg_hi:[0,1,0]
  v_pk_mul_f32 v[112:113], v[112:113], v[132:133] op_sel:[0,1] op_sel_hi:[1,1]
  v_pk_mul_f32 v[114:115], v[114:115], v[132:133] op_sel:[0,1] op_sel_hi:[1,1]
  v_cvt_pk_bf16_f32 v158, v112, v113
  v_cvt_pk_bf16_f32 v159, v114, v115
  ds_write_b64 v4, v[158:159] offset:57600
  s_waitcnt lgkmcnt(0)
  s_barrier
  s_call_b64 s[84:85], attn_sub
  s_barrier
  s_waitcnt vmcnt(0)
  s_barrier
  s_cmp_lg_u32 s46, 0
  s_cbranch_scc1 Lw_1
  s_lshl_b32 s47, s44, 10
  s_lshl_b32 s48, s45, 6
  s_add_u32 s47, s47, s48
  s_add_u32 s47, s47, 65536
  v_mov_b32 v4, s22
  v_mov_b32 v5, 0
  s_mov_b64 exec, 1
  buffer_store_dword v4, v5, s[64:67], s47 offen sc1
  s_mov_b64 exec, -1
Lw_1:
  s_branch p1_done
attn_sub:
  s_bfe_u32 s61, s46, 0x10001
  s_and_b32 s62, s46, 1
  s_lshr_b32 s63, s46, 2
  v_and_b32 v64, 15, v0
  v_lshrrev_b32 v65, 4, v0
  s_lshl_b32 s47, s61, 6
  s_mul_i32 s48, s62, 144
  s_add_u32 s47, s47, s48
  s_add_u32 s47, s47, 93696
  s_mul_i32 s49, s63, 9216
  s_add_u32 s49, s49, s47
  v_mul_u32_u24 v66, 288, v64
  v_lshl_add_u32 v66, v65, 4, v66
  v_add_u32 v66, s49, v66
  v_lshlrev_b32 v70, 1, v64
  v_subrev_u32 v70, 16, v70
  v_max_i32 v70, 0, v70
  v_mul_u32_u24 v67, 144, v70
  v_lshl_add_u32 v67, v65, 4, v67
  v_add_u32 v67, s47, v67
  v_subrev_u32 v71, 2304, v66
  s_cmp_eq_u32 s63, 0
  s_cselect_b64 s[40:41], -1, 0
  v_cndmask_b32 v67, v71, v67, s[40:41]
  v_bfe_u32 v70, v0, 2, 2
  v_lshl_add_u32 v70, v65, 2, v70
  v_mul_u32_u24 v68, 288, v70
  v_and_b32 v71, 3, v0
  v_lshl_add_u32 v68, v71, 3, v68
  v_add_u32 v68, s49, v68
  v_lshlrev_b32 v70, 1, v70
  v_subrev_u32 v70, 16, v70
  v_max_i32 v70, 0, v70
  v_mul_u32_u24 v69, 144, v70
  v_lshl_add_u32 v69, v71, 3, v69
  v_add_u32 v69, s47, v69
  v_subrev_u32 v71, 2304, v68
  v_cndmask_b32 v69, v71, v69, s[40:41]
  ds_read_b128 v[76:79], v66 offset:0
  ds_read_b128 v[84:87], v67 offset:18432
  ds_read_b128 v[88:91], v66 offset:20736
  ds_read_b128 v[80:83], v66 offset:4608
  ds_read_b128 v[92:95], v66 offset:20736
  ds_read_b128 v[96:99], v66 offset:25344
  ds_read_b64_tr_b16 v[100:101], v69 offset:39168
  ds_read_b64_tr_b16 v[102:103], v68 offset:41472
  ds_read_b64_tr_b16 v[104:105], v69 offset:39200
  ds_read_b64_tr_b16 v[106:107], v68 offset:41504
  ds_read_b64_tr_b16 v[108:109], v68 offset:41472
  ds_read_b64_tr_b16 v[110:111], v68 offset:46080
  ds_read_b64_tr_b16 v[112:113], v68 offset:41504
  ds_read_b64_tr_b16 v[114:115], v68 offset:46112
  v_lshl_add_u32 v71, v65, 2, 0
  v_sub_u32 v72, v64, v71
  v_cmp_gt_u32 s[32:33], 8, v72
  v_add_u32 v72, 9, v64
  v_cmp_ge_u32 s[24:25], v71, v72
  v_lshl_add_u32 v71, v65, 2, 1
  v_sub_u32 v72, v64, v71
  v_cmp_gt_u32 s[34:35], 8, v72
  v_add_u32 v72, 9, v64
  v_cmp_ge_u32 s[26:27], v71, v72
  v_lshl_add_u32 v71, v65, 2, 2
  v_sub_u32 v72, v64, v71
  v_cmp_gt_u32 s[36:37], 8, v72
  v_add_u32 v72, 9, v64
  v_cmp_ge_u32 s[28:29], v71, v72
  v_lshl_add_u32 v71, v65, 2, 3
  v_sub_u32 v72, v64, v71
  v_cmp_gt_u32 s[38:39], 8, v72
  v_add_u32 v72, 9, v64
  v_cmp_ge_u32 s[30:31], v71, v72
  s_add_u32 s48, s44, s63
  s_cmp_eq_u32 s48, 0
  s_cselect_b64 s[40:41], 0, s[24:25]
  s_cselect_b64 s[42:43], 0, s[26:27]
  s_cselect_b64 s[68:69], 0, s[28:29]
  s_cselect_b64 s[98:99], 0, s[30:31]
  s_waitcnt lgkmcnt(0)
  s_barrier
  v_mfma_f32_16x16x32_bf16 v[116:119], v[84:87], v[76:79], 0
  v_mfma_f32_16x16x32_bf16 v[120:123], v[88:91], v[76:79], 0
  v_mfma_f32_16x16x32_bf16 v[124:127], v[92:95], v[80:83], 0
  v_mfma_f32_16x16x32_bf16 v[128:131], v[96:99], v[80:83], 0
  s_mov_b32 s51, 0x3e8293ee
  v_mov_b32 v70, 0xf149f2ca
  s_nop 2
  v_cndmask_b32 v116, v70, v116, s[40:41]
  s_nop 0
  v_cndmask_b32 v124, v70, v124, s[24:25]
  v_cndmask_b32 v120, v70, v120, s[32:33]
  v_cndmask_b32 v128, v70, v128, s[32:33]
  v_cndmask_b32 v117, v70, v117, s[42:43]
  v_cndmask_b32 v125, v70, v125, s[26:27]
  v_cndmask_b32 v121, v70, v121, s[34:35]
  v_cndmask_b32 v129, v70, v129, s[34:35]
  v_cndmask_b32 v118, v70, v118, s[68:69]
  v_cndmask_b32 v126, v70, v126, s[28:29]
  v_cndmask_b32 v122, v70, v122, s[36:37]
  v_cndmask_b32 v130, v70, v130, s[36:37]
  v_cndmask_b32 v119, v70, v119, s[98:99]
  v_cndmask_b32 v127, v70, v127, s[30:31]
  v_cndmask_b32 v123, v70, v123, s[38:39]
  v_cndmask_b32 v131, v70, v131, s[38:39]
  v_max3_f32 v156, v116, v117, v118
  v_max3_f32 v160, v124, v125, v126
  v_max3_f32 v157, v119, v120, v121
  v_max3_f32 v161, v127, v128, v129
  v_max3_f32 v156, v156, v122, v123
  v_max3_f32 v160, v160, v130, v131
  v_max_f32 v156, v156, v157
  v_max_f32 v160, v160, v161
  v_mov_b32 v157, v156
  v_mov_b32 v161, v160
  s_nop 0
  v_permlane32_swap_b32 v156, v157
  v_permlane32_swap_b32 v160, v161
  v_max_f32 v156, v156, v157
  v_max_f32 v160, v160, v161
  v_mov_b32 v157, v156
  v_mov_b32 v161, v160
  s_nop 0
  v_permlane16_swap_b32 v156, v157
  v_permlane16_swap_b32 v160, v161
  v_max_f32 v156, v156, v157
  v_max_f32 v160, v160, v161
  v_mul_f32 v156, s51, v156
  v_mul_f32 v160, s51, v160
  v_fma_f32 v116, v116, s51, -v156
  v_fma_f32 v124, v124, s51, -v160
  v_fma_f32 v117, v117, s51, -v156
  v_fma_f32 v125, v125, s51, -v160
  v_fma_f32 v118, v118, s51, -v156
  v_fma_f32 v126, v126, s51, -v160
  v_fma_f32 v119, v119, s51, -v156
  v_fma_f32 v127, v127, s51, -v160
  v_fma_f32 v120, v120, s51, -v156
  v_fma_f32 v128, v128, s51, -v160
  v_fma_f32 v121, v121, s51, -v156
  v_fma_f32 v129, v129, s51, -v160
  v_fma_f32 v122, v122, s51, -v156
  v_fma_f32 v130, v130, s51, -v160
  v_fma_f32 v123, v123, s51, -v156
  v_fma_f32 v131, v131, s51, -v160
  v_exp_f32 v116, v116
  v_exp_f32 v124, v124
  v_exp_f32 v117, v117
  v_exp_f32 v125, v125
  v_exp_f32 v118, v118
  v_exp_f32 v126, v126
  v_exp_f32 v119, v119
  v_exp_f32 v127, v127
  v_exp_f32 v120, v120
  v_exp_f32 v128, v128
  v_exp_f32 v121, v121
  v_exp_f32 v129, v129
  v_exp_f32 v122, v122
  v_exp_f32 v130, v130
  v_exp_f32 v123, v123
  v_exp_f32 v131, v131
  v_cvt_pk_bf16_f32 v132, v116, v117
  v_cvt_pk_bf16_f32 v136, v124, v125
  v_cvt_pk_bf16_f32 v133, v118, v119
  v_cvt_pk_bf16_f32 v137, v126, v127
  v_cvt_pk_bf16_f32 v134, v120, v121
  v_cvt_pk_bf16_f32 v138, v128, v129
  v_cvt_pk_bf16_f32 v135, v122, v123
  v_cvt_pk_bf16_f32 v139, v130, v131
  v_add_f32 v156, v116, v117
  v_add_f32 v160, v124, v125
  v_add_f32 v156, v156, v118
  v_add_f32 v160, v160, v126
  v_add_f32 v156, v156, v119
  v_add_f32 v160, v160, v127
  v_add_f32 v156, v156, v120
  v_add_f32 v160, v160, v128
  v_add_f32 v156, v156, v121
  v_add_f32 v160, v160, v129
  v_add_f32 v156, v156, v122
  v_add_f32 v160, v160, v130
  v_add_f32 v156, v156, v123
  v_add_f32 v160, v160, v131
  v_mov_b32 v157, v156
  v_mov_b32 v161, v160
  s_nop 0
  v_permlane32_swap_b32 v156, v157
  v_permlane32_swap_b32 v160, v161
  v_add_f32 v156, v156, v157
  v_add_f32 v160, v160, v161
  v_mov_b32 v157, v156
  v_mov_b32 v161, v160
  s_nop 0
  v_permlane16_swap_b32 v156, v157
  v_permlane16_swap_b32 v160, v161
  v_add_f32 v156, v156, v157
  v_add_f32 v160, v160, v161
  v_rcp_f32 v156, v156
  v_rcp_f32 v160, v160
  v_mfma_f32_16x16x32_bf16 v[140:143], v[100:103], v[132:135], 0
  v_mfma_f32_16x16x32_bf16 v[144:147], v[104:107], v[132:135], 0
  v_mfma_f32_16x16x32_bf16 v[148:151], v[108:111], v[136:139], 0
  v_mfma_f32_16x16x32_bf16 v[152:155], v[112:115], v[136:139], 0
  s_add_u32 s36, s4, 0x400000
  s_addc_u32 s37, s5, 0x0
  s_mov_b32 s38, 0x400000
  s_mov_b32 s39, 0x20000
  s_lshl_b32 s47, s44, 4
  s_add_u32 s47, s47, s45
  s_lshl_b32 s47, s47, 14
  s_lshl_b32 s48, s61, 13
  s_add_u32 s47, s47, s48
  s_lshl_b32 s48, s62, 12
  s_add_u32 s47, s47, s48
  s_lshl_b32 s48, s63, 11
  s_add_u32 s47, s47, s48
  v_lshlrev_b32 v71, 6, v64
  v_lshrrev_b32 v72, 1, v65
  v_and_b32 v73, 1, v65
  v_lshl_or_b32 v72, v73, 1, v72
  v_lshl_add_u32 v71, v72, 4, v71
  v_add_u32 v71, s47, v71
  v_mul_f32 v140, v140, v156
  v_mul_f32 v141, v141, v156
  v_mul_f32 v142, v142, v156
  v_mul_f32 v143, v143, v156
  v_mul_f32 v144, v144, v156
  v_mul_f32 v145, v145, v156
  v_mul_f32 v146, v146, v156
  v_mul_f32 v147, v147, v156
  v_cvt_pk_bf16_f32 v132, v140, v141
  v_cvt_pk_bf16_f32 v133, v142, v143
  v_cvt_pk_bf16_f32 v134, v144, v145
  v_cvt_pk_bf16_f32 v135, v146, v147
  s_nop 0
  v_permlane16_swap_b32 v132, v134
  v_permlane16_swap_b32 v133, v135
  buffer_store_dwordx4 v[132:135], v71, s[36:39], 0 offen offset:0 sc1
  v_mul_f32 v148, v148, v160
  v_mul_f32 v149, v149, v160
  v_mul_f32 v150, v150, v160
  v_mul_f32 v151, v151, v160
  v_mul_f32 v152, v152, v160
  v_mul_f32 v153, v153, v160
  v_mul_f32 v154, v154, v160
  v_mul_f32 v155, v155, v160
  v_cvt_pk_bf16_f32 v136, v148, v149
  v_cvt_pk_bf16_f32 v137, v150, v151
  v_cvt_pk_bf16_f32 v138, v152, v153
  v_cvt_pk_bf16_f32 v139, v154, v155
  s_nop 0
  v_permlane16_swap_b32 v136, v138
  v_permlane16_swap_b32 v137, v139
  buffer_store_dwordx4 v[136:139], v71, s[36:39], 0 offen offset:1024 sc1
  s_setpc_b64 s[84:85]
p1_done:
  s_mov_b32 s44, s59
  s_mov_b32 s45, s60
  s_lshr_b32 s61, s46, 1
  s_and_b32 s62, s46, 1
  s_mov_b32 s32, s6
  s_mov_b32 s33, s7
  s_mov_b32 s34, 0x400000
  s_mov_b32 s35, 0x20000
  s_add_u32 s36, s4, 0x800000
  s_addc_u32 s37, s5, 0x0
  s_mov_b32 s38, 0x400000
  s_mov_b32 s39, 0x20000
  v_lshrrev_b32 v5, 4, v0
  v_lshrrev_b32 v6, 1, v5
  v_and_b32 v5, 1, v5
  v_lshl_or_b32 v5, v5, 1, v6
  v_lshlrev_b32 v6, 4, v5
  v_and_b32 v5, 15, v0
  s_lshl_b32 s49, s44, 7
  s_lshl_b32 s50, s61, 6
  s_add_u32 s49, s49, s50
  v_add_u32 v7, s49, v5
  v_lshlrev_b32 v7, 11, v7
  v_add_u32 v7, v7, v6
  s_lshl_b32 s49, s45, 7
  s_lshl_b32 s50, s62, 6
  s_add_u32 s49, s49, s50
  v_add_u32 v7, s49, v7
  s_lshl_b32 s49, s44, 4
  s_add_u32 s49, s49, s45
  s_lshl_b32 s49, s49, 14
  s_lshl_b32 s50, s62, 13
  s_add_u32 s49, s49, s50
  s_lshl_b32 s50, s61, 12
  s_add_u32 s49, s49, s50
  v_lshl_add_u32 v8, v5, 6, v6
  v_add_u32 v8, s49, v8
  v_add_u32 v5, 0, v7
  buffer_load_dwordx4 v[92:95], v5, s[32:35], 0 offen
  v_add_u32 v5, 32768, v7
  buffer_load_dwordx4 v[96:99], v5, s[32:35], 0 offen
  v_add_u32 v5, 65536, v7
  buffer_load_dwordx4 v[100:103], v5, s[32:35], 0 offen
  v_add_u32 v5, 98304, v7
  buffer_load_dwordx4 v[104:107], v5, s[32:35], 0 offen
  s_lshl_b32 s49, s61, 13
  v_and_b32 v5, 15, v0
  v_lshlrev_b32 v1, 7, v5
  v_lshrrev_b32 v5, 4, v0
  v_and_b32 v2, 6, v0
  v_xor_b32 v5, v5, v2
  v_lshlrev_b32 v5, 4, v5
  v_add_u32 v1, v1, v5
  v_add_u32 v1, s49, v1
  v_xor_b32 v2, 64, v1
  v_lshrrev_b32 v5, 4, v0
  v_lshlrev_b32 v3, 10, v5
  v_and_b32 v4, 1, v5
  v_lshlrev_b32 v4, 2, v4
  v_bfe_u32 v5, v0, 2, 2
  v_lshl_add_u32 v3, v5, 7, v3
  v_and_b32 v5, 2, v5
  v_or_b32 v4, v4, v5
  v_bfe_u32 v5, v0, 1, 1
  v_xor_b32 v4, v4, v5
  v_and_b32 v5, 1, v0
  v_lshl_add_u32 v3, v5, 3, v3
  s_lshl_b32 s49, s62, 2
  v_xor_b32 v5, s49, v4
  v_xor_b32 v6, 2, v5
  v_lshl_add_u32 v4, v6, 4, v3
  v_lshl_add_u32 v3, v5, 4, v3
  v_add_u32 v3, 16384, v3
  v_add_u32 v4, 16384, v4
  v_mov_b32 v12, 0
  v_mov_b32 v13, 0
  v_mov_b32 v14, 0
  v_mov_b32 v15, 0
  v_mov_b32 v16, 0
  v_mov_b32 v17, 0
  v_mov_b32 v18, 0
  v_mov_b32 v19, 0
  v_mov_b32 v20, 0
  v_mov_b32 v21, 0
  v_mov_b32 v22, 0
  v_mov_b32 v23, 0
  v_mov_b32 v24, 0
  v_mov_b32 v25, 0
  v_mov_b32 v26, 0
  v_mov_b32 v27, 0
  v_mov_b32 v28, 0
  v_mov_b32 v29, 0
  v_mov_b32 v30, 0
  v_mov_b32 v31, 0
  v_mov_b32 v32, 0
  v_mov_b32 v33, 0
  v_mov_b32 v34, 0
  v_mov_b32 v35, 0
  v_mov_b32 v36, 0
  v_mov_b32 v37, 0
  v_mov_b32 v38, 0
  v_mov_b32 v39, 0
  v_mov_b32 v40, 0
  v_mov_b32 v41, 0
  v_mov_b32 v42, 0
  v_mov_b32 v43, 0
  s_barrier
  s_mov_b32 s53, 0
  s_mov_b32 s52, 16
  s_barrier
  ds_read_b64_tr_b16 v[60:61], v3 offset:0
  ds_read_b64_tr_b16 v[62:63], v3 offset:512
  ds_read_b128 v[44:47], v1 offset:0
  ds_read_b128 v[48:51], v1 offset:2048
  ds_read_b128 v[52:55], v1 offset:4096
  ds_read_b128 v[56:59], v1 offset:6144
  ds_read_b64_tr_b16 v[64:65], v4 offset:0
  ds_read_b64_tr_b16 v[66:67], v4 offset:512
p2_loop:
  s_waitcnt lgkmcnt(0)
  v_mfma_f32_16x16x32_bf16 v[12:15], v[60:63], v[44:47], v[12:15]
  s_add_u32 s53, s53, 24576
  ds_read_b64_tr_b16 v[84:85], v3 offset:4096
  v_mfma_f32_16x16x32_bf16 v[16:19], v[60:63], v[48:51], v[16:19]
  s_cmp_eq_u32 s53, 147456
  ds_read_b64_tr_b16 v[86:87], v3 offset:4608
  v_mfma_f32_16x16x32_bf16 v[20:23], v[60:63], v[52:55], v[20:23]
  s_cselect_b32 s54, 147456, 0
  ds_read_b128 v[68:71], v2 offset:0
  v_mfma_f32_16x16x32_bf16 v[24:27], v[60:63], v[56:59], v[24:27]
  s_cselect_b32 s53, 0, s53
  ds_read_b128 v[72:75], v2 offset:2048
  v_mfma_f32_16x16x32_bf16 v[28:31], v[64:67], v[44:47], v[28:31]
  s_sub_u32 s54, 24576, s54
  ds_read_b128 v[76:79], v2 offset:4096
  v_mfma_f32_16x16x32_bf16 v[32:35], v[64:67], v[48:51], v[32:35]
  s_sub_u32 s52, s52, 1
  ds_read_b128 v[80:83], v2 offset:6144
  v_mfma_f32_16x16x32_bf16 v[36:39], v[64:67], v[52:55], v[36:39]
  ds_read_b64_tr_b16 v[88:89], v4 offset:4096
  ds_read_b64_tr_b16 v[90:91], v4 offset:4608
  v_mfma_f32_16x16x32_bf16 v[40:43], v[64:67], v[56:59], v[40:43]
  s_waitcnt lgkmcnt(0)
  s_barrier
  v_mfma_f32_16x16x32_bf16 v[12:15], v[84:87], v[68:71], v[12:15]
  v_add_u32 v3, s54, v3
  v_mfma_f32_16x16x32_bf16 v[16:19], v[84:87], v[72:75], v[16:19]
  v_add_u32 v1, s54, v1
  ds_read_b64_tr_b16 v[60:61], v3 offset:0
  v_mfma_f32_16x16x32_bf16 v[20:23], v[84:87], v[76:79], v[20:23]
  v_add_u32 v4, s54, v4
  ds_read_b64_tr_b16 v[62:63], v3 offset:512
  v_mfma_f32_16x16x32_bf16 v[24:27], v[84:87], v[80:83], v[24:27]
  v_add_u32 v2, s54, v2
  ds_read_b128 v[44:47], v1 offset:0
  v_mfma_f32_16x16x32_bf16 v[28:31], v[88:91], v[68:71], v[28:31]
  s_cmp_lg_u32 s52, 0
  ds_read_b128 v[48:51], v1 offset:2048
  v_mfma_f32_16x16x32_bf16 v[32:35], v[88:91], v[72:75], v[32:35]
  ds_read_b128 v[52:55], v1 offset:4096
  v_mfma_f32_16x16x32_bf16 v[36:39], v[88:91], v[76:79], v[36:39]
  ds_read_b128 v[56:59], v1 offset:6144
  v_mfma_f32_16x16x32_bf16 v[40:43], v[88:91], v[80:83], v[40:43]
  ds_read_b64_tr_b16 v[64:65], v4 offset:0
  ds_read_b64_tr_b16 v[66:67], v4 offset:512
  s_cbranch_scc1 p2_loop
  s_waitcnt lgkmcnt(0)
  s_nop 7
  s_barrier
  s_waitcnt vmcnt(0)
  v_permlane16_swap_b32 v12, v28
  v_permlane16_swap_b32 v13, v29
  v_permlane16_swap_b32 v14, v30
  v_permlane16_swap_b32 v15, v31
  v_lshlrev_b32 v140, 16, v92
  v_and_b32 v141, 0xffff0000, v92
  v_lshlrev_b32 v142, 16, v93
  v_and_b32 v143, 0xffff0000, v93
  v_lshlrev_b32 v144, 16, v94
  v_and_b32 v145, 0xffff0000, v94
  v_lshlrev_b32 v146, 16, v95
  v_and_b32 v147, 0xffff0000, v95
  v_add_f32 v140, v140, v12
  v_add_f32 v141, v141, v13
  v_add_f32 v142, v142, v14
  v_add_f32 v143, v143, v15
  v_add_f32 v144, v144, v28
  v_add_f32 v145, v145, v29
  v_add_f32 v146, v146, v30
  v_add_f32 v147, v147, v31
  v_cvt_pk_bf16_f32 v108, v140, v141
  v_cvt_pk_bf16_f32 v109, v142, v143
  v_cvt_pk_bf16_f32 v110, v144, v145
  v_cvt_pk_bf16_f32 v111, v146, v147
  v_add_u32 v5, 0, v8
  buffer_store_dwordx4 v[108:111], v5, s[36:39], 0 offen sc1
  v_permlane16_swap_b32 v16, v32
  v_permlane16_swap_b32 v17, v33
  v_permlane16_swap_b32 v18, v34
  v_permlane16_swap_b32 v19, v35
  v_lshlrev_b32 v148, 16, v96
  v_and_b32 v149, 0xffff0000, v96
  v_lshlrev_b32 v150, 16, v97
  v_and_b32 v151, 0xffff0000, v97
  v_lshlrev_b32 v152, 16, v98
  v_and_b32 v153, 0xffff0000, v98
  v_lshlrev_b32 v154, 16, v99
  v_and_b32 v155, 0xffff0000, v99
  v_add_f32 v148, v148, v16
  v_add_f32 v149, v149, v17
  v_add_f32 v150, v150, v18
  v_add_f32 v151, v151, v19
  v_add_f32 v152, v152, v32
  v_add_f32 v153, v153, v33
  v_add_f32 v154, v154, v34
  v_add_f32 v155, v155, v35
  v_cvt_pk_bf16_f32 v112, v148, v149
  v_cvt_pk_bf16_f32 v113, v150, v151
  v_cvt_pk_bf16_f32 v114, v152, v153
  v_cvt_pk_bf16_f32 v115, v154, v155
  v_add_u32 v5, 1024, v8
  buffer_store_dwordx4 v[112:115], v5, s[36:39], 0 offen sc1
  v_permlane16_swap_b32 v20, v36
  v_permlane16_swap_b32 v21, v37
  v_permlane16_swap_b32 v22, v38
  v_permlane16_swap_b32 v23, v39
  v_lshlrev_b32 v156, 16, v100
  v_and_b32 v157, 0xffff0000, v100
  v_lshlrev_b32 v158, 16, v101
  v_and_b32 v159, 0xffff0000, v101
  v_lshlrev_b32 v160, 16, v102
  v_and_b32 v161, 0xffff0000, v102
  v_lshlrev_b32 v162, 16, v103
  v_and_b32 v163, 0xffff0000, v103
  v_add_f32 v156, v156, v20
  v_add_f32 v157, v157, v21
  v_add_f32 v158, v158, v22
  v_add_f32 v159, v159, v23
  v_add_f32 v160, v160, v36
  v_add_f32 v161, v161, v37
  v_add_f32 v162, v162, v38
  v_add_f32 v163, v163, v39
  v_cvt_pk_bf16_f32 v116, v156, v157
  v_cvt_pk_bf16_f32 v117, v158, v159
  v_cvt_pk_bf16_f32 v118, v160, v161
  v_cvt_pk_bf16_f32 v119, v162, v163
  v_add_u32 v5, 2048, v8
  buffer_store_dwordx4 v[116:119], v5, s[36:39], 0 offen sc1
  v_permlane16_swap_b32 v24, v40
  v_permlane16_swap_b32 v25, v41
  v_permlane16_swap_b32 v26, v42
  v_permlane16_swap_b32 v27, v43
  v_lshlrev_b32 v164, 16, v104
  v_and_b32 v165, 0xffff0000, v104
  v_lshlrev_b32 v166, 16, v105
  v_and_b32 v167, 0xffff0000, v105
  v_lshlrev_b32 v168, 16, v106
  v_and_b32 v169, 0xffff0000, v106
  v_lshlrev_b32 v170, 16, v107
  v_and_b32 v171, 0xffff0000, v107
  v_add_f32 v164, v164, v24
  v_add_f32 v165, v165, v25
  v_add_f32 v166, v166, v26
  v_add_f32 v167, v167, v27
  v_add_f32 v168, v168, v40
  v_add_f32 v169, v169, v41
  v_add_f32 v170, v170, v42
  v_add_f32 v171, v171, v43
  v_cvt_pk_bf16_f32 v120, v164, v165
  v_cvt_pk_bf16_f32 v121, v166, v167
  v_cvt_pk_bf16_f32 v122, v168, v169
  v_cvt_pk_bf16_f32 v123, v170, v171
  v_add_u32 v5, 3072, v8
  buffer_store_dwordx4 v[120:123], v5, s[36:39], 0 offen sc1
  s_barrier
  v_add_f32 v124, v140, v141
  v_mul_f32 v128, v140, v140
  v_fmac_f32 v128, v141, v141
  v_add_f32 v124, v124, v142
  v_fmac_f32 v128, v142, v142
  v_add_f32 v124, v124, v143
  v_fmac_f32 v128, v143, v143
  v_add_f32 v124, v124, v144
  v_fmac_f32 v128, v144, v144
  v_add_f32 v124, v124, v145
  v_fmac_f32 v128, v145, v145
  v_add_f32 v124, v124, v146
  v_fmac_f32 v128, v146, v146
  v_add_f32 v124, v124, v147
  v_fmac_f32 v128, v147, v147
  v_add_f32 v125, v148, v149
  v_mul_f32 v129, v148, v148
  v_fmac_f32 v129, v149, v149
  v_add_f32 v125, v125, v150
  v_fmac_f32 v129, v150, v150
  v_add_f32 v125, v125, v151
  v_fmac_f32 v129, v151, v151
  v_add_f32 v125, v125, v152
  v_fmac_f32 v129, v152, v152
  v_add_f32 v125, v125, v153
  v_fmac_f32 v129, v153, v153
  v_add_f32 v125, v125, v154
  v_fmac_f32 v129, v154, v154
  v_add_f32 v125, v125, v155
  v_fmac_f32 v129, v155, v155
  v_add_f32 v126, v156, v157
  v_mul_f32 v130, v156, v156
  v_fmac_f32 v130, v157, v157
  v_add_f32 v126, v126, v158
  v_fmac_f32 v130, v158, v158
  v_add_f32 v126, v126, v159
  v_fmac_f32 v130, v159, v159
  v_add_f32 v126, v126, v160
  v_fmac_f32 v130, v160, v160
  v_add_f32 v126, v126, v161
  v_fmac_f32 v130, v161, v161
  v_add_f32 v126, v126, v162
  v_fmac_f32 v130, v162, v162
  v_add_f32 v126, v126, v163
  v_fmac_f32 v130, v163, v163
  v_add_f32 v127, v164, v165
  v_mul_f32 v131, v164, v164
  v_fmac_f32 v131, v165, v165
  v_add_f32 v127, v127, v166
  v_fmac_f32 v131, v166, v166
  v_add_f32 v127, v127, v167
  v_fmac_f32 v131, v167, v167
  v_add_f32 v127, v127, v168
  v_fmac_f32 v131, v168, v168
  v_add_f32 v127, v127, v169
  v_fmac_f32 v131, v169, v169
  v_add_f32 v127, v127, v170
  v_fmac_f32 v131, v170, v170
  v_add_f32 v127, v127, v171
  v_fmac_f32 v131, v171, v171
  v_permlane16_swap_b32 v124, v125
  v_permlane16_swap_b32 v126, v127
  v_add_f32 v124, v124, v125
  v_add_f32 v126, v126, v127
  s_nop 1
  v_permlane32_swap_b32 v124, v126
  v_add_f32 v124, v124, v126
  v_permlane16_swap_b32 v128, v129
  v_permlane16_swap_b32 v130, v131
  v_add_f32 v128, v128, v129
  v_add_f32 v130, v130, v131
  s_nop 1
  v_permlane32_swap_b32 v128, v130
  v_add_f32 v128, v128, v130
  s_lshl_b32 s49, s61, 9
  s_lshl_b32 s50, s62, 10
  s_add_u32 s49, s49, s50
  s_add_u32 s49, s49, 157952
  v_lshlrev_b32 v5, 3, v0
  v_add_u32 v5, s49, v5
  v_mov_b32 v140, v124
  v_mov_b32 v141, v128
  ds_write_b64 v5, v[140:141]
  s_waitcnt lgkmcnt(0)
  s_barrier
  s_cmp_eq_u32 s62, 0
  s_cbranch_scc0 Lst_2
  ds_read_b64 v[142:143], v5 offset:1024
  s_add_u32 s40, s4, 0x2480000
  s_addc_u32 s41, s5, 0x0
  s_mov_b32 s42, 0x40000
  s_mov_b32 s43, 0x20000
  s_waitcnt lgkmcnt(0)
  v_add_f32 v140, v140, v142
  v_add_f32 v141, v141, v143
  s_lshl_b32 s49, s45, 14
  s_lshl_b32 s50, s44, 10
  s_add_u32 s49, s49, s50
  s_lshl_b32 s50, s61, 9
  s_add_u32 s49, s49, s50
  v_lshlrev_b32 v5, 3, v0
  buffer_store_dwordx2 v[140:141], v5, s[40:43], s49 offen sc1
  s_waitcnt vmcnt(1)
  s_branch Lst_2_w
Lst_2:
  s_waitcnt vmcnt(0)
Lst_2_w:
  s_waitcnt vmcnt(1)
  s_barrier
  s_cmp_lg_u32 s46, 0
  s_cbranch_scc1 Lw_3
  s_lshl_b32 s47, s44, 10
  s_lshl_b32 s48, s45, 6
  s_add_u32 s47, s47, s48
  s_add_u32 s47, s47, 81920
  v_mov_b32 v5, s22
  v_mov_b32 v6, 0
  s_mov_b64 exec, 1
  buffer_store_dword v5, v6, s[64:67], s47 offen sc1
  s_mov_b64 exec, -1
Lw_3:
  s_cmp_eq_u32 s62, 0
  s_cbranch_scc0 Lst_2_e
  s_lshl_b32 s63, s45, 1
  s_add_u32 s63, s63, s61
  s_waitcnt vmcnt(0)
  s_lshl_b32 s47, s44, 8
  s_lshl_b32 s48, s63, 2
  s_add_u32 s47, s47, s48
  s_add_u32 s47, s47, 28672
  v_mov_b32 v5, s22
  v_mov_b32 v6, 0
  s_mov_b64 exec, 1
  buffer_store_dword v5, v6, s[64:67], s47 offen sc1
  s_mov_b64 exec, -1
Lst_2_e:
  s_mov_b32 s44, s57
  s_mov_b32 s45, s58
  s_lshl_b32 s49, s46, 12
  v_and_b32 v5, 15, v0
  v_lshlrev_b32 v1, 7, v5
  v_lshrrev_b32 v5, 4, v0
  v_and_b32 v2, 6, v0
  v_xor_b32 v5, v5, v2
  v_lshlrev_b32 v5, 4, v5
  v_add_u32 v1, v1, v5
  v_add_u32 v1, s49, v1
  v_xor_b32 v2, 64, v1
  v_lshrrev_b32 v5, 5, v0
  v_lshlrev_b32 v5, 4, v5
  v_bfe_u32 v6, v0, 4, 1
  v_lshl_add_u32 v5, v6, 2, v5
  v_bfe_u32 v6, v0, 2, 2
  v_add_u32 v5, v5, v6
  v_mul_u32_u24 v3, 224, v5
  v_and_b32 v6, 3, v0
  v_lshl_add_u32 v3, v6, 3, v3
  v_add_u32 v3, 16384, v3
  s_mov_b32 s32, s12
  s_mov_b32 s33, s13
  s_mov_b32 s34, 0x700000
  s_mov_b32 s35, 0x20000
  s_add_u32 s36, s4, 0x2400000
  s_addc_u32 s37, s5, 0x0
  s_mov_b32 s38, 0x38000
  s_mov_b32 s39, 0x20000
  v_lshrrev_b32 v5, 3, v0
  v_lshlrev_b32 v5, 3, v5
  s_lshl_b32 s47, s58, 6
  v_add_u32 v5, s47, v5
  s_mov_b32 s47, 7168
  v_mul_lo_u32 v5, v5, s47
  v_and_b32 v6, 7, v0
  v_min_u32 v6, 6, v6
  v_lshl_add_u32 v5, v6, 4, v5
  s_mul_i32 s47, s57, 448
  s_mul_i32 s48, s46, 112
  s_add_u32 s47, s47, s48
  v_add_u32 v5, s47, v5
  s_mov_b32 s48, 0
  buffer_load_dwordx4 v[68:71], v5, s[32:35], s48 offen
  s_mov_b32 s48, 7168
  buffer_load_dwordx4 v[72:75], v5, s[32:35], s48 offen
  s_mov_b32 s48, 14336
  buffer_load_dwordx4 v[76:79], v5, s[32:35], s48 offen
  s_mov_b32 s48, 21504
  buffer_load_dwordx4 v[80:83], v5, s[32:35], s48 offen
  s_mov_b32 s48, 28672
  buffer_load_dwordx4 v[84:87], v5, s[32:35], s48 offen
  s_mov_b32 s48, 35840
  buffer_load_dwordx4 v[88:91], v5, s[32:35], s48 offen
  s_mov_b32 s48, 43008
  buffer_load_dwordx4 v[92:95], v5, s[32:35], s48 offen
  s_mov_b32 s48, 50176
  buffer_load_dwordx4 v[96:99], v5, s[32:35], s48 offen
  v_mov_b32 v12, 0
  v_mov_b32 v13, 0
  v_mov_b32 v14, 0
  v_mov_b32 v15, 0
  v_mov_b32 v16, 0
  v_mov_b32 v17, 0
  v_mov_b32 v18, 0
  v_mov_b32 v19, 0
  v_mov_b32 v20, 0
  v_mov_b32 v21, 0
  v_mov_b32 v22, 0
  v_mov_b32 v23, 0
  v_mov_b32 v24, 0
  v_mov_b32 v25, 0
  v_mov_b32 v26, 0
  v_mov_b32 v27, 0
  v_mov_b32 v28, 0
  v_mov_b32 v29, 0
  v_mov_b32 v30, 0
  v_mov_b32 v31, 0
  v_mov_b32 v32, 0
  v_mov_b32 v33, 0
  v_mov_b32 v34, 0
  v_mov_b32 v35, 0
  v_mov_b32 v36, 0
  v_mov_b32 v37, 0
  v_mov_b32 v38, 0
  v_mov_b32 v39, 0
  v_mov_b32 v40, 0
  v_mov_b32 v41, 0
  v_mov_b32 v42, 0
  v_mov_b32 v43, 0
  v_mov_b32 v44, 0
  v_mov_b32 v45, 0
  v_mov_b32 v46, 0
  v_mov_b32 v47, 0
  v_mov_b32 v48, 0
  v_mov_b32 v49, 0
  v_mov_b32 v50, 0
  v_mov_b32 v51, 0
  v_mov_b32 v52, 0
  v_mov_b32 v53, 0
  v_mov_b32 v54, 0
  v_mov_b32 v55, 0
  v_mov_b32 v56, 0
  v_mov_b32 v57, 0
  v_mov_b32 v58, 0
  v_mov_b32 v59, 0
  v_mov_b32 v60, 0
  v_mov_b32 v61, 0
  v_mov_b32 v62, 0
  v_mov_b32 v63, 0
  v_mov_b32 v64, 0
  v_mov_b32 v65, 0
  v_mov_b32 v66, 0
  v_mov_b32 v67, 0
  s_barrier
  s_add_u32 s36, s4, 0x2400000
  s_addc_u32 s37, s5, 0x0
  s_mov_b32 s38, 0x38000
  s_mov_b32 s39, 0x20000
  v_and_b32 v6, 7, v0
  v_min_u32 v6, 6, v6
  s_mov_b32 s47, 0x05040100
  s_mov_b32 s48, 0x07060302
  s_mov_b32 s49, 0x3f803f80
  v_mov_b32 v100, 0
  v_mov_b32 v101, 0
  v_mov_b32 v102, 0
  v_mov_b32 v103, 0
  v_mov_b32 v104, 0
  v_mov_b32 v105, 0
  v_mov_b32 v106, 0
  v_mov_b32 v107, 0
  s_waitcnt vmcnt(0)
  v_perm_b32 v108, v72, v68, s47
  v_perm_b32 v109, v72, v68, s48
  v_dot2_f32_bf16 v100, v108, s49, v100
  v_dot2_f32_bf16 v101, v109, s49, v101
  v_perm_b32 v110, v73, v69, s47
  v_perm_b32 v111, v73, v69, s48
  v_dot2_f32_bf16 v102, v110, s49, v102
  v_dot2_f32_bf16 v103, v111, s49, v103
  v_perm_b32 v112, v74, v70, s47
  v_perm_b32 v113, v74, v70, s48
  v_dot2_f32_bf16 v104, v112, s49, v104
  v_dot2_f32_bf16 v105, v113, s49, v105
  v_perm_b32 v114, v75, v71, s47
  v_perm_b32 v115, v75, v71, s48
  v_dot2_f32_bf16 v106, v114, s49, v106
  v_dot2_f32_bf16 v107, v115, s49, v107
  v_perm_b32 v108, v80, v76, s47
  v_perm_b32 v109, v80, v76, s48
  v_dot2_f32_bf16 v100, v108, s49, v100
  v_dot2_f32_bf16 v101, v109, s49, v101
  v_perm_b32 v110, v81, v77, s47
  v_perm_b32 v111, v81, v77, s48
  v_dot2_f32_bf16 v102, v110, s49, v102
  v_dot2_f32_bf16 v103, v111, s49, v103
  v_perm_b32 v112, v82, v78, s47
  v_perm_b32 v113, v82, v78, s48
  v_dot2_f32_bf16 v104, v112, s49, v104
  v_dot2_f32_bf16 v105, v113, s49, v105
  v_perm_b32 v114, v83, v79, s47
  v_perm_b32 v115, v83, v79, s48
  v_dot2_f32_bf16 v106, v114, s49, v106
  v_dot2_f32_bf16 v107, v115, s49, v107
  v_perm_b32 v108, v88, v84, s47
  v_perm_b32 v109, v88, v84, s48
  v_dot2_f32_bf16 v100, v108, s49, v100
  v_dot2_f32_bf16 v101, v109, s49, v101
  v_perm_b32 v110, v89, v85, s47
  v_perm_b32 v111, v89, v85, s48
  v_dot2_f32_bf16 v102, v110, s49, v102
  v_dot2_f32_bf16 v103, v111, s49, v103
  v_perm_b32 v112, v90, v86, s47
  v_perm_b32 v113, v90, v86, s48
  v_dot2_f32_bf16 v104, v112, s49, v104
  v_dot2_f32_bf16 v105, v113, s49, v105
  v_perm_b32 v114, v91, v87, s47
  v_perm_b32 v115, v91, v87, s48
  v_dot2_f32_bf16 v106, v114, s49, v106
  v_dot2_f32_bf16 v107, v115, s49, v107
  v_perm_b32 v108, v96, v92, s47
  v_perm_b32 v109, v96, v92, s48
  v_dot2_f32_bf16 v100, v108, s49, v100
  v_dot2_f32_bf16 v101, v109, s49, v101
  v_perm_b32 v110, v97, v93, s47
  v_perm_b32 v111, v97, v93, s48
  v_dot2_f32_bf16 v102, v110, s49, v102
  v_dot2_f32_bf16 v103, v111, s49, v103
  v_perm_b32 v112, v98, v94, s47
  v_perm_b32 v113, v98, v94, s48
  v_dot2_f32_bf16 v104, v112, s49, v104
  v_dot2_f32_bf16 v105, v113, s49, v105
  v_perm_b32 v114, v99, v95, s47
  v_perm_b32 v115, v99, v95, s48
  v_dot2_f32_bf16 v106, v114, s49, v106
  v_dot2_f32_bf16 v107, v115, s49, v107
  v_add_f32_dpp v100, v100, v100 row_ror:8 row_mask:0xf bank_mask:0xf
  v_add_f32_dpp v101, v101, v101 row_ror:8 row_mask:0xf bank_mask:0xf
  v_add_f32_dpp v102, v102, v102 row_ror:8 row_mask:0xf bank_mask:0xf
  v_add_f32_dpp v103, v103, v103 row_ror:8 row_mask:0xf bank_mask:0xf
  v_add_f32_dpp v104, v104, v104 row_ror:8 row_mask:0xf bank_mask:0xf
  v_add_f32_dpp v105, v105, v105 row_ror:8 row_mask:0xf bank_mask:0xf
  v_add_f32_dpp v106, v106, v106 row_ror:8 row_mask:0xf bank_mask:0xf
  v_add_f32_dpp v107, v107, v107 row_ror:8 row_mask:0xf bank_mask:0xf
  v_mov_b32 v108, v100
  v_mov_b32 v109, v101
  v_mov_b32 v110, v102
  v_mov_b32 v111, v103
  v_mov_b32 v112, v104
  v_mov_b32 v113, v105
  v_mov_b32 v114, v106
  v_mov_b32 v115, v107
  v_permlane16_swap_b32 v100, v108
  v_permlane16_swap_b32 v101, v109
  v_permlane16_swap_b32 v102, v110
  v_permlane16_swap_b32 v103, v111
  v_permlane16_swap_b32 v104, v112
  v_permlane16_swap_b32 v105, v113
  v_permlane16_swap_b32 v106, v114
  v_permlane16_swap_b32 v107, v115
  v_add_f32 v100, v100, v108
  v_add_f32 v101, v101, v109
  v_add_f32 v102, v102, v110
  v_add_f32 v103, v103, v111
  v_add_f32 v104, v104, v112
  v_add_f32 v105, v105, v113
  v_add_f32 v106, v106, v114
  v_add_f32 v107, v107, v115
  v_mov_b32 v108, v100
  v_mov_b32 v109, v101
  v_mov_b32 v110, v102
  v_mov_b32 v111, v103
  v_mov_b32 v112, v104
  v_mov_b32 v113, v105
  v_mov_b32 v114, v106
  v_mov_b32 v115, v107
  v_permlane32_swap_b32 v100, v108
  v_permlane32_swap_b32 v101, v109
  v_permlane32_swap_b32 v102, v110
  v_permlane32_swap_b32 v103, v111
  v_permlane32_swap_b32 v104, v112
  v_permlane32_swap_b32 v105, v113
  v_permlane32_swap_b32 v106, v114
  v_permlane32_swap_b32 v107, v115
  v_add_f32 v100, v100, v108
  v_add_f32 v101, v101, v109
  v_add_f32 v102, v102, v110
  v_add_f32 v103, v103, v111
  v_add_f32 v104, v104, v112
  v_add_f32 v105, v105, v113
  v_add_f32 v106, v106, v114
  v_add_f32 v107, v107, v115
  s_mul_i32 s47, s58, 14336
  s_mul_i32 s48, s57, 896
  s_add_u32 s47, s47, s48
  s_mul_i32 s48, s46, 224
  s_add_u32 s47, s47, s48
  v_lshlrev_b32 v6, 5, v6
  s_mov_b64 exec, 0x7f
  buffer_store_dwordx4 v[100:103], v6, s[36:39], s47 offen sc1
  buffer_store_dwordx4 v[104:107], v6, s[36:39], s47 offen offset:16 sc1
  s_mov_b64 exec, -1
  s_mov_b32 s53, 0
  s_barrier
  ds_read_b64_tr_b16 v[132:133], v3 offset:0
  ds_read_b64_tr_b16 v[134:135], v3 offset:1792
  ds_read_b128 v[124:127], v1 offset:0
  ds_read_b128 v[128:131], v1 offset:2048
  ds_read_b64_tr_b16 v[136:137], v3 offset:32
  ds_read_b64_tr_b16 v[138:139], v3 offset:1824
  ds_read_b64_tr_b16 v[140:141], v3 offset:64
  ds_read_b64_tr_b16 v[142:143], v3 offset:1856
  ds_read_b64_tr_b16 v[144:145], v3 offset:96
  ds_read_b64_tr_b16 v[146:147], v3 offset:1888
  ds_read_b64_tr_b16 v[148:149], v3 offset:128
  ds_read_b64_tr_b16 v[150:151], v3 offset:1920
  ds_read_b64_tr_b16 v[152:153], v3 offset:160
  ds_read_b64_tr_b16 v[154:155], v3 offset:1952
  ds_read_b64_tr_b16 v[156:157], v3 offset:192
  ds_read_b64_tr_b16 v[158:159], v3 offset:1984
  s_mov_b32 s52, 5
  s_call_b64 s[84:85], p3s_loop
  s_waitcnt vmcnt(0)
  s_mov_b32 s52, 6
  s_call_b64 s[84:85], p3s_loop
  s_cmp_ge_u32 s46, 2
  s_cbranch_scc1 p3_pj_cs
  s_add_u32 s32, s4, 0x2480000
  s_addc_u32 s33, s5, 0x0
  s_mov_b32 s34, 0x40000
  s_mov_b32 s35, 0x20000
  s_lshl_b32 s49, s44, 10
  s_lshl_b32 s50, s46, 9
  s_add_u32 s49, s49, s50
  v_lshlrev_b32 v5, 3, v0
  v_add_u32 v5, s49, v5
  s_mov_b32 s47, 0
  buffer_load_dwordx2 v[68:69], v5, s[32:35], s47 offen sc1
  s_mov_b32 s47, 16384
  buffer_load_dwordx2 v[70:71], v5, s[32:35], s47 offen sc1
  s_mov_b32 s47, 32768
  buffer_load_dwordx2 v[72:73], v5, s[32:35], s47 offen sc1
  s_mov_b32 s47, 49152
  buffer_load_dwordx2 v[74:75], v5, s[32:35], s47 offen sc1
  s_mov_b32 s47, 65536
  buffer_load_dwordx2 v[76:77], v5, s[32:35], s47 offen sc1
  s_mov_b32 s47, 81920
  buffer_load_dwordx2 v[78:79], v5, s[32:35], s47 offen sc1
  s_mov_b32 s47, 98304
  buffer_load_dwordx2 v[80:81], v5, s[32:35], s47 offen sc1
  s_mov_b32 s47, 114688
  buffer_load_dwordx2 v[82:83], v5, s[32:35], s47 offen sc1
  s_mov_b32 s47, 131072
  buffer_load_dwordx2 v[84:85], v5, s[32:35], s47 offen sc1
  s_mov_b32 s47, 147456
  buffer_load_dwordx2 v[86:87], v5, s[32:35], s47 offen sc1
  s_mov_b32 s47, 163840
  buffer_load_dwordx2 v[88:89], v5, s[32:35], s47 offen sc1
  s_mov_b32 s47, 180224
  buffer_load_dwordx2 v[90:91], v5, s[32:35], s47 offen sc1
  s_mov_b32 s47, 196608
  buffer_load_dwordx2 v[92:93], v5, s[32:35], s47 offen sc1
  s_mov_b32 s47, 212992
  buffer_load_dwordx2 v[94:95], v5, s[32:35], s47 offen sc1
  s_mov_b32 s47, 229376
  buffer_load_dwordx2 v[96:97], v5, s[32:35], s47 offen sc1
  s_mov_b32 s47, 245760
  buffer_load_dwordx2 v[98:99], v5, s[32:35], s47 offen sc1
  s_branch p3_pj_done
p3_pj_cs:
  s_add_u32 s32, s4, 0x2400000
  s_addc_u32 s33, s5, 0x0
  s_mov_b32 s34, 0x38000
  s_mov_b32 s35, 0x20000
  s_mul_i32 s49, s45, 448
  s_cmp_eq_u32 s46, 2
  s_cselect_b32 s50, 7168, 0
  s_add_u32 s49, s49, s50
  v_and_b32 v6, 31, v0
  v_min_u32 v6, 27, v6
  v_lshlrev_b32 v6, 4, v6
  v_add_u32 v5, s49, v6
  v_lshrrev_b32 v6, 5, v0
  s_mov_b32 s47, 114688
  v_mul_lo_u32 v6, v6, s47
  v_add_u32 v5, v5, v6
  s_mov_b32 s47, 0
  buffer_load_dwordx4 v[68:71], v5, s[32:35], s47 offen sc1
  s_mov_b32 s47, 14336
  buffer_load_dwordx4 v[72:75], v5, s[32:35], s47 offen sc1
  s_mov_b32 s47, 28672
  buffer_load_dwordx4 v[76:79], v5, s[32:35], s47 offen sc1
  s_mov_b32 s47, 43008
  buffer_load_dwordx4 v[80:83], v5, s[32:35], s47 offen sc1
  s_mov_b32 s47, 57344
  buffer_load_dwordx4 v[84:87], v5, s[32:35], s47 offen sc1
  s_mov_b32 s47, 71680
  buffer_load_dwordx4 v[88:91], v5, s[32:35], s47 offen sc1
  s_mov_b32 s47, 86016
  buffer_load_dwordx4 v[92:95], v5, s[32:35], s47 offen sc1
  s_mov_b32 s47, 100352
  buffer_load_dwordx4 v[96:99], v5, s[32:35], s47 offen sc1
p3_pj_done:
  s_nop 3
  s_mov_b32 s52, 3
  s_call_b64 s[84:85], p3s_loop
  s_waitcnt vmcnt(0)
  s_cmp_ge_u32 s46, 2
  s_cbranch_scc1 p3_tf_cs
  v_add_f32 v68, v68, v70
  v_add_f32 v69, v69, v71
  v_add_f32 v68, v68, v72
  v_add_f32 v69, v69, v73
  v_add_f32 v68, v68, v74
  v_add_f32 v69, v69, v75
  v_add_f32 v68, v68, v76
  v_add_f32 v69, v69, v77
  v_add_f32 v68, v68, v78
  v_add_f32 v69, v69, v79
  v_add_f32 v68, v68, v80
  v_add_f32 v69, v69, v81
  v_add_f32 v68, v68, v82
  v_add_f32 v69, v69, v83
  v_add_f32 v68, v68, v84
  v_add_f32 v69, v69, v85
  v_add_f32 v68, v68, v86
  v_add_f32 v69, v69, v87
  v_add_f32 v68, v68, v88
  v_add_f32 v69, v69, v89
  v_add_f32 v68, v68, v90
  v_add_f32 v69, v69, v91
  v_add_f32 v68, v68, v92
  v_add_f32 v69, v69, v93
  v_add_f32 v68, v68, v94
  v_add_f32 v69, v69, v95
  v_add_f32 v68, v68, v96
  v_add_f32 v69, v69, v97
  v_add_f32 v68, v68, v98
  v_add_f32 v69, v69, v99
  v_mul_f32 v72, 0x3a800000, v68
  v_mul_f32 v69, 0x3a800000, v69
  v_fma_f32 v69, -v72, v72, v69
  v_max_f32 v69, 0, v69
  v_add_f32 v69, 0x3727c5ac, v69
  v_rsq_f32 v70, v69
  v_sqrt_f32 v75, v69
  v_mul_f32 v73, 0xc0135761, v70
  v_mul_f32 v71, v70, v70
  v_mul_f32 v71, v71, v70
  v_mul_f32 v74, 0xbdd2d3e8, v71
  s_lshl_b32 s49, s46, 10
  s_add_u32 s49, s49, 154880
  v_lshlrev_b32 v5, 4, v0
  v_add_u32 v5, s49, v5
  ds_write_b128 v5, v[72:75]
  s_branch p3_tf_done
p3_tf_cs:
  v_add_f32 v68, v68, v72
  v_add_f32 v69, v69, v73
  v_add_f32 v70, v70, v74
  v_add_f32 v71, v71, v75
  v_add_f32 v68, v68, v76
  v_add_f32 v69, v69, v77
  v_add_f32 v70, v70, v78
  v_add_f32 v71, v71, v79
  v_add_f32 v68, v68, v80
  v_add_f32 v69, v69, v81
  v_add_f32 v70, v70, v82
  v_add_f32 v71, v71, v83
  v_add_f32 v68, v68, v84
  v_add_f32 v69, v69, v85
  v_add_f32 v70, v70, v86
  v_add_f32 v71, v71, v87
  v_add_f32 v68, v68, v88
  v_add_f32 v69, v69, v89
  v_add_f32 v70, v70, v90
  v_add_f32 v71, v71, v91
  v_add_f32 v68, v68, v92
  v_add_f32 v69, v69, v93
  v_add_f32 v70, v70, v94
  v_add_f32 v71, v71, v95
  v_add_f32 v68, v68, v96
  v_add_f32 v69, v69, v97
  v_add_f32 v70, v70, v98
  v_add_f32 v71, v71, v99
  v_mov_b32 v72, v68
  v_mov_b32 v73, v69
  v_mov_b32 v74, v70
  v_mov_b32 v75, v71
  v_permlane32_swap_b32 v68, v72
  v_permlane32_swap_b32 v69, v73
  v_permlane32_swap_b32 v70, v74
  v_permlane32_swap_b32 v71, v75
  v_add_f32 v68, v68, v72
  v_add_f32 v69, v69, v73
  v_add_f32 v70, v70, v74
  v_add_f32 v71, v71, v75
  v_and_b32 v6, 31, v0
  v_min_u32 v6, 27, v6
  v_lshlrev_b32 v6, 4, v6
  s_sub_u32 s50, s46, 2
  s_mul_i32 s50, s50, 448
  s_add_u32 s50, s50, 156928
  v_add_u32 v6, s50, v6
  ds_write_b128 v6, v[68:71]
p3_tf_done:
  s_nop 3
  s_mov_b32 s52, 2
  s_call_b64 s[84:85], p3s_loop
  s_waitcnt lgkmcnt(0)
  v_and_b32 v5, 15, v0
  v_lshlrev_b32 v5, 4, v5
  s_lshl_b32 s49, s46, 9
  s_add_u32 s49, s49, 154880
  v_add_u32 v5, s49, v5
  ds_read_b128 v[124:127], v5 offset:0
  ds_read_b128 v[128:131], v5 offset:256
  v_lshrrev_b32 v5, 4, v0
  v_lshlrev_b32 v5, 4, v5
  v_add_u32 v5, 156928, v5
  ds_read_b128 v[132:135], v5 offset:0
  ds_read_b128 v[136:139], v5 offset:64
  ds_read_b128 v[140:143], v5 offset:128
  ds_read_b128 v[144:147], v5 offset:192
  ds_read_b128 v[148:151], v5 offset:256
  ds_read_b128 v[152:155], v5 offset:320
  ds_read_b128 v[156:159], v5 offset:384
  s_waitcnt lgkmcnt(0)
  v_pk_fma_f32 v[164:165], v[132:133], v[124:125], v[12:13] op_sel_hi:[1,0,1] neg_lo:[0,1,0] neg_hi:[0,1,0]
  v_pk_fma_f32 v[168:169], v[134:135], v[124:125], v[14:15] op_sel_hi:[1,0,1] neg_lo:[0,1,0] neg_hi:[0,1,0]
  v_pk_fma_f32 v[172:173], v[132:133], v[128:129], v[16:17] op_sel_hi:[1,0,1] neg_lo:[0,1,0] neg_hi:[0,1,0]
  v_pk_fma_f32 v[176:177], v[134:135], v[128:129], v[18:19] op_sel_hi:[1,0,1] neg_lo:[0,1,0] neg_hi:[0,1,0]
  v_pk_mul_f32 v[166:167], v[164:165], v[164:165]
  v_pk_mul_f32 v[170:171], v[168:169], v[168:169]
  v_pk_mul_f32 v[174:175], v[172:173], v[172:173]
  v_pk_mul_f32 v[178:179], v[176:177], v[176:177]
  v_pk_fma_f32 v[166:167], v[166:167], v[126:127], v[124:125] op_sel:[0,0,1] op_sel_hi:[1,0,1]
  v_pk_fma_f32 v[170:171], v[170:171], v[126:127], v[124:125] op_sel:[0,0,1] op_sel_hi:[1,0,1]
  v_pk_fma_f32 v[174:175], v[174:175], v[130:131], v[128:129] op_sel:[0,0,1] op_sel_hi:[1,0,1]
  v_pk_fma_f32 v[178:179], v[178:179], v[130:131], v[128:129] op_sel:[0,0,1] op_sel_hi:[1,0,1]
  v_pk_mul_f32 v[166:167], v[166:167], v[164:165]
  v_pk_mul_f32 v[170:171], v[170:171], v[168:169]
  v_pk_mul_f32 v[174:175], v[174:175], v[172:173]
  v_pk_mul_f32 v[178:179], v[178:179], v[176:177]
  v_exp_f32 v166, v166
  v_exp_f32 v170, v170
  v_exp_f32 v174, v174
  v_exp_f32 v178, v178
  v_exp_f32 v167, v167
  v_exp_f32 v171, v171
  v_exp_f32 v175, v175
  v_exp_f32 v179, v179
  v_pk_fma_f32 v[166:167], v[166:167], v[126:127], v[126:127] op_sel:[0,1,1] op_sel_hi:[1,1,1]
  v_pk_fma_f32 v[170:171], v[170:171], v[126:127], v[126:127] op_sel:[0,1,1] op_sel_hi:[1,1,1]
  v_pk_fma_f32 v[174:175], v[174:175], v[130:131], v[130:131] op_sel:[0,1,1] op_sel_hi:[1,1,1]
  v_pk_fma_f32 v[178:179], v[178:179], v[130:131], v[130:131] op_sel:[0,1,1] op_sel_hi:[1,1,1]
  v_rcp_f32 v166, v166
  v_rcp_f32 v170, v170
  v_rcp_f32 v174, v174
  v_rcp_f32 v178, v178
  v_rcp_f32 v167, v167
  v_rcp_f32 v171, v171
  v_rcp_f32 v175, v175
  v_rcp_f32 v179, v179
  v_pk_mul_f32 v[68:69], v[164:165], v[166:167]
  v_pk_mul_f32 v[70:71], v[168:169], v[170:171]
  v_pk_mul_f32 v[72:73], v[172:173], v[174:175]
  v_pk_mul_f32 v[74:75], v[176:177], v[178:179]
  v_pk_fma_f32 v[164:165], v[136:137], v[124:125], v[20:21] op_sel_hi:[1,0,1] neg_lo:[0,1,0] neg_hi:[0,1,0]
  v_pk_fma_f32 v[168:169], v[138:139], v[124:125], v[22:23] op_sel_hi:[1,0,1] neg_lo:[0,1,0] neg_hi:[0,1,0]
  v_pk_fma_f32 v[172:173], v[136:137], v[128:129], v[24:25] op_sel_hi:[1,0,1] neg_lo:[0,1,0] neg_hi:[0,1,0]
  v_pk_fma_f32 v[176:177], v[138:139], v[128:129], v[26:27] op_sel_hi:[1,0,1] neg_lo:[0,1,0] neg_hi:[0,1,0]
  v_pk_mul_f32 v[166:167], v[164:165], v[164:165]
  v_pk_mul_f32 v[170:171], v[168:169], v[168:169]
  v_pk_mul_f32 v[174:175], v[172:173], v[172:173]
  v_pk_mul_f32 v[178:179], v[176:177], v[176:177]
  v_pk_fma_f32 v[166:167], v[166:167], v[126:127], v[124:125] op_sel:[0,0,1] op_sel_hi:[1,0,1]
  v_pk_fma_f32 v[170:171], v[170:171], v[126:127], v[124:125] op_sel:[0,0,1] op_sel_hi:[1,0,1]
  v_pk_fma_f32 v[174:175], v[174:175], v[130:131], v[128:129] op_sel:[0,0,1] op_sel_hi:[1,0,1]
  v_pk_fma_f32 v[178:179], v[178:179], v[130:131], v[128:129] op_sel:[0,0,1] op_sel_hi:[1,0,1]
  v_pk_mul_f32 v[166:167], v[166:167], v[164:165]
  v_pk_mul_f32 v[170:171], v[170:171], v[168:169]
  v_pk_mul_f32 v[174:175], v[174:175], v[172:173]
  v_pk_mul_f32 v[178:179], v[178:179], v[176:177]
  v_exp_f32 v166, v166
  v_exp_f32 v170, v170
  v_exp_f32 v174, v174
  v_exp_f32 v178, v178
  v_exp_f32 v167, v167
  v_exp_f32 v171, v171
  v_exp_f32 v175, v175
  v_exp_f32 v179, v179
  v_pk_fma_f32 v[166:167], v[166:167], v[126:127], v[126:127] op_sel:[0,1,1] op_sel_hi:[1,1,1]
  v_pk_fma_f32 v[170:171], v[170:171], v[126:127], v[126:127] op_sel:[0,1,1] op_sel_hi:[1,1,1]
  v_pk_fma_f32 v[174:175], v[174:175], v[130:131], v[130:131] op_sel:[0,1,1] op_sel_hi:[1,1,1]
  v_pk_fma_f32 v[178:179], v[178:179], v[130:131], v[130:131] op_sel:[0,1,1] op_sel_hi:[1,1,1]
  v_rcp_f32 v166, v166
  v_rcp_f32 v170, v170
  v_rcp_f32 v174, v174
  v_rcp_f32 v178, v178
  v_rcp_f32 v167, v167
  v_rcp_f32 v171, v171
  v_rcp_f32 v175, v175
  v_rcp_f32 v179, v179
  v_pk_mul_f32 v[76:77], v[164:165], v[166:167]
  v_pk_mul_f32 v[78:79], v[168:169], v[170:171]
  v_pk_mul_f32 v[80:81], v[172:173], v[174:175]
  v_pk_mul_f32 v[82:83], v[176:177], v[178:179]
  v_pk_fma_f32 v[164:165], v[140:141], v[124:125], v[28:29] op_sel_hi:[1,0,1] neg_lo:[0,1,0] neg_hi:[0,1,0]
  v_pk_fma_f32 v[168:169], v[142:143], v[124:125], v[30:31] op_sel_hi:[1,0,1] neg_lo:[0,1,0] neg_hi:[0,1,0]
  v_pk_fma_f32 v[172:173], v[140:141], v[128:129], v[32:33] op_sel_hi:[1,0,1] neg_lo:[0,1,0] neg_hi:[0,1,0]
  v_pk_fma_f32 v[176:177], v[142:143], v[128:129], v[34:35] op_sel_hi:[1,0,1] neg_lo:[0,1,0] neg_hi:[0,1,0]
  v_pk_mul_f32 v[166:167], v[164:165], v[164:165]
  v_pk_mul_f32 v[170:171], v[168:169], v[168:169]
  v_pk_mul_f32 v[174:175], v[172:173], v[172:173]
  v_pk_mul_f32 v[178:179], v[176:177], v[176:177]
  v_pk_fma_f32 v[166:167], v[166:167], v[126:127], v[124:125] op_sel:[0,0,1] op_sel_hi:[1,0,1]
  v_pk_fma_f32 v[170:171], v[170:171], v[126:127], v[124:125] op_sel:[0,0,1] op_sel_hi:[1,0,1]
  v_pk_fma_f32 v[174:175], v[174:175], v[130:131], v[128:129] op_sel:[0,0,1] op_sel_hi:[1,0,1]
  v_pk_fma_f32 v[178:179], v[178:179], v[130:131], v[128:129] op_sel:[0,0,1] op_sel_hi:[1,0,1]
  v_pk_mul_f32 v[166:167], v[166:167], v[164:165]
  v_pk_mul_f32 v[170:171], v[170:171], v[168:169]
  v_pk_mul_f32 v[174:175], v[174:175], v[172:173]
  v_pk_mul_f32 v[178:179], v[178:179], v[176:177]
  v_exp_f32 v166, v166
  v_exp_f32 v170, v170
  v_exp_f32 v174, v174
  v_exp_f32 v178, v178
  v_exp_f32 v167, v167
  v_exp_f32 v171, v171
  v_exp_f32 v175, v175
  v_exp_f32 v179, v179
  v_pk_fma_f32 v[166:167], v[166:167], v[126:127], v[126:127] op_sel:[0,1,1] op_sel_hi:[1,1,1]
  v_pk_fma_f32 v[170:171], v[170:171], v[126:127], v[126:127] op_sel:[0,1,1] op_sel_hi:[1,1,1]
  v_pk_fma_f32 v[174:175], v[174:175], v[130:131], v[130:131] op_sel:[0,1,1] op_sel_hi:[1,1,1]
  v_pk_fma_f32 v[178:179], v[178:179], v[130:131], v[130:131] op_sel:[0,1,1] op_sel_hi:[1,1,1]
  v_rcp_f32 v166, v166
  v_rcp_f32 v170, v170
  v_rcp_f32 v174, v174
  v_rcp_f32 v178, v178
  v_rcp_f32 v167, v167
  v_rcp_f32 v171, v171
  v_rcp_f32 v175, v175
  v_rcp_f32 v179, v179
  v_pk_mul_f32 v[84:85], v[164:165], v[166:167]
  v_pk_mul_f32 v[86:87], v[168:169], v[170:171]
  v_pk_mul_f32 v[88:89], v[172:173], v[174:175]
  v_pk_mul_f32 v[90:91], v[176:177], v[178:179]
  v_pk_fma_f32 v[164:165], v[144:145], v[124:125], v[36:37] op_sel_hi:[1,0,1] neg_lo:[0,1,0] neg_hi:[0,1,0]
  v_pk_fma_f32 v[168:169], v[146:147], v[124:125], v[38:39] op_sel_hi:[1,0,1] neg_lo:[0,1,0] neg_hi:[0,1,0]
  v_pk_fma_f32 v[172:173], v[144:145], v[128:129], v[40:41] op_sel_hi:[1,0,1] neg_lo:[0,1,0] neg_hi:[0,1,0]
  v_pk_fma_f32 v[176:177], v[146:147], v[128:129], v[42:43] op_sel_hi:[1,0,1] neg_lo:[0,1,0] neg_hi:[0,1,0]
  v_pk_mul_f32 v[166:167], v[164:165], v[164:165]
  v_pk_mul_f32 v[170:171], v[168:169], v[168:169]
  v_pk_mul_f32 v[174:175], v[172:173], v[172:173]
  v_pk_mul_f32 v[178:179], v[176:177], v[176:177]
  v_pk_fma_f32 v[166:167], v[166:167], v[126:127], v[124:125] op_sel:[0,0,1] op_sel_hi:[1,0,1]
  v_pk_fma_f32 v[170:171], v[170:171], v[126:127], v[124:125] op_sel:[0,0,1] op_sel_hi:[1,0,1]
  v_pk_fma_f32 v[174:175], v[174:175], v[130:131], v[128:129] op_sel:[0,0,1] op_sel_hi:[1,0,1]
  v_pk_fma_f32 v[178:179], v[178:179], v[130:131], v[128:129] op_sel:[0,0,1] op_sel_hi:[1,0,1]
  v_pk_mul_f32 v[166:167], v[166:167], v[164:165]
  v_pk_mul_f32 v[170:171], v[170:171], v[168:169]
  v_pk_mul_f32 v[174:175], v[174:175], v[172:173]
  v_pk_mul_f32 v[178:179], v[178:179], v[176:177]
  v_exp_f32 v166, v166
  v_exp_f32 v170, v170
  v_exp_f32 v174, v174
  v_exp_f32 v178, v178
  v_exp_f32 v167, v167
  v_exp_f32 v171, v171
  v_exp_f32 v175, v175
  v_exp_f32 v179, v179
  v_pk_fma_f32 v[166:167], v[166:167], v[126:127], v[126:127] op_sel:[0,1,1] op_sel_hi:[1,1,1]
  v_pk_fma_f32 v[170:171], v[170:171], v[126:127], v[126:127] op_sel:[0,1,1] op_sel_hi:[1,1,1]
  v_pk_fma_f32 v[174:175], v[174:175], v[130:131], v[130:131] op_sel:[0,1,1] op_sel_hi:[1,1,1]
  v_pk_fma_f32 v[178:179], v[178:179], v[130:131], v[130:131] op_sel:[0,1,1] op_sel_hi:[1,1,1]
  v_rcp_f32 v166, v166
  v_rcp_f32 v170, v170
  v_rcp_f32 v174, v174
  v_rcp_f32 v178, v178
  v_rcp_f32 v167, v167
  v_rcp_f32 v171, v171
  v_rcp_f32 v175, v175
  v_rcp_f32 v179, v179
  v_pk_mul_f32 v[92:93], v[164:165], v[166:167]
  v_pk_mul_f32 v[94:95], v[168:169], v[170:171]
  v_pk_mul_f32 v[96:97], v[172:173], v[174:175]
  v_pk_mul_f32 v[98:99], v[176:177], v[178:179]
  v_pk_fma_f32 v[164:165], v[148:149], v[124:125], v[44:45] op_sel_hi:[1,0,1] neg_lo:[0,1,0] neg_hi:[0,1,0]
  v_pk_fma_f32 v[168:169], v[150:151], v[124:125], v[46:47] op_sel_hi:[1,0,1] neg_lo:[0,1,0] neg_hi:[0,1,0]
  v_pk_fma_f32 v[172:173], v[148:149], v[128:129], v[48:49] op_sel_hi:[1,0,1] neg_lo:[0,1,0] neg_hi:[0,1,0]
  v_pk_fma_f32 v[176:177], v[150:151], v[128:129], v[50:51] op_sel_hi:[1,0,1] neg_lo:[0,1,0] neg_hi:[0,1,0]
  v_pk_mul_f32 v[166:167], v[164:165], v[164:165]
  v_pk_mul_f32 v[170:171], v[168:169], v[168:169]
  v_pk_mul_f32 v[174:175], v[172:173], v[172:173]
  v_pk_mul_f32 v[178:179], v[176:177], v[176:177]
  v_pk_fma_f32 v[166:167], v[166:167], v[126:127], v[124:125] op_sel:[0,0,1] op_sel_hi:[1,0,1]
  v_pk_fma_f32 v[170:171], v[170:171], v[126:127], v[124:125] op_sel:[0,0,1] op_sel_hi:[1,0,1]
  v_pk_fma_f32 v[174:175], v[174:175], v[130:131], v[128:129] op_sel:[0,0,1] op_sel_hi:[1,0,1]
  v_pk_fma_f32 v[178:179], v[178:179], v[130:131], v[128:129] op_sel:[0,0,1] op_sel_hi:[1,0,1]
  v_pk_mul_f32 v[166:167], v[166:167], v[164:165]
  v_pk_mul_f32 v[170:171], v[170:171], v[168:169]
  v_pk_mul_f32 v[174:175], v[174:175], v[172:173]
  v_pk_mul_f32 v[178:179], v[178:179], v[176:177]
  v_exp_f32 v166, v166
  v_exp_f32 v170, v170
  v_exp_f32 v174, v174
  v_exp_f32 v178, v178
  v_exp_f32 v167, v167
  v_exp_f32 v171, v171
  v_exp_f32 v175, v175
  v_exp_f32 v179, v179
  v_pk_fma_f32 v[166:167], v[166:167], v[126:127], v[126:127] op_sel:[0,1,1] op_sel_hi:[1,1,1]
  v_pk_fma_f32 v[170:171], v[170:171], v[126:127], v[126:127] op_sel:[0,1,1] op_sel_hi:[1,1,1]
  v_pk_fma_f32 v[174:175], v[174:175], v[130:131], v[130:131] op_sel:[0,1,1] op_sel_hi:[1,1,1]
  v_pk_fma_f32 v[178:179], v[178:179], v[130:131], v[130:131] op_sel:[0,1,1] op_sel_hi:[1,1,1]
  v_rcp_f32 v166, v166
  v_rcp_f32 v170, v170
  v_rcp_f32 v174, v174
  v_rcp_f32 v178, v178
  v_rcp_f32 v167, v167
  v_rcp_f32 v171, v171
  v_rcp_f32 v175, v175
  v_rcp_f32 v179, v179
  v_pk_mul_f32 v[100:101], v[164:165], v[166:167]
  v_pk_mul_f32 v[102:103], v[168:169], v[170:171]
  v_pk_mul_f32 v[104:105], v[172:173], v[174:175]
  v_pk_mul_f32 v[106:107], v[176:177], v[178:179]
  v_pk_fma_f32 v[164:165], v[152:153], v[124:125], v[52:53] op_sel_hi:[1,0,1] neg_lo:[0,1,0] neg_hi:[0,1,0]
  v_pk_fma_f32 v[168:169], v[154:155], v[124:125], v[54:55] op_sel_hi:[1,0,1] neg_lo:[0,1,0] neg_hi:[0,1,0]
  v_pk_fma_f32 v[172:173], v[152:153], v[128:129], v[56:57] op_sel_hi:[1,0,1] neg_lo:[0,1,0] neg_hi:[0,1,0]
  v_pk_fma_f32 v[176:177], v[154:155], v[128:129], v[58:59] op_sel_hi:[1,0,1] neg_lo:[0,1,0] neg_hi:[0,1,0]
  v_pk_mul_f32 v[166:167], v[164:165], v[164:165]
  v_pk_mul_f32 v[170:171], v[168:169], v[168:169]
  v_pk_mul_f32 v[174:175], v[172:173], v[172:173]
  v_pk_mul_f32 v[178:179], v[176:177], v[176:177]
  v_pk_fma_f32 v[166:167], v[166:167], v[126:127], v[124:125] op_sel:[0,0,1] op_sel_hi:[1,0,1]
  v_pk_fma_f32 v[170:171], v[170:171], v[126:127], v[124:125] op_sel:[0,0,1] op_sel_hi:[1,0,1]
  v_pk_fma_f32 v[174:175], v[174:175], v[130:131], v[128:129] op_sel:[0,0,1] op_sel_hi:[1,0,1]
  v_pk_fma_f32 v[178:179], v[178:179], v[130:131], v[128:129] op_sel:[0,0,1] op_sel_hi:[1,0,1]
  v_pk_mul_f32 v[166:167], v[166:167], v[164:165]
  v_pk_mul_f32 v[170:171], v[170:171], v[168:169]
  v_pk_mul_f32 v[174:175], v[174:175], v[172:173]
  v_pk_mul_f32 v[178:179], v[178:179], v[176:177]
  v_exp_f32 v166, v166
  v_exp_f32 v170, v170
  v_exp_f32 v174, v174
  v_exp_f32 v178, v178
  v_exp_f32 v167, v167
  v_exp_f32 v171, v171
  v_exp_f32 v175, v175
  v_exp_f32 v179, v179
  v_pk_fma_f32 v[166:167], v[166:167], v[126:127], v[126:127] op_sel:[0,1,1] op_sel_hi:[1,1,1]
  v_pk_fma_f32 v[170:171], v[170:171], v[126:127], v[126:127] op_sel:[0,1,1] op_sel_hi:[1,1,1]
  v_pk_fma_f32 v[174:175], v[174:175], v[130:131], v[130:131] op_sel:[0,1,1] op_sel_hi:[1,1,1]
  v_pk_fma_f32 v[178:179], v[178:179], v[130:131], v[130:131] op_sel:[0,1,1] op_sel_hi:[1,1,1]
  v_rcp_f32 v166, v166
  v_rcp_f32 v170, v170
  v_rcp_f32 v174, v174
  v_rcp_f32 v178, v178
  v_rcp_f32 v167, v167
  v_rcp_f32 v171, v171
  v_rcp_f32 v175, v175
  v_rcp_f32 v179, v179
  v_pk_mul_f32 v[108:109], v[164:165], v[166:167]
  v_pk_mul_f32 v[110:111], v[168:169], v[170:171]
  v_pk_mul_f32 v[112:113], v[172:173], v[174:175]
  v_pk_mul_f32 v[114:115], v[176:177], v[178:179]
  v_pk_fma_f32 v[164:165], v[156:157], v[124:125], v[60:61] op_sel_hi:[1,0,1] neg_lo:[0,1,0] neg_hi:[0,1,0]
  v_pk_fma_f32 v[168:169], v[158:159], v[124:125], v[62:63] op_sel_hi:[1,0,1] neg_lo:[0,1,0] neg_hi:[0,1,0]
  v_pk_fma_f32 v[172:173], v[156:157], v[128:129], v[64:65] op_sel_hi:[1,0,1] neg_lo:[0,1,0] neg_hi:[0,1,0]
  v_pk_fma_f32 v[176:177], v[158:159], v[128:129], v[66:67] op_sel_hi:[1,0,1] neg_lo:[0,1,0] neg_hi:[0,1,0]
  v_pk_mul_f32 v[166:167], v[164:165], v[164:165]
  v_pk_mul_f32 v[170:171], v[168:169], v[168:169]
  v_pk_mul_f32 v[174:175], v[172:173], v[172:173]
  v_pk_mul_f32 v[178:179], v[176:177], v[176:177]
  v_pk_fma_f32 v[166:167], v[166:167], v[126:127], v[124:125] op_sel:[0,0,1] op_sel_hi:[1,0,1]
  v_pk_fma_f32 v[170:171], v[170:171], v[126:127], v[124:125] op_sel:[0,0,1] op_sel_hi:[1,0,1]
  v_pk_fma_f32 v[174:175], v[174:175], v[130:131], v[128:129] op_sel:[0,0,1] op_sel_hi:[1,0,1]
  v_pk_fma_f32 v[178:179], v[178:179], v[130:131], v[128:129] op_sel:[0,0,1] op_sel_hi:[1,0,1]
  v_pk_mul_f32 v[166:167], v[166:167], v[164:165]
  v_pk_mul_f32 v[170:171], v[170:171], v[168:169]
  v_pk_mul_f32 v[174:175], v[174:175], v[172:173]
  v_pk_mul_f32 v[178:179], v[178:179], v[176:177]
  v_exp_f32 v166, v166
  v_exp_f32 v170, v170
  v_exp_f32 v174, v174
  v_exp_f32 v178, v178
  v_exp_f32 v167, v167
  v_exp_f32 v171, v171
  v_exp_f32 v175, v175
  v_exp_f32 v179, v179
  v_pk_fma_f32 v[166:167], v[166:167], v[126:127], v[126:127] op_sel:[0,1,1] op_sel_hi:[1,1,1]
  v_pk_fma_f32 v[170:171], v[170:171], v[126:127], v[126:127] op_sel:[0,1,1] op_sel_hi:[1,1,1]
  v_pk_fma_f32 v[174:175], v[174:175], v[130:131], v[130:131] op_sel:[0,1,1] op_sel_hi:[1,1,1]
  v_pk_fma_f32 v[178:179], v[178:179], v[130:131], v[130:131] op_sel:[0,1,1] op_sel_hi:[1,1,1]
  v_rcp_f32 v166, v166
  v_rcp_f32 v170, v170
  v_rcp_f32 v174, v174
  v_rcp_f32 v178, v178
  v_rcp_f32 v167, v167
  v_rcp_f32 v171, v171
  v_rcp_f32 v175, v175
  v_rcp_f32 v179, v179
  v_pk_mul_f32 v[116:117], v[164:165], v[166:167]
  v_pk_mul_f32 v[118:119], v[168:169], v[170:171]
  v_pk_mul_f32 v[120:121], v[172:173], v[174:175]
  v_pk_mul_f32 v[122:123], v[176:177], v[178:179]
  v_pk_mul_f32 v[200:201], v[68:69], v[68:69]
  v_mov_b32 v196, v68
  v_mov_b32 v197, v69
  v_pk_add_f32 v[196:197], v[196:197], v[70:71]
  v_pk_fma_f32 v[200:201], v[70:71], v[70:71], v[200:201]
  v_pk_add_f32 v[196:197], v[196:197], v[76:77]
  v_pk_fma_f32 v[200:201], v[76:77], v[76:77], v[200:201]
  v_pk_add_f32 v[196:197], v[196:197], v[78:79]
  v_pk_fma_f32 v[200:201], v[78:79], v[78:79], v[200:201]
  v_pk_add_f32 v[196:197], v[196:197], v[84:85]
  v_pk_fma_f32 v[200:201], v[84:85], v[84:85], v[200:201]
  v_pk_add_f32 v[196:197], v[196:197], v[86:87]
  v_pk_fma_f32 v[200:201], v[86:87], v[86:87], v[200:201]
  v_pk_add_f32 v[196:197], v[196:197], v[92:93]
  v_pk_fma_f32 v[200:201], v[92:93], v[92:93], v[200:201]
  v_pk_add_f32 v[196:197], v[196:197], v[94:95]
  v_pk_fma_f32 v[200:201], v[94:95], v[94:95], v[200:201]
  v_pk_add_f32 v[196:197], v[196:197], v[100:101]
  v_pk_fma_f32 v[200:201], v[100:101], v[100:101], v[200:201]
  v_pk_add_f32 v[196:197], v[196:197], v[102:103]
  v_pk_fma_f32 v[200:201], v[102:103], v[102:103], v[200:201]
  v_pk_add_f32 v[196:197], v[196:197], v[108:109]
  v_pk_fma_f32 v[200:201], v[108:109], v[108:109], v[200:201]
  v_pk_add_f32 v[196:197], v[196:197], v[110:111]
  v_pk_fma_f32 v[200:201], v[110:111], v[110:111], v[200:201]
  v_pk_add_f32 v[196:197], v[196:197], v[116:117]
  v_pk_fma_f32 v[200:201], v[116:117], v[116:117], v[200:201]
  v_pk_add_f32 v[196:197], v[196:197], v[118:119]
  v_pk_fma_f32 v[200:201], v[118:119], v[118:119], v[200:201]
  v_pk_mul_f32 v[202:203], v[72:73], v[72:73]
  v_mov_b32 v198, v72
  v_mov_b32 v199, v73
  v_pk_add_f32 v[198:199], v[198:199], v[74:75]
  v_pk_fma_f32 v[202:203], v[74:75], v[74:75], v[202:203]
  v_pk_add_f32 v[198:199], v[198:199], v[80:81]
  v_pk_fma_f32 v[202:203], v[80:81], v[80:81], v[202:203]
  v_pk_add_f32 v[198:199], v[198:199], v[82:83]
  v_pk_fma_f32 v[202:203], v[82:83], v[82:83], v[202:203]
  v_pk_add_f32 v[198:199], v[198:199], v[88:89]
  v_pk_fma_f32 v[202:203], v[88:89], v[88:89], v[202:203]
  v_pk_add_f32 v[198:199], v[198:199], v[90:91]
  v_pk_fma_f32 v[202:203], v[90:91], v[90:91], v[202:203]
  v_pk_add_f32 v[198:199], v[198:199], v[96:97]
  v_pk_fma_f32 v[202:203], v[96:97], v[96:97], v[202:203]
  v_pk_add_f32 v[198:199], v[198:199], v[98:99]
  v_pk_fma_f32 v[202:203], v[98:99], v[98:99], v[202:203]
  v_pk_add_f32 v[198:199], v[198:199], v[104:105]
  v_pk_fma_f32 v[202:203], v[104:105], v[104:105], v[202:203]
  v_pk_add_f32 v[198:199], v[198:199], v[106:107]
  v_pk_fma_f32 v[202:203], v[106:107], v[106:107], v[202:203]
  v_pk_add_f32 v[198:199], v[198:199], v[112:113]
  v_pk_fma_f32 v[202:203], v[112:113], v[112:113], v[202:203]
  v_pk_add_f32 v[198:199], v[198:199], v[114:115]
  v_pk_fma_f32 v[202:203], v[114:115], v[114:115], v[202:203]
  v_pk_add_f32 v[198:199], v[198:199], v[120:121]
  v_pk_fma_f32 v[202:203], v[120:121], v[120:121], v[202:203]
  v_pk_add_f32 v[198:199], v[198:199], v[122:123]
  v_pk_fma_f32 v[202:203], v[122:123], v[122:123], v[202:203]
  v_add_f32 v208, v196, v197
  v_add_f32 v210, v200, v201
  v_add_f32 v209, v198, v199
  v_add_f32 v211, v202, v203
  s_nop 0
  v_permlane16_swap_b32 v208, v209
  v_add_f32 v208, v208, v209
  v_mov_b32 v209, v208
  s_nop 1
  v_permlane32_swap_b32 v208, v209
  v_add_f32 v204, v208, v209
  v_permlane16_swap_b32 v210, v211
  v_add_f32 v210, v210, v211
  v_mov_b32 v211, v210
  s_nop 1
  v_permlane32_swap_b32 v210, v211
  v_add_f32 v206, v210, v211
  v_mov_b32 v205, s22
  v_mov_b32 v207, s22
  s_add_u32 s40, s4, 0x2500000
  s_addc_u32 s41, s5, 0x0
  s_mov_b32 s42, 0x80000
  s_mov_b32 s43, 0x20000
  s_lshl_b32 s49, s44, 15
  s_lshl_b32 s50, s46, 9
  s_add_u32 s49, s49, s50
  v_and_b32 v5, 31, v0
  v_lshlrev_b32 v5, 4, v5
  v_add_u32 v7, s49, v5
  s_lshl_b32 s50, s45, 11
  s_mov_b32 exec_hi, 0
  buffer_store_dwordx4 v[204:207], v7, s[40:43], s50 offen sc1
  s_mov_b64 exec, -1
  v_lshrrev_b32 v5, 5, v0
  v_lshl_add_u32 v7, v5, 11, v7
  v_mov_b32 v12, 0
  v_mov_b32 v13, 0
  v_mov_b32 v14, 0
  v_mov_b32 v15, 0
  v_mov_b32 v16, 0
  v_mov_b32 v17, 0
  v_mov_b32 v18, 0
  v_mov_b32 v19, 0
  v_mov_b32 v20, 0
  v_mov_b32 v21, 0
  v_mov_b32 v22, 0
  v_mov_b32 v23, 0
  v_mov_b32 v24, 0
  v_mov_b32 v25, 0
  v_mov_b32 v26, 0
  v_mov_b32 v27, 0
  v_mov_b32 v28, 0
  v_mov_b32 v29, 0
  v_mov_b32 v30, 0
  v_mov_b32 v31, 0
  v_mov_b32 v32, 0
  v_mov_b32 v33, 0
  v_mov_b32 v34, 0
  v_mov_b32 v35, 0
  v_mov_b32 v36, 0
  v_mov_b32 v37, 0
  v_mov_b32 v38, 0
  v_mov_b32 v39, 0
  v_mov_b32 v40, 0
  v_mov_b32 v41, 0
  v_mov_b32 v42, 0
  v_mov_b32 v43, 0
  v_mov_b32 v44, 0
  v_mov_b32 v45, 0
  v_mov_b32 v46, 0
  v_mov_b32 v47, 0
  v_mov_b32 v48, 0
  v_mov_b32 v49, 0
  v_mov_b32 v50, 0
  v_mov_b32 v51, 0
  v_mov_b32 v52, 0
  v_mov_b32 v53, 0
  v_mov_b32 v54, 0
  v_mov_b32 v55, 0
  v_mov_b32 v56, 0
  v_mov_b32 v57, 0
  v_mov_b32 v58, 0
  v_mov_b32 v59, 0
  v_mov_b32 v60, 0
  v_mov_b32 v61, 0
  v_mov_b32 v62, 0
  v_mov_b32 v63, 0
  v_mov_b32 v64, 0
  v_mov_b32 v65, 0
  v_mov_b32 v66, 0
  v_mov_b32 v67, 0
  ds_read_b64_tr_b16 v[132:133], v3 offset:0
  ds_read_b64_tr_b16 v[134:135], v3 offset:1792
  ds_read_b128 v[124:127], v1 offset:0
  ds_read_b128 v[128:131], v1 offset:2048
  ds_read_b64_tr_b16 v[136:137], v3 offset:32
  ds_read_b64_tr_b16 v[138:139], v3 offset:1824
  ds_read_b64_tr_b16 v[140:141], v3 offset:64
  ds_read_b64_tr_b16 v[142:143], v3 offset:1856
  ds_read_b64_tr_b16 v[144:145], v3 offset:96
  ds_read_b64_tr_b16 v[146:147], v3 offset:1888
  ds_read_b64_tr_b16 v[148:149], v3 offset:128
  ds_read_b64_tr_b16 v[150:151], v3 offset:1920
  ds_read_b64_tr_b16 v[152:153], v3 offset:160
  ds_read_b64_tr_b16 v[154:155], v3 offset:1952
  ds_read_b64_tr_b16 v[156:157], v3 offset:192
  ds_read_b64_tr_b16 v[158:159], v3 offset:1984
  s_mov_b32 s52, 3
  s_call_b64 s[84:85], p3s_loop
  s_mov_b32 s47, 0
  buffer_load_dwordx4 v[212:215], v7, s[40:43], s47 offen sc1
  s_mov_b32 s47, 4096
  buffer_load_dwordx4 v[216:219], v7, s[40:43], s47 offen sc1
  s_mov_b32 s47, 8192
  buffer_load_dwordx4 v[220:223], v7, s[40:43], s47 offen sc1
  s_mov_b32 s47, 12288
  buffer_load_dwordx4 v[224:227], v7, s[40:43], s47 offen sc1
  s_mov_b32 s47, 16384
  buffer_load_dwordx4 v[228:231], v7, s[40:43], s47 offen sc1
  s_mov_b32 s47, 20480
  buffer_load_dwordx4 v[232:235], v7, s[40:43], s47 offen sc1
  s_mov_b32 s47, 24576
  buffer_load_dwordx4 v[236:239], v7, s[40:43], s47 offen sc1
  s_mov_b32 s47, 28672
  buffer_load_dwordx4 v[240:243], v7, s[40:43], s47 offen sc1
  s_mov_b32 s52, 2
  s_call_b64 s[84:85], p3s_loop
  s_mov_b32 s63, 100000
p3_poll:
  s_waitcnt vmcnt(0)
  v_xor_b32 v6, s22, v213
  v_xor_b32 v5, s22, v215
  v_or_b32 v6, v6, v5
  v_xor_b32 v5, s22, v217
  v_or_b32 v6, v6, v5
  v_xor_b32 v5, s22, v219
  v_or_b32 v6, v6, v5
  v_xor_b32 v5, s22, v221
  v_or_b32 v6, v6, v5
  v_xor_b32 v5, s22, v223
  v_or_b32 v6, v6, v5
  v_xor_b32 v5, s22, v225
  v_or_b32 v6, v6, v5
  v_xor_b32 v5, s22, v227
  v_or_b32 v6, v6, v5
  v_xor_b32 v5, s22, v229
  v_or_b32 v6, v6, v5
  v_xor_b32 v5, s22, v231
  v_or_b32 v6, v6, v5
  v_xor_b32 v5, s22, v233
  v_or_b32 v6, v6, v5
  v_xor_b32 v5, s22, v235
  v_or_b32 v6, v6, v5
  v_xor_b32 v5, s22, v237
  v_or_b32 v6, v6, v5
  v_xor_b32 v5, s22, v239
  v_or_b32 v6, v6, v5
  v_xor_b32 v5, s22, v241
  v_or_b32 v6, v6, v5
  v_xor_b32 v5, s22, v243
  v_or_b32 v6, v6, v5
  v_cmp_ne_u32 vcc, 0, v6
  s_sub_u32 s63, s63, 1
  s_cmp_eq_u32 s63, 0
  s_cbranch_scc1 p3_polldone
  s_cmp_eq_u64 vcc, 0
  s_cbranch_scc1 p3_polldone
  s_mov_b32 s47, 0
  buffer_load_dwordx4 v[212:215], v7, s[40:43], s47 offen sc1
  s_mov_b32 s47, 4096
  buffer_load_dwordx4 v[216:219], v7, s[40:43], s47 offen sc1
  s_mov_b32 s47, 8192
  buffer_load_dwordx4 v[220:223], v7, s[40:43], s47 offen sc1
  s_mov_b32 s47, 12288
  buffer_load_dwordx4 v[224:227], v7, s[40:43], s47 offen sc1
  s_mov_b32 s47, 16384
  buffer_load_dwordx4 v[228:231], v7, s[40:43], s47 offen sc1
  s_mov_b32 s47, 20480
  buffer_load_dwordx4 v[232:235], v7, s[40:43], s47 offen sc1
  s_mov_b32 s47, 24576
  buffer_load_dwordx4 v[236:239], v7, s[40:43], s47 offen sc1
  s_mov_b32 s47, 28672
  buffer_load_dwordx4 v[240:243], v7, s[40:43], s47 offen sc1
  s_branch p3_poll
p3_polldone:
  v_add_f32 v212, v212, v216
  v_add_f32 v214, v214, v218
  v_add_f32 v212, v212, v220
  v_add_f32 v214, v214, v222
  v_add_f32 v212, v212, v224
  v_add_f32 v214, v214, v226
  v_add_f32 v212, v212, v228
  v_add_f32 v214, v214, v230
  v_add_f32 v212, v212, v232
  v_add_f32 v214, v214, v234
  v_add_f32 v212, v212, v236
  v_add_f32 v214, v214, v238
  v_add_f32 v212, v212, v240
  v_add_f32 v214, v214, v242
  v_mov_b32 v213, v212
  s_nop 1
  v_permlane32_swap_b32 v212, v213
  v_add_f32 v212, v212, v213
  v_mov_b32 v215, v214
  s_nop 1
  v_permlane32_swap_b32 v214, v215
  v_add_f32 v214, v214, v215
  v_mul_f32 v196, 0x3a124925, v212
  v_mul_f32 v197, 0x3a124925, v214
  v_fma_f32 v197, -v196, v196, v197
  v_max_f32 v197, 0, v197
  v_add_f32 v197, 0x3727c5ac, v197
  v_rsq_f32 v197, v197
  s_nop 0
  v_mul_f32 v196, v196, v197
  v_mov_b32 v200, v197
  v_mov_b32 v202, v197
  v_mov_b32 v201, v196
  v_mov_b32 v203, v196
  v_permlane16_swap_b32 v200, v202
  s_nop 0
  v_permlane16_swap_b32 v201, v203
  s_add_u32 s36, s4, 0x1400000
  s_addc_u32 s37, s5, 0x0
  s_mov_b32 s38, 0x700000
  s_mov_b32 s39, 0x20000
  s_lshl_b32 s50, s45, 5
  s_lshl_b32 s49, s44, 1
  s_lshr_b32 s47, s46, 1
  s_add_u32 s49, s49, s47
  s_add_u32 s49, s49, s50
  s_mul_i32 s49, s49, 14336
  s_and_b32 s47, s46, 1
  s_mul_i32 s47, s47, 7168
  s_add_u32 s49, s49, s47
  v_bfe_u32 v5, v0, 2, 1
  v_lshlrev_b32 v5, 9, v5
  v_bfe_u32 v6, v0, 3, 1
  v_lshl_add_u32 v5, v6, 7, v5
  v_and_b32 v6, 3, v0
  v_lshl_add_u32 v5, v6, 5, v5
  v_add_u32 v5, s49, v5
  v_lshrrev_b32 v6, 4, v0
  v_lshl_add_u32 v204, v6, 3, v5
  v_bfe_u32 v6, v0, 4, 1
  v_lshl_add_u32 v205, v6, 10, v5
  v_lshrrev_b32 v6, 5, v0
  v_lshl_add_u32 v205, v6, 4, v205
  v_pk_fma_f32 v[68:69], v[68:69], v[200:201], v[200:201] op_sel:[0,0,1] op_sel_hi:[1,0,1] neg_lo:[0,0,1] neg_hi:[0,0,1]
  v_pk_fma_f32 v[70:71], v[70:71], v[200:201], v[200:201] op_sel:[0,0,1] op_sel_hi:[1,0,1] neg_lo:[0,0,1] neg_hi:[0,0,1]
  v_cvt_pk_bf16_f32 v160, v68, v69
  v_cvt_pk_bf16_f32 v161, v70, v71
  v_pk_fma_f32 v[76:77], v[76:77], v[200:201], v[200:201] op_sel:[0,0,1] op_sel_hi:[1,0,1] neg_lo:[0,0,1] neg_hi:[0,0,1]
  v_pk_fma_f32 v[78:79], v[78:79], v[200:201], v[200:201] op_sel:[0,0,1] op_sel_hi:[1,0,1] neg_lo:[0,0,1] neg_hi:[0,0,1]
  v_cvt_pk_bf16_f32 v162, v76, v77
  v_cvt_pk_bf16_f32 v163, v78, v79
  s_nop 0
  v_permlane16_swap_b32 v160, v162
  v_permlane16_swap_b32 v161, v163
  s_mov_b32 s47, 0
  buffer_store_dwordx4 v[160:163], v205, s[36:39], s47 offen sc1
  v_pk_fma_f32 v[84:85], v[84:85], v[200:201], v[200:201] op_sel:[0,0,1] op_sel_hi:[1,0,1] neg_lo:[0,0,1] neg_hi:[0,0,1]
  v_pk_fma_f32 v[86:87], v[86:87], v[200:201], v[200:201] op_sel:[0,0,1] op_sel_hi:[1,0,1] neg_lo:[0,0,1] neg_hi:[0,0,1]
  v_cvt_pk_bf16_f32 v164, v84, v85
  v_cvt_pk_bf16_f32 v165, v86, v87
  v_pk_fma_f32 v[92:93], v[92:93], v[200:201], v[200:201] op_sel:[0,0,1] op_sel_hi:[1,0,1] neg_lo:[0,0,1] neg_hi:[0,0,1]
  v_pk_fma_f32 v[94:95], v[94:95], v[200:201], v[200:201] op_sel:[0,0,1] op_sel_hi:[1,0,1] neg_lo:[0,0,1] neg_hi:[0,0,1]
  v_cvt_pk_bf16_f32 v166, v92, v93
  v_cvt_pk_bf16_f32 v167, v94, v95
  s_nop 0
  v_permlane16_swap_b32 v164, v166
  v_permlane16_swap_b32 v165, v167
  s_mov_b32 s47, 2048
  buffer_store_dwordx4 v[164:167], v205, s[36:39], s47 offen sc1
  v_pk_fma_f32 v[100:101], v[100:101], v[200:201], v[200:201] op_sel:[0,0,1] op_sel_hi:[1,0,1] neg_lo:[0,0,1] neg_hi:[0,0,1]
  v_pk_fma_f32 v[102:103], v[102:103], v[200:201], v[200:201] op_sel:[0,0,1] op_sel_hi:[1,0,1] neg_lo:[0,0,1] neg_hi:[0,0,1]
  v_cvt_pk_bf16_f32 v168, v100, v101
  v_cvt_pk_bf16_f32 v169, v102, v103
  v_pk_fma_f32 v[108:109], v[108:109], v[200:201], v[200:201] op_sel:[0,0,1] op_sel_hi:[1,0,1] neg_lo:[0,0,1] neg_hi:[0,0,1]
  v_pk_fma_f32 v[110:111], v[110:111], v[200:201], v[200:201] op_sel:[0,0,1] op_sel_hi:[1,0,1] neg_lo:[0,0,1] neg_hi:[0,0,1]
  v_cvt_pk_bf16_f32 v170, v108, v109
  v_cvt_pk_bf16_f32 v171, v110, v111
  s_nop 0
  v_permlane16_swap_b32 v168, v170
  v_permlane16_swap_b32 v169, v171
  s_mov_b32 s47, 4096
  buffer_store_dwordx4 v[168:171], v205, s[36:39], s47 offen sc1
  v_pk_fma_f32 v[116:117], v[116:117], v[200:201], v[200:201] op_sel:[0,0,1] op_sel_hi:[1,0,1] neg_lo:[0,0,1] neg_hi:[0,0,1]
  v_pk_fma_f32 v[118:119], v[118:119], v[200:201], v[200:201] op_sel:[0,0,1] op_sel_hi:[1,0,1] neg_lo:[0,0,1] neg_hi:[0,0,1]
  v_cvt_pk_bf16_f32 v172, v116, v117
  v_cvt_pk_bf16_f32 v173, v118, v119
  s_mov_b32 s47, 6144
  buffer_store_dwordx2 v[172:173], v204, s[36:39], s47 offen sc1
  v_pk_fma_f32 v[72:73], v[72:73], v[202:203], v[202:203] op_sel:[0,0,1] op_sel_hi:[1,0,1] neg_lo:[0,0,1] neg_hi:[0,0,1]
  v_pk_fma_f32 v[74:75], v[74:75], v[202:203], v[202:203] op_sel:[0,0,1] op_sel_hi:[1,0,1] neg_lo:[0,0,1] neg_hi:[0,0,1]
  v_cvt_pk_bf16_f32 v176, v72, v73
  v_cvt_pk_bf16_f32 v177, v74, v75
  v_pk_fma_f32 v[80:81], v[80:81], v[202:203], v[202:203] op_sel:[0,0,1] op_sel_hi:[1,0,1] neg_lo:[0,0,1] neg_hi:[0,0,1]
  v_pk_fma_f32 v[82:83], v[82:83], v[202:203], v[202:203] op_sel:[0,0,1] op_sel_hi:[1,0,1] neg_lo:[0,0,1] neg_hi:[0,0,1]
  v_cvt_pk_bf16_f32 v178, v80, v81
  v_cvt_pk_bf16_f32 v179, v82, v83
  s_nop 0
  v_permlane16_swap_b32 v176, v178
  v_permlane16_swap_b32 v177, v179
  s_mov_b32 s47, 256
  buffer_store_dwordx4 v[176:179], v205, s[36:39], s47 offen sc1
  v_pk_fma_f32 v[88:89], v[88:89], v[202:203], v[202:203] op_sel:[0,0,1] op_sel_hi:[1,0,1] neg_lo:[0,0,1] neg_hi:[0,0,1]
  v_pk_fma_f32 v[90:91], v[90:91], v[202:203], v[202:203] op_sel:[0,0,1] op_sel_hi:[1,0,1] neg_lo:[0,0,1] neg_hi:[0,0,1]
  v_cvt_pk_bf16_f32 v180, v88, v89
  v_cvt_pk_bf16_f32 v181, v90, v91
  v_pk_fma_f32 v[96:97], v[96:97], v[202:203], v[202:203] op_sel:[0,0,1] op_sel_hi:[1,0,1] neg_lo:[0,0,1] neg_hi:[0,0,1]
  v_pk_fma_f32 v[98:99], v[98:99], v[202:203], v[202:203] op_sel:[0,0,1] op_sel_hi:[1,0,1] neg_lo:[0,0,1] neg_hi:[0,0,1]
  v_cvt_pk_bf16_f32 v182, v96, v97
  v_cvt_pk_bf16_f32 v183, v98, v99
  s_nop 0
  v_permlane16_swap_b32 v180, v182
  v_permlane16_swap_b32 v181, v183
  s_mov_b32 s47, 2304
  buffer_store_dwordx4 v[180:183], v205, s[36:39], s47 offen sc1
  v_pk_fma_f32 v[104:105], v[104:105], v[202:203], v[202:203] op_sel:[0,0,1] op_sel_hi:[1,0,1] neg_lo:[0,0,1] neg_hi:[0,0,1]
  v_pk_fma_f32 v[106:107], v[106:107], v[202:203], v[202:203] op_sel:[0,0,1] op_sel_hi:[1,0,1] neg_lo:[0,0,1] neg_hi:[0,0,1]
  v_cvt_pk_bf16_f32 v184, v104, v105
  v_cvt_pk_bf16_f32 v185, v106, v107
  v_pk_fma_f32 v[112:113], v[112:113], v[202:203], v[202:203] op_sel:[0,0,1] op_sel_hi:[1,0,1] neg_lo:[0,0,1] neg_hi:[0,0,1]
  v_pk_fma_f32 v[114:115], v[114:115], v[202:203], v[202:203] op_sel:[0,0,1] op_sel_hi:[1,0,1] neg_lo:[0,0,1] neg_hi:[0,0,1]
  v_cvt_pk_bf16_f32 v186, v112, v113
  v_cvt_pk_bf16_f32 v187, v114, v115
  s_nop 0
  v_permlane16_swap_b32 v184, v186
  v_permlane16_swap_b32 v185, v187
  s_mov_b32 s47, 4352
  buffer_store_dwordx4 v[184:187], v205, s[36:39], s47 offen sc1
  v_pk_fma_f32 v[120:121], v[120:121], v[202:203], v[202:203] op_sel:[0,0,1] op_sel_hi:[1,0,1] neg_lo:[0,0,1] neg_hi:[0,0,1]
  v_pk_fma_f32 v[122:123], v[122:123], v[202:203], v[202:203] op_sel:[0,0,1] op_sel_hi:[1,0,1] neg_lo:[0,0,1] neg_hi:[0,0,1]
  v_cvt_pk_bf16_f32 v188, v120, v121
  v_cvt_pk_bf16_f32 v189, v122, v123
  s_mov_b32 s47, 6400
  buffer_store_dwordx2 v[188:189], v204, s[36:39], s47 offen sc1
  s_nop 1
  s_mov_b32 s52, 4
  s_call_b64 s[84:85], p3s_loop
  s_lshl_b32 s63, s44, 2
  s_add_u32 s63, s63, s46
  s_waitcnt vmcnt(0)
  s_lshl_b32 s47, s45, 8
  s_lshl_b32 s48, s63, 2
  s_add_u32 s47, s47, s48
  s_add_u32 s47, s47, 8192
  v_mov_b32 v5, s22
  v_mov_b32 v6, 0
  s_mov_b64 exec, 1
  buffer_store_dword v5, v6, s[64:67], s47 offen sc1
  s_mov_b64 exec, -1
  s_mov_b32 s52, 7
  s_call_b64 s[84:85], p3s_loop
  s_waitcnt lgkmcnt(0)
  v_and_b32 v5, 15, v0
  v_lshlrev_b32 v5, 4, v5
  s_lshl_b32 s49, s46, 9
  s_add_u32 s49, s49, 154880
  v_add_u32 v5, s49, v5
  ds_read_b128 v[124:127], v5 offset:0
  ds_read_b128 v[128:131], v5 offset:256
  v_lshrrev_b32 v5, 4, v0
  v_lshlrev_b32 v5, 4, v5
  v_add_u32 v5, 157376, v5
  ds_read_b128 v[132:135], v5 offset:0
  ds_read_b128 v[136:139], v5 offset:64
  ds_read_b128 v[140:143], v5 offset:128
  ds_read_b128 v[144:147], v5 offset:192
  ds_read_b128 v[148:151], v5 offset:256
  ds_read_b128 v[152:155], v5 offset:320
  ds_read_b128 v[156:159], v5 offset:384
  s_waitcnt lgkmcnt(0)
  v_pk_fma_f32 v[164:165], v[132:133], v[124:125], v[12:13] op_sel_hi:[1,0,1] neg_lo:[0,1,0] neg_hi:[0,1,0]
  v_pk_fma_f32 v[168:169], v[134:135], v[124:125], v[14:15] op_sel_hi:[1,0,1] neg_lo:[0,1,0] neg_hi:[0,1,0]
  v_pk_fma_f32 v[172:173], v[132:133], v[128:129], v[16:17] op_sel_hi:[1,0,1] neg_lo:[0,1,0] neg_hi:[0,1,0]
  v_pk_fma_f32 v[176:177], v[134:135], v[128:129], v[18:19] op_sel_hi:[1,0,1] neg_lo:[0,1,0] neg_hi:[0,1,0]
  v_pk_mul_f32 v[166:167], v[164:165], v[164:165]
  v_pk_mul_f32 v[170:171], v[168:169], v[168:169]
  v_pk_mul_f32 v[174:175], v[172:173], v[172:173]
  v_pk_mul_f32 v[178:179], v[176:177], v[176:177]
  v_pk_fma_f32 v[166:167], v[166:167], v[126:127], v[124:125] op_sel:[0,0,1] op_sel_hi:[1,0,1]
  v_pk_fma_f32 v[170:171], v[170:171], v[126:127], v[124:125] op_sel:[0,0,1] op_sel_hi:[1,0,1]
  v_pk_fma_f32 v[174:175], v[174:175], v[130:131], v[128:129] op_sel:[0,0,1] op_sel_hi:[1,0,1]
  v_pk_fma_f32 v[178:179], v[178:179], v[130:131], v[128:129] op_sel:[0,0,1] op_sel_hi:[1,0,1]
  v_pk_mul_f32 v[166:167], v[166:167], v[164:165]
  v_pk_mul_f32 v[170:171], v[170:171], v[168:169]
  v_pk_mul_f32 v[174:175], v[174:175], v[172:173]
  v_pk_mul_f32 v[178:179], v[178:179], v[176:177]
  v_exp_f32 v166, v166
  v_exp_f32 v170, v170
  v_exp_f32 v174, v174
  v_exp_f32 v178, v178
  v_exp_f32 v167, v167
  v_exp_f32 v171, v171
  v_exp_f32 v175, v175
  v_exp_f32 v179, v179
  v_pk_fma_f32 v[166:167], v[166:167], v[126:127], v[126:127] op_sel:[0,1,1] op_sel_hi:[1,1,1]
  v_pk_fma_f32 v[170:171], v[170:171], v[126:127], v[126:127] op_sel:[0,1,1] op_sel_hi:[1,1,1]
  v_pk_fma_f32 v[174:175], v[174:175], v[130:131], v[130:131] op_sel:[0,1,1] op_sel_hi:[1,1,1]
  v_pk_fma_f32 v[178:179], v[178:179], v[130:131], v[130:131] op_sel:[0,1,1] op_sel_hi:[1,1,1]
  v_rcp_f32 v166, v166
  v_rcp_f32 v170, v170
  v_rcp_f32 v174, v174
  v_rcp_f32 v178, v178
  v_rcp_f32 v167, v167
  v_rcp_f32 v171, v171
  v_rcp_f32 v175, v175
  v_rcp_f32 v179, v179
  v_pk_mul_f32 v[12:13], v[164:165], v[166:167]
  v_pk_mul_f32 v[14:15], v[168:169], v[170:171]
  v_pk_mul_f32 v[16:17], v[172:173], v[174:175]
  v_pk_mul_f32 v[18:19], v[176:177], v[178:179]
  v_pk_fma_f32 v[164:165], v[136:137], v[124:125], v[20:21] op_sel_hi:[1,0,1] neg_lo:[0,1,0] neg_hi:[0,1,0]
  v_pk_fma_f32 v[168:169], v[138:139], v[124:125], v[22:23] op_sel_hi:[1,0,1] neg_lo:[0,1,0] neg_hi:[0,1,0]
  v_pk_fma_f32 v[172:173], v[136:137], v[128:129], v[24:25] op_sel_hi:[1,0,1] neg_lo:[0,1,0] neg_hi:[0,1,0]
  v_pk_fma_f32 v[176:177], v[138:139], v[128:129], v[26:27] op_sel_hi:[1,0,1] neg_lo:[0,1,0] neg_hi:[0,1,0]
  v_pk_mul_f32 v[166:167], v[164:165], v[164:165]
  v_pk_mul_f32 v[170:171], v[168:169], v[168:169]
  v_pk_mul_f32 v[174:175], v[172:173], v[172:173]
  v_pk_mul_f32 v[178:179], v[176:177], v[176:177]
  v_pk_fma_f32 v[166:167], v[166:167], v[126:127], v[124:125] op_sel:[0,0,1] op_sel_hi:[1,0,1]
  v_pk_fma_f32 v[170:171], v[170:171], v[126:127], v[124:125] op_sel:[0,0,1] op_sel_hi:[1,0,1]
  v_pk_fma_f32 v[174:175], v[174:175], v[130:131], v[128:129] op_sel:[0,0,1] op_sel_hi:[1,0,1]
  v_pk_fma_f32 v[178:179], v[178:179], v[130:131], v[128:129] op_sel:[0,0,1] op_sel_hi:[1,0,1]
  v_pk_mul_f32 v[166:167], v[166:167], v[164:165]
  v_pk_mul_f32 v[170:171], v[170:171], v[168:169]
  v_pk_mul_f32 v[174:175], v[174:175], v[172:173]
  v_pk_mul_f32 v[178:179], v[178:179], v[176:177]
  v_exp_f32 v166, v166
  v_exp_f32 v170, v170
  v_exp_f32 v174, v174
  v_exp_f32 v178, v178
  v_exp_f32 v167, v167
  v_exp_f32 v171, v171
  v_exp_f32 v175, v175
  v_exp_f32 v179, v179
  v_pk_fma_f32 v[166:167], v[166:167], v[126:127], v[126:127] op_sel:[0,1,1] op_sel_hi:[1,1,1]
  v_pk_fma_f32 v[170:171], v[170:171], v[126:127], v[126:127] op_sel:[0,1,1] op_sel_hi:[1,1,1]
  v_pk_fma_f32 v[174:175], v[174:175], v[130:131], v[130:131] op_sel:[0,1,1] op_sel_hi:[1,1,1]
  v_pk_fma_f32 v[178:179], v[178:179], v[130:131], v[130:131] op_sel:[0,1,1] op_sel_hi:[1,1,1]
  v_rcp_f32 v166, v166
  v_rcp_f32 v170, v170
  v_rcp_f32 v174, v174
  v_rcp_f32 v178, v178
  v_rcp_f32 v167, v167
  v_rcp_f32 v171, v171
  v_rcp_f32 v175, v175
  v_rcp_f32 v179, v179
  v_pk_mul_f32 v[20:21], v[164:165], v[166:167]
  v_pk_mul_f32 v[22:23], v[168:169], v[170:171]
  v_pk_mul_f32 v[24:25], v[172:173], v[174:175]
  v_pk_mul_f32 v[26:27], v[176:177], v[178:179]
  v_pk_fma_f32 v[164:165], v[140:141], v[124:125], v[28:29] op_sel_hi:[1,0,1] neg_lo:[0,1,0] neg_hi:[0,1,0]
  v_pk_fma_f32 v[168:169], v[142:143], v[124:125], v[30:31] op_sel_hi:[1,0,1] neg_lo:[0,1,0] neg_hi:[0,1,0]
  v_pk_fma_f32 v[172:173], v[140:141], v[128:129], v[32:33] op_sel_hi:[1,0,1] neg_lo:[0,1,0] neg_hi:[0,1,0]
  v_pk_fma_f32 v[176:177], v[142:143], v[128:129], v[34:35] op_sel_hi:[1,0,1] neg_lo:[0,1,0] neg_hi:[0,1,0]
  v_pk_mul_f32 v[166:167], v[164:165], v[164:165]
  v_pk_mul_f32 v[170:171], v[168:169], v[168:169]
  v_pk_mul_f32 v[174:175], v[172:173], v[172:173]
  v_pk_mul_f32 v[178:179], v[176:177], v[176:177]
  v_pk_fma_f32 v[166:167], v[166:167], v[126:127], v[124:125] op_sel:[0,0,1] op_sel_hi:[1,0,1]
  v_pk_fma_f32 v[170:171], v[170:171], v[126:127], v[124:125] op_sel:[0,0,1] op_sel_hi:[1,0,1]
  v_pk_fma_f32 v[174:175], v[174:175], v[130:131], v[128:129] op_sel:[0,0,1] op_sel_hi:[1,0,1]
  v_pk_fma_f32 v[178:179], v[178:179], v[130:131], v[128:129] op_sel:[0,0,1] op_sel_hi:[1,0,1]
  v_pk_mul_f32 v[166:167], v[166:167], v[164:165]
  v_pk_mul_f32 v[170:171], v[170:171], v[168:169]
  v_pk_mul_f32 v[174:175], v[174:175], v[172:173]
  v_pk_mul_f32 v[178:179], v[178:179], v[176:177]
  v_exp_f32 v166, v166
  v_exp_f32 v170, v170
  v_exp_f32 v174, v174
  v_exp_f32 v178, v178
  v_exp_f32 v167, v167
  v_exp_f32 v171, v171
  v_exp_f32 v175, v175
  v_exp_f32 v179, v179
  v_pk_fma_f32 v[166:167], v[166:167], v[126:127], v[126:127] op_sel:[0,1,1] op_sel_hi:[1,1,1]
  v_pk_fma_f32 v[170:171], v[170:171], v[126:127], v[126:127] op_sel:[0,1,1] op_sel_hi:[1,1,1]
  v_pk_fma_f32 v[174:175], v[174:175], v[130:131], v[130:131] op_sel:[0,1,1] op_sel_hi:[1,1,1]
  v_pk_fma_f32 v[178:179], v[178:179], v[130:131], v[130:131] op_sel:[0,1,1] op_sel_hi:[1,1,1]
  v_rcp_f32 v166, v166
  v_rcp_f32 v170, v170
  v_rcp_f32 v174, v174
  v_rcp_f32 v178, v178
  v_rcp_f32 v167, v167
  v_rcp_f32 v171, v171
  v_rcp_f32 v175, v175
  v_rcp_f32 v179, v179
  v_pk_mul_f32 v[28:29], v[164:165], v[166:167]
  v_pk_mul_f32 v[30:31], v[168:169], v[170:171]
  v_pk_mul_f32 v[32:33], v[172:173], v[174:175]
  v_pk_mul_f32 v[34:35], v[176:177], v[178:179]
  v_pk_fma_f32 v[164:165], v[144:145], v[124:125], v[36:37] op_sel_hi:[1,0,1] neg_lo:[0,1,0] neg_hi:[0,1,0]
  v_pk_fma_f32 v[168:169], v[146:147], v[124:125], v[38:39] op_sel_hi:[1,0,1] neg_lo:[0,1,0] neg_hi:[0,1,0]
  v_pk_fma_f32 v[172:173], v[144:145], v[128:129], v[40:41] op_sel_hi:[1,0,1] neg_lo:[0,1,0] neg_hi:[0,1,0]
  v_pk_fma_f32 v[176:177], v[146:147], v[128:129], v[42:43] op_sel_hi:[1,0,1] neg_lo:[0,1,0] neg_hi:[0,1,0]
  v_pk_mul_f32 v[166:167], v[164:165], v[164:165]
  v_pk_mul_f32 v[170:171], v[168:169], v[168:169]
  v_pk_mul_f32 v[174:175], v[172:173], v[172:173]
  v_pk_mul_f32 v[178:179], v[176:177], v[176:177]
  v_pk_fma_f32 v[166:167], v[166:167], v[126:127], v[124:125] op_sel:[0,0,1] op_sel_hi:[1,0,1]
  v_pk_fma_f32 v[170:171], v[170:171], v[126:127], v[124:125] op_sel:[0,0,1] op_sel_hi:[1,0,1]
  v_pk_fma_f32 v[174:175], v[174:175], v[130:131], v[128:129] op_sel:[0,0,1] op_sel_hi:[1,0,1]
  v_pk_fma_f32 v[178:179], v[178:179], v[130:131], v[128:129] op_sel:[0,0,1] op_sel_hi:[1,0,1]
  v_pk_mul_f32 v[166:167], v[166:167], v[164:165]
  v_pk_mul_f32 v[170:171], v[170:171], v[168:169]
  v_pk_mul_f32 v[174:175], v[174:175], v[172:173]
  v_pk_mul_f32 v[178:179], v[178:179], v[176:177]
  v_exp_f32 v166, v166
  v_exp_f32 v170, v170
  v_exp_f32 v174, v174
  v_exp_f32 v178, v178
  v_exp_f32 v167, v167
  v_exp_f32 v171, v171
  v_exp_f32 v175, v175
  v_exp_f32 v179, v179
  v_pk_fma_f32 v[166:167], v[166:167], v[126:127], v[126:127] op_sel:[0,1,1] op_sel_hi:[1,1,1]
  v_pk_fma_f32 v[170:171], v[170:171], v[126:127], v[126:127] op_sel:[0,1,1] op_sel_hi:[1,1,1]
  v_pk_fma_f32 v[174:175], v[174:175], v[130:131], v[130:131] op_sel:[0,1,1] op_sel_hi:[1,1,1]
  v_pk_fma_f32 v[178:179], v[178:179], v[130:131], v[130:131] op_sel:[0,1,1] op_sel_hi:[1,1,1]
  v_rcp_f32 v166, v166
  v_rcp_f32 v170, v170
  v_rcp_f32 v174, v174
  v_rcp_f32 v178, v178
  v_rcp_f32 v167, v167
  v_rcp_f32 v171, v171
  v_rcp_f32 v175, v175
  v_rcp_f32 v179, v179
  v_pk_mul_f32 v[36:37], v[164:165], v[166:167]
  v_pk_mul_f32 v[38:39], v[168:169], v[170:171]
  v_pk_mul_f32 v[40:41], v[172:173], v[174:175]
  v_pk_mul_f32 v[42:43], v[176:177], v[178:179]
  v_pk_fma_f32 v[164:165], v[148:149], v[124:125], v[44:45] op_sel_hi:[1,0,1] neg_lo:[0,1,0] neg_hi:[0,1,0]
  v_pk_fma_f32 v[168:169], v[150:151], v[124:125], v[46:47] op_sel_hi:[1,0,1] neg_lo:[0,1,0] neg_hi:[0,1,0]
  v_pk_fma_f32 v[172:173], v[148:149], v[128:129], v[48:49] op_sel_hi:[1,0,1] neg_lo:[0,1,0] neg_hi:[0,1,0]
  v_pk_fma_f32 v[176:177], v[150:151], v[128:129], v[50:51] op_sel_hi:[1,0,1] neg_lo:[0,1,0] neg_hi:[0,1,0]
  v_pk_mul_f32 v[166:167], v[164:165], v[164:165]
  v_pk_mul_f32 v[170:171], v[168:169], v[168:169]
  v_pk_mul_f32 v[174:175], v[172:173], v[172:173]
  v_pk_mul_f32 v[178:179], v[176:177], v[176:177]
  v_pk_fma_f32 v[166:167], v[166:167], v[126:127], v[124:125] op_sel:[0,0,1] op_sel_hi:[1,0,1]
  v_pk_fma_f32 v[170:171], v[170:171], v[126:127], v[124:125] op_sel:[0,0,1] op_sel_hi:[1,0,1]
  v_pk_fma_f32 v[174:175], v[174:175], v[130:131], v[128:129] op_sel:[0,0,1] op_sel_hi:[1,0,1]
  v_pk_fma_f32 v[178:179], v[178:179], v[130:131], v[128:129] op_sel:[0,0,1] op_sel_hi:[1,0,1]
  v_pk_mul_f32 v[166:167], v[166:167], v[164:165]
  v_pk_mul_f32 v[170:171], v[170:171], v[168:169]
  v_pk_mul_f32 v[174:175], v[174:175], v[172:173]
  v_pk_mul_f32 v[178:179], v[178:179], v[176:177]
  v_exp_f32 v166, v166
  v_exp_f32 v170, v170
  v_exp_f32 v174, v174
  v_exp_f32 v178, v178
  v_exp_f32 v167, v167
  v_exp_f32 v171, v171
  v_exp_f32 v175, v175
  v_exp_f32 v179, v179
  v_pk_fma_f32 v[166:167], v[166:167], v[126:127], v[126:127] op_sel:[0,1,1] op_sel_hi:[1,1,1]
  v_pk_fma_f32 v[170:171], v[170:171], v[126:127], v[126:127] op_sel:[0,1,1] op_sel_hi:[1,1,1]
  v_pk_fma_f32 v[174:175], v[174:175], v[130:131], v[130:131] op_sel:[0,1,1] op_sel_hi:[1,1,1]
  v_pk_fma_f32 v[178:179], v[178:179], v[130:131], v[130:131] op_sel:[0,1,1] op_sel_hi:[1,1,1]
  v_rcp_f32 v166, v166
  v_rcp_f32 v170, v170
  v_rcp_f32 v174, v174
  v_rcp_f32 v178, v178
  v_rcp_f32 v167, v167
  v_rcp_f32 v171, v171
  v_rcp_f32 v175, v175
  v_rcp_f32 v179, v179
  v_pk_mul_f32 v[44:45], v[164:165], v[166:167]
  v_pk_mul_f32 v[46:47], v[168:169], v[170:171]
  v_pk_mul_f32 v[48:49], v[172:173], v[174:175]
  v_pk_mul_f32 v[50:51], v[176:177], v[178:179]
  v_pk_fma_f32 v[164:165], v[152:153], v[124:125], v[52:53] op_sel_hi:[1,0,1] neg_lo:[0,1,0] neg_hi:[0,1,0]
  v_pk_fma_f32 v[168:169], v[154:155], v[124:125], v[54:55] op_sel_hi:[1,0,1] neg_lo:[0,1,0] neg_hi:[0,1,0]
  v_pk_fma_f32 v[172:173], v[152:153], v[128:129], v[56:57] op_sel_hi:[1,0,1] neg_lo:[0,1,0] neg_hi:[0,1,0]
  v_pk_fma_f32 v[176:177], v[154:155], v[128:129], v[58:59] op_sel_hi:[1,0,1] neg_lo:[0,1,0] neg_hi:[0,1,0]
  v_pk_mul_f32 v[166:167], v[164:165], v[164:165]
  v_pk_mul_f32 v[170:171], v[168:169], v[168:169]
  v_pk_mul_f32 v[174:175], v[172:173], v[172:173]
  v_pk_mul_f32 v[178:179], v[176:177], v[176:177]
  v_pk_fma_f32 v[166:167], v[166:167], v[126:127], v[124:125] op_sel:[0,0,1] op_sel_hi:[1,0,1]
  v_pk_fma_f32 v[170:171], v[170:171], v[126:127], v[124:125] op_sel:[0,0,1] op_sel_hi:[1,0,1]
  v_pk_fma_f32 v[174:175], v[174:175], v[130:131], v[128:129] op_sel:[0,0,1] op_sel_hi:[1,0,1]
  v_pk_fma_f32 v[178:179], v[178:179], v[130:131], v[128:129] op_sel:[0,0,1] op_sel_hi:[1,0,1]
  v_pk_mul_f32 v[166:167], v[166:167], v[164:165]
  v_pk_mul_f32 v[170:171], v[170:171], v[168:169]
  v_pk_mul_f32 v[174:175], v[174:175], v[172:173]
  v_pk_mul_f32 v[178:179], v[178:179], v[176:177]
  v_exp_f32 v166, v166
  v_exp_f32 v170, v170
  v_exp_f32 v174, v174
  v_exp_f32 v178, v178
  v_exp_f32 v167, v167
  v_exp_f32 v171, v171
  v_exp_f32 v175, v175
  v_exp_f32 v179, v179
  v_pk_fma_f32 v[166:167], v[166:167], v[126:127], v[126:127] op_sel:[0,1,1] op_sel_hi:[1,1,1]
  v_pk_fma_f32 v[170:171], v[170:171], v[126:127], v[126:127] op_sel:[0,1,1] op_sel_hi:[1,1,1]
  v_pk_fma_f32 v[174:175], v[174:175], v[130:131], v[130:131] op_sel:[0,1,1] op_sel_hi:[1,1,1]
  v_pk_fma_f32 v[178:179], v[178:179], v[130:131], v[130:131] op_sel:[0,1,1] op_sel_hi:[1,1,1]
  v_rcp_f32 v166, v166
  v_rcp_f32 v170, v170
  v_rcp_f32 v174, v174
  v_rcp_f32 v178, v178
  v_rcp_f32 v167, v167
  v_rcp_f32 v171, v171
  v_rcp_f32 v175, v175
  v_rcp_f32 v179, v179
  v_pk_mul_f32 v[52:53], v[164:165], v[166:167]
  v_pk_mul_f32 v[54:55], v[168:169], v[170:171]
  v_pk_mul_f32 v[56:57], v[172:173], v[174:175]
  v_pk_mul_f32 v[58:59], v[176:177], v[178:179]
  v_pk_fma_f32 v[164:165], v[156:157], v[124:125], v[60:61] op_sel_hi:[1,0,1] neg_lo:[0,1,0] neg_hi:[0,1,0]
  v_pk_fma_f32 v[168:169], v[158:159], v[124:125], v[62:63] op_sel_hi:[1,0,1] neg_lo:[0,1,0] neg_hi:[0,1,0]
  v_pk_fma_f32 v[172:173], v[156:157], v[128:129], v[64:65] op_sel_hi:[1,0,1] neg_lo:[0,1,0] neg_hi:[0,1,0]
  v_pk_fma_f32 v[176:177], v[158:159], v[128:129], v[66:67] op_sel_hi:[1,0,1] neg_lo:[0,1,0] neg_hi:[0,1,0]
  v_pk_mul_f32 v[166:167], v[164:165], v[164:165]
  v_pk_mul_f32 v[170:171], v[168:169], v[168:169]
  v_pk_mul_f32 v[174:175], v[172:173], v[172:173]
  v_pk_mul_f32 v[178:179], v[176:177], v[176:177]
  v_pk_fma_f32 v[166:167], v[166:167], v[126:127], v[124:125] op_sel:[0,0,1] op_sel_hi:[1,0,1]
  v_pk_fma_f32 v[170:171], v[170:171], v[126:127], v[124:125] op_sel:[0,0,1] op_sel_hi:[1,0,1]
  v_pk_fma_f32 v[174:175], v[174:175], v[130:131], v[128:129] op_sel:[0,0,1] op_sel_hi:[1,0,1]
  v_pk_fma_f32 v[178:179], v[178:179], v[130:131], v[128:129] op_sel:[0,0,1] op_sel_hi:[1,0,1]
  v_pk_mul_f32 v[166:167], v[166:167], v[164:165]
  v_pk_mul_f32 v[170:171], v[170:171], v[168:169]
  v_pk_mul_f32 v[174:175], v[174:175], v[172:173]
  v_pk_mul_f32 v[178:179], v[178:179], v[176:177]
  v_exp_f32 v166, v166
  v_exp_f32 v170, v170
  v_exp_f32 v174, v174
  v_exp_f32 v178, v178
  v_exp_f32 v167, v167
  v_exp_f32 v171, v171
  v_exp_f32 v175, v175
  v_exp_f32 v179, v179
  v_pk_fma_f32 v[166:167], v[166:167], v[126:127], v[126:127] op_sel:[0,1,1] op_sel_hi:[1,1,1]
  v_pk_fma_f32 v[170:171], v[170:171], v[126:127], v[126:127] op_sel:[0,1,1] op_sel_hi:[1,1,1]
  v_pk_fma_f32 v[174:175], v[174:175], v[130:131], v[130:131] op_sel:[0,1,1] op_sel_hi:[1,1,1]
  v_pk_fma_f32 v[178:179], v[178:179], v[130:131], v[130:131] op_sel:[0,1,1] op_sel_hi:[1,1,1]
  v_rcp_f32 v166, v166
  v_rcp_f32 v170, v170
  v_rcp_f32 v174, v174
  v_rcp_f32 v178, v178
  v_rcp_f32 v167, v167
  v_rcp_f32 v171, v171
  v_rcp_f32 v175, v175
  v_rcp_f32 v179, v179
  v_pk_mul_f32 v[60:61], v[164:165], v[166:167]
  v_pk_mul_f32 v[62:63], v[168:169], v[170:171]
  v_pk_mul_f32 v[64:65], v[172:173], v[174:175]
  v_pk_mul_f32 v[66:67], v[176:177], v[178:179]
  v_cvt_pk_bf16_f32 v68, v12, v13
  v_cvt_pk_bf16_f32 v69, v14, v15
  v_cvt_pk_bf16_f32 v70, v16, v17
  v_cvt_pk_bf16_f32 v71, v18, v19
  v_cvt_pk_bf16_f32 v72, v20, v21
  v_cvt_pk_bf16_f32 v73, v22, v23
  v_cvt_pk_bf16_f32 v74, v24, v25
  v_cvt_pk_bf16_f32 v75, v26, v27
  v_cvt_pk_bf16_f32 v76, v28, v29
  v_cvt_pk_bf16_f32 v77, v30, v31
  v_cvt_pk_bf16_f32 v78, v32, v33
  v_cvt_pk_bf16_f32 v79, v34, v35
  v_cvt_pk_bf16_f32 v80, v36, v37
  v_cvt_pk_bf16_f32 v81, v38, v39
  v_cvt_pk_bf16_f32 v82, v40, v41
  v_cvt_pk_bf16_f32 v83, v42, v43
  v_cvt_pk_bf16_f32 v84, v44, v45
  v_cvt_pk_bf16_f32 v85, v46, v47
  v_cvt_pk_bf16_f32 v86, v48, v49
  v_cvt_pk_bf16_f32 v87, v50, v51
  v_cvt_pk_bf16_f32 v88, v52, v53
  v_cvt_pk_bf16_f32 v89, v54, v55
  v_cvt_pk_bf16_f32 v90, v56, v57
  v_cvt_pk_bf16_f32 v91, v58, v59
  v_cvt_pk_bf16_f32 v92, v60, v61
  v_cvt_pk_bf16_f32 v93, v62, v63
  v_cvt_pk_bf16_f32 v94, v64, v65
  v_cvt_pk_bf16_f32 v95, v66, v67
  s_mov_b32 s36, s16
  s_mov_b32 s37, s17
  s_mov_b32 s38, 0x1000
  s_mov_b32 s39, 0x20000
  s_add_u32 s40, s4, 0x1c00000
  s_addc_u32 s41, s5, 0x0
  s_mov_b32 s42, 0x700000
  s_mov_b32 s43, 0x20000
  s_lshl_b32 s49, s44, 7
  s_lshl_b32 s50, s46, 5
  s_add_u32 s49, s49, s50
  v_and_b32 v5, 15, v0
  v_add_u32 v5, s49, v5
  v_lshlrev_b32 v6, 1, v5
  buffer_load_ushort v10, v6, s[36:39], 0 offen
  buffer_load_ushort v11, v6, s[36:39], 0 offen offset:32
  s_mul_i32 s49, s44, 458752
  s_lshl_b32 s50, s46, 11
  s_add_u32 s49, s49, s50
  s_mul_i32 s50, s45, 7
  s_lshr_b32 s50, s50, 1
  s_lshl_b32 s50, s50, 13
  s_add_u32 s49, s49, s50
  v_and_b32 v8, 15, v0
  v_lshlrev_b32 v8, 6, v8
  v_add_u32 v8, s49, v8
  v_lshrrev_b32 v6, 4, v0
  v_and_b32 v7, 1, v6
  v_lshl_add_u32 v9, v7, 10, v8
  v_lshrrev_b32 v7, 1, v6
  v_lshl_add_u32 v9, v7, 4, v9
  v_and_b32 v6, 1, v6
  v_lshl_or_b32 v6, v6, 1, v7
  v_lshl_add_u32 v8, v6, 4, v8
  v_lshlrev_b32 v4, 3, v0
  v_add_u32 v4, 16384, v4
  v_add_u32 v4, s53, v4
  v_mov_b32 v12, 0
  v_mov_b32 v13, 0
  v_mov_b32 v14, 0
  v_mov_b32 v15, 0
  v_mov_b32 v16, 0
  v_mov_b32 v17, 0
  v_mov_b32 v18, 0
  v_mov_b32 v19, 0
  v_mov_b32 v20, 0
  v_mov_b32 v21, 0
  v_mov_b32 v22, 0
  v_mov_b32 v23, 0
  v_mov_b32 v24, 0
  v_mov_b32 v25, 0
  v_mov_b32 v26, 0
  v_mov_b32 v27, 0
  v_mov_b32 v28, 0
  v_mov_b32 v29, 0
  v_mov_b32 v30, 0
  v_mov_b32 v31, 0
  v_mov_b32 v32, 0
  v_mov_b32 v33, 0
  v_mov_b32 v34, 0
  v_mov_b32 v35, 0
  v_mov_b32 v36, 0
  v_mov_b32 v37, 0
  v_mov_b32 v38, 0
  v_mov_b32 v39, 0
  v_mov_b32 v40, 0
  v_mov_b32 v41, 0
  v_mov_b32 v42, 0
  v_mov_b32 v43, 0
  v_mov_b32 v44, 0
  v_mov_b32 v45, 0
  v_mov_b32 v46, 0
  v_mov_b32 v47, 0
  v_mov_b32 v48, 0
  v_mov_b32 v49, 0
  v_mov_b32 v50, 0
  v_mov_b32 v51, 0
  v_mov_b32 v52, 0
  v_mov_b32 v53, 0
  v_mov_b32 v54, 0
  v_mov_b32 v55, 0
  v_mov_b32 v56, 0
  v_mov_b32 v57, 0
  v_mov_b32 v58, 0
  v_mov_b32 v59, 0
  v_mov_b32 v60, 0
  v_mov_b32 v61, 0
  v_mov_b32 v62, 0
  v_mov_b32 v63, 0
  v_mov_b32 v64, 0
  v_mov_b32 v65, 0
  v_mov_b32 v66, 0
  v_mov_b32 v67, 0
  s_barrier
  s_mov_b32 s52, 32
  ds_read_b64_tr_b16 v[132:133], v4 offset:0
  ds_read_b64_tr_b16 v[134:135], v4 offset:512
  ds_read_b128 v[124:127], v1 offset:0
  ds_read_b128 v[128:131], v1 offset:2048
  ds_read_b64_tr_b16 v[136:137], v4 offset:1024
  ds_read_b64_tr_b16 v[138:139], v4 offset:1536
  ds_read_b64_tr_b16 v[140:141], v4 offset:2048
  ds_read_b64_tr_b16 v[142:143], v4 offset:2560
  ds_read_b64_tr_b16 v[144:145], v4 offset:3072
  ds_read_b64_tr_b16 v[146:147], v4 offset:3584
  ds_read_b64_tr_b16 v[148:149], v4 offset:4096
  ds_read_b64_tr_b16 v[150:151], v4 offset:4608
  ds_read_b64_tr_b16 v[152:153], v4 offset:5120
  ds_read_b64_tr_b16 v[154:155], v4 offset:5632
  ds_read_b64_tr_b16 v[156:157], v4 offset:6144
  ds_read_b64_tr_b16 v[158:159], v4 offset:6656
p4_loop:
  s_waitcnt lgkmcnt(0)
  v_mfma_f32_16x16x32_bf16 v[12:15], v[132:135], v[124:127], v[12:15]
  s_add_u32 s53, s53, 30720
  ds_read_b64_tr_b16 v[168:169], v4 offset:7168
  v_mfma_f32_16x16x32_bf16 v[16:19], v[132:135], v[128:131], v[16:19]
  s_cmp_eq_u32 s53, 153600
  ds_read_b64_tr_b16 v[170:171], v4 offset:7680
  v_mfma_f32_16x16x32_bf16 v[20:23], v[136:139], v[124:127], v[20:23]
  s_cselect_b32 s54, 153600, 0
  ds_read_b128 v[160:163], v2 offset:0
  v_mfma_f32_16x16x32_bf16 v[24:27], v[136:139], v[128:131], v[24:27]
  s_cselect_b32 s53, 0, s53
  ds_read_b128 v[164:167], v2 offset:2048
  v_mfma_f32_16x16x32_bf16 v[28:31], v[140:143], v[124:127], v[28:31]
  s_sub_u32 s54, 30720, s54
  ds_read_b64_tr_b16 v[172:173], v4 offset:8192
  v_mfma_f32_16x16x32_bf16 v[32:35], v[140:143], v[128:131], v[32:35]
  s_sub_u32 s52, s52, 1
  ds_read_b64_tr_b16 v[174:175], v4 offset:8704
  v_mfma_f32_16x16x32_bf16 v[36:39], v[144:147], v[124:127], v[36:39]
  ds_read_b64_tr_b16 v[176:177], v4 offset:9216
  ds_read_b64_tr_b16 v[178:179], v4 offset:9728
  v_mfma_f32_16x16x32_bf16 v[40:43], v[144:147], v[128:131], v[40:43]
  ds_read_b64_tr_b16 v[180:181], v4 offset:10240
  ds_read_b64_tr_b16 v[182:183], v4 offset:10752
  v_mfma_f32_16x16x32_bf16 v[44:47], v[148:151], v[124:127], v[44:47]
  ds_read_b64_tr_b16 v[184:185], v4 offset:11264
  ds_read_b64_tr_b16 v[186:187], v4 offset:11776
  v_mfma_f32_16x16x32_bf16 v[48:51], v[148:151], v[128:131], v[48:51]
  ds_read_b64_tr_b16 v[188:189], v4 offset:12288
  ds_read_b64_tr_b16 v[190:191], v4 offset:12800
  v_mfma_f32_16x16x32_bf16 v[52:55], v[152:155], v[124:127], v[52:55]
  ds_read_b64_tr_b16 v[192:193], v4 offset:13312
  ds_read_b64_tr_b16 v[194:195], v4 offset:13824
  v_mfma_f32_16x16x32_bf16 v[56:59], v[152:155], v[128:131], v[56:59]
  v_mfma_f32_16x16x32_bf16 v[60:63], v[156:159], v[124:127], v[60:63]
  v_mfma_f32_16x16x32_bf16 v[64:67], v[156:159], v[128:131], v[64:67]
  s_waitcnt lgkmcnt(0)
  s_barrier
  v_mfma_f32_16x16x32_bf16 v[12:15], v[168:171], v[160:163], v[12:15]
  v_add_u32 v4, s54, v4
  v_mfma_f32_16x16x32_bf16 v[16:19], v[168:171], v[164:167], v[16:19]
  v_add_u32 v1, s54, v1
  ds_read_b64_tr_b16 v[132:133], v4 offset:0
  v_mfma_f32_16x16x32_bf16 v[20:23], v[172:175], v[160:163], v[20:23]
  v_add_u32 v2, s54, v2
  ds_read_b64_tr_b16 v[134:135], v4 offset:512
  v_mfma_f32_16x16x32_bf16 v[24:27], v[172:175], v[164:167], v[24:27]
  s_cmp_lg_u32 s52, 0
  ds_read_b128 v[124:127], v1 offset:0
  v_mfma_f32_16x16x32_bf16 v[28:31], v[176:179], v[160:163], v[28:31]
  ds_read_b128 v[128:131], v1 offset:2048
  v_mfma_f32_16x16x32_bf16 v[32:35], v[176:179], v[164:167], v[32:35]
  ds_read_b64_tr_b16 v[136:137], v4 offset:1024
  ds_read_b64_tr_b16 v[138:139], v4 offset:1536
  v_mfma_f32_16x16x32_bf16 v[36:39], v[180:183], v[160:163], v[36:39]
  ds_read_b64_tr_b16 v[140:141], v4 offset:2048
  ds_read_b64_tr_b16 v[142:143], v4 offset:2560
  v_mfma_f32_16x16x32_bf16 v[40:43], v[180:183], v[164:167], v[40:43]
  ds_read_b64_tr_b16 v[144:145], v4 offset:3072
  ds_read_b64_tr_b16 v[146:147], v4 offset:3584
  v_mfma_f32_16x16x32_bf16 v[44:47], v[184:187], v[160:163], v[44:47]
  ds_read_b64_tr_b16 v[148:149], v4 offset:4096
  ds_read_b64_tr_b16 v[150:151], v4 offset:4608
  v_mfma_f32_16x16x32_bf16 v[48:51], v[184:187], v[164:167], v[48:51]
  ds_read_b64_tr_b16 v[152:153], v4 offset:5120
  ds_read_b64_tr_b16 v[154:155], v4 offset:5632
  v_mfma_f32_16x16x32_bf16 v[52:55], v[188:191], v[160:163], v[52:55]
  ds_read_b64_tr_b16 v[156:157], v4 offset:6144
  ds_read_b64_tr_b16 v[158:159], v4 offset:6656
  v_mfma_f32_16x16x32_bf16 v[56:59], v[188:191], v[164:167], v[56:59]
  v_mfma_f32_16x16x32_bf16 v[60:63], v[192:195], v[160:163], v[60:63]
  v_mfma_f32_16x16x32_bf16 v[64:67], v[192:195], v[164:167], v[64:67]
  s_cbranch_scc1 p4_loop
  s_waitcnt lgkmcnt(0)
  s_nop 7
  s_barrier
  s_waitcnt vmcnt(0)
  v_lshlrev_b32 v10, 16, v10
  v_lshlrev_b32 v11, 16, v11
  s_and_b32 s48, s45, 1
  s_cmp_eq_u32 s48, 0
  s_cbranch_scc0 p4_odd
  v_lshlrev_b32 v172, 16, v92
  v_and_b32 v173, 0xffff0000, v92
  v_lshlrev_b32 v174, 16, v93
  v_and_b32 v175, 0xffff0000, v93
  v_pk_add_f32 v[60:61], v[60:61], v[10:11] op_sel:[0,0] op_sel_hi:[1,0]
  v_pk_add_f32 v[62:63], v[62:63], v[10:11] op_sel:[0,0] op_sel_hi:[1,0]
  v_pk_mul_f32 v[60:61], v[60:61], v[172:173]
  v_pk_mul_f32 v[62:63], v[62:63], v[174:175]
  v_cvt_pk_bf16_f32 v196, v60, v61
  v_cvt_pk_bf16_f32 v197, v62, v63
  v_lshlrev_b32 v176, 16, v94
  v_and_b32 v177, 0xffff0000, v94
  v_lshlrev_b32 v178, 16, v95
  v_and_b32 v179, 0xffff0000, v95
  v_pk_add_f32 v[64:65], v[64:65], v[10:11] op_sel:[0,1] op_sel_hi:[1,1]
  v_pk_add_f32 v[66:67], v[66:67], v[10:11] op_sel:[0,1] op_sel_hi:[1,1]
  v_pk_mul_f32 v[64:65], v[64:65], v[176:177]
  v_pk_mul_f32 v[66:67], v[66:67], v[178:179]
  v_cvt_pk_bf16_f32 v198, v64, v65
  v_cvt_pk_bf16_f32 v199, v66, v67
  s_nop 0
  v_permlane16_swap_b32 v196, v198
  v_permlane16_swap_b32 v197, v199
  s_mov_b32 s47, 24576
  buffer_store_dwordx4 v[196:199], v9, s[40:43], s47 offen sc1
  v_lshlrev_b32 v124, 16, v68
  v_and_b32 v125, 0xffff0000, v68
  v_lshlrev_b32 v126, 16, v69
  v_and_b32 v127, 0xffff0000, v69
  v_pk_add_f32 v[12:13], v[12:13], v[10:11] op_sel:[0,0] op_sel_hi:[1,0]
  v_pk_add_f32 v[14:15], v[14:15], v[10:11] op_sel:[0,0] op_sel_hi:[1,0]
  v_pk_mul_f32 v[12:13], v[12:13], v[124:125]
  v_pk_mul_f32 v[14:15], v[14:15], v[126:127]
  v_cvt_pk_bf16_f32 v200, v12, v13
  v_cvt_pk_bf16_f32 v201, v14, v15
  v_lshlrev_b32 v132, 16, v72
  v_and_b32 v133, 0xffff0000, v72
  v_lshlrev_b32 v134, 16, v73
  v_and_b32 v135, 0xffff0000, v73
  v_pk_add_f32 v[20:21], v[20:21], v[10:11] op_sel:[0,0] op_sel_hi:[1,0]
  v_pk_add_f32 v[22:23], v[22:23], v[10:11] op_sel:[0,0] op_sel_hi:[1,0]
  v_pk_mul_f32 v[20:21], v[20:21], v[132:133]
  v_pk_mul_f32 v[22:23], v[22:23], v[134:135]
  v_cvt_pk_bf16_f32 v202, v20, v21
  v_cvt_pk_bf16_f32 v203, v22, v23
  s_nop 0
  v_permlane16_swap_b32 v200, v202
  v_permlane16_swap_b32 v201, v203
  s_mov_b32 s47, 0
  buffer_store_dwordx4 v[200:203], v8, s[40:43], s47 offen sc1
  v_lshlrev_b32 v140, 16, v76
  v_and_b32 v141, 0xffff0000, v76
  v_lshlrev_b32 v142, 16, v77
  v_and_b32 v143, 0xffff0000, v77
  v_pk_add_f32 v[28:29], v[28:29], v[10:11] op_sel:[0,0] op_sel_hi:[1,0]
  v_pk_add_f32 v[30:31], v[30:31], v[10:11] op_sel:[0,0] op_sel_hi:[1,0]
  v_pk_mul_f32 v[28:29], v[28:29], v[140:141]
  v_pk_mul_f32 v[30:31], v[30:31], v[142:143]
  v_cvt_pk_bf16_f32 v204, v28, v29
  v_cvt_pk_bf16_f32 v205, v30, v31
  v_lshlrev_b32 v148, 16, v80
  v_and_b32 v149, 0xffff0000, v80
  v_lshlrev_b32 v150, 16, v81
  v_and_b32 v151, 0xffff0000, v81
  v_pk_add_f32 v[36:37], v[36:37], v[10:11] op_sel:[0,0] op_sel_hi:[1,0]
  v_pk_add_f32 v[38:39], v[38:39], v[10:11] op_sel:[0,0] op_sel_hi:[1,0]
  v_pk_mul_f32 v[36:37], v[36:37], v[148:149]
  v_pk_mul_f32 v[38:39], v[38:39], v[150:151]
  v_cvt_pk_bf16_f32 v206, v36, v37
  v_cvt_pk_bf16_f32 v207, v38, v39
  s_nop 0
  v_permlane16_swap_b32 v204, v206
  v_permlane16_swap_b32 v205, v207
  s_mov_b32 s47, 8192
  buffer_store_dwordx4 v[204:207], v8, s[40:43], s47 offen sc1
  v_lshlrev_b32 v156, 16, v84
  v_and_b32 v157, 0xffff0000, v84
  v_lshlrev_b32 v158, 16, v85
  v_and_b32 v159, 0xffff0000, v85
  v_pk_add_f32 v[44:45], v[44:45], v[10:11] op_sel:[0,0] op_sel_hi:[1,0]
  v_pk_add_f32 v[46:47], v[46:47], v[10:11] op_sel:[0,0] op_sel_hi:[1,0]
  v_pk_mul_f32 v[44:45], v[44:45], v[156:157]
  v_pk_mul_f32 v[46:47], v[46:47], v[158:159]
  v_cvt_pk_bf16_f32 v208, v44, v45
  v_cvt_pk_bf16_f32 v209, v46, v47
  v_lshlrev_b32 v164, 16, v88
  v_and_b32 v165, 0xffff0000, v88
  v_lshlrev_b32 v166, 16, v89
  v_and_b32 v167, 0xffff0000, v89
  v_pk_add_f32 v[52:53], v[52:53], v[10:11] op_sel:[0,0] op_sel_hi:[1,0]
  v_pk_add_f32 v[54:55], v[54:55], v[10:11] op_sel:[0,0] op_sel_hi:[1,0]
  v_pk_mul_f32 v[52:53], v[52:53], v[164:165]
  v_pk_mul_f32 v[54:55], v[54:55], v[166:167]
  v_cvt_pk_bf16_f32 v210, v52, v53
  v_cvt_pk_bf16_f32 v211, v54, v55
  s_nop 0
  v_permlane16_swap_b32 v208, v210
  v_permlane16_swap_b32 v209, v211
  s_mov_b32 s47, 16384
  buffer_store_dwordx4 v[208:211], v8, s[40:43], s47 offen sc1
  v_lshlrev_b32 v128, 16, v70
  v_and_b32 v129, 0xffff0000, v70
  v_lshlrev_b32 v130, 16, v71
  v_and_b32 v131, 0xffff0000, v71
  v_pk_add_f32 v[16:17], v[16:17], v[10:11] op_sel:[0,1] op_sel_hi:[1,1]
  v_pk_add_f32 v[18:19], v[18:19], v[10:11] op_sel:[0,1] op_sel_hi:[1,1]
  v_pk_mul_f32 v[16:17], v[16:17], v[128:129]
  v_pk_mul_f32 v[18:19], v[18:19], v[130:131]
  v_cvt_pk_bf16_f32 v212, v16, v17
  v_cvt_pk_bf16_f32 v213, v18, v19
  v_lshlrev_b32 v136, 16, v74
  v_and_b32 v137, 0xffff0000, v74
  v_lshlrev_b32 v138, 16, v75
  v_and_b32 v139, 0xffff0000, v75
  v_pk_add_f32 v[24:25], v[24:25], v[10:11] op_sel:[0,1] op_sel_hi:[1,1]
  v_pk_add_f32 v[26:27], v[26:27], v[10:11] op_sel:[0,1] op_sel_hi:[1,1]
  v_pk_mul_f32 v[24:25], v[24:25], v[136:137]
  v_pk_mul_f32 v[26:27], v[26:27], v[138:139]
  v_cvt_pk_bf16_f32 v214, v24, v25
  v_cvt_pk_bf16_f32 v215, v26, v27
  s_nop 0
  v_permlane16_swap_b32 v212, v214
  v_permlane16_swap_b32 v213, v215
  s_mov_b32 s47, 1024
  buffer_store_dwordx4 v[212:215], v8, s[40:43], s47 offen sc1
  v_lshlrev_b32 v144, 16, v78
  v_and_b32 v145, 0xffff0000, v78
  v_lshlrev_b32 v146, 16, v79
  v_and_b32 v147, 0xffff0000, v79
  v_pk_add_f32 v[32:33], v[32:33], v[10:11] op_sel:[0,1] op_sel_hi:[1,1]
  v_pk_add_f32 v[34:35], v[34:35], v[10:11] op_sel:[0,1] op_sel_hi:[1,1]
  v_pk_mul_f32 v[32:33], v[32:33], v[144:145]
  v_pk_mul_f32 v[34:35], v[34:35], v[146:147]
  v_cvt_pk_bf16_f32 v216, v32, v33
  v_cvt_pk_bf16_f32 v217, v34, v35
  v_lshlrev_b32 v152, 16, v82
  v_and_b32 v153, 0xffff0000, v82
  v_lshlrev_b32 v154, 16, v83
  v_and_b32 v155, 0xffff0000, v83
  v_pk_add_f32 v[40:41], v[40:41], v[10:11] op_sel:[0,1] op_sel_hi:[1,1]
  v_pk_add_f32 v[42:43], v[42:43], v[10:11] op_sel:[0,1] op_sel_hi:[1,1]
  v_pk_mul_f32 v[40:41], v[40:41], v[152:153]
  v_pk_mul_f32 v[42:43], v[42:43], v[154:155]
  v_cvt_pk_bf16_f32 v218, v40, v41
  v_cvt_pk_bf16_f32 v219, v42, v43
  s_nop 0
  v_permlane16_swap_b32 v216, v218
  v_permlane16_swap_b32 v217, v219
  s_mov_b32 s47, 9216
  buffer_store_dwordx4 v[216:219], v8, s[40:43], s47 offen sc1
  v_lshlrev_b32 v160, 16, v86
  v_and_b32 v161, 0xffff0000, v86
  v_lshlrev_b32 v162, 16, v87
  v_and_b32 v163, 0xffff0000, v87
  v_pk_add_f32 v[48:49], v[48:49], v[10:11] op_sel:[0,1] op_sel_hi:[1,1]
  v_pk_add_f32 v[50:51], v[50:51], v[10:11] op_sel:[0,1] op_sel_hi:[1,1]
  v_pk_mul_f32 v[48:49], v[48:49], v[160:161]
  v_pk_mul_f32 v[50:51], v[50:51], v[162:163]
  v_cvt_pk_bf16_f32 v220, v48, v49
  v_cvt_pk_bf16_f32 v221, v50, v51
  v_lshlrev_b32 v168, 16, v90
  v_and_b32 v169, 0xffff0000, v90
  v_lshlrev_b32 v170, 16, v91
  v_and_b32 v171, 0xffff0000, v91
  v_pk_add_f32 v[56:57], v[56:57], v[10:11] op_sel:[0,1] op_sel_hi:[1,1]
  v_pk_add_f32 v[58:59], v[58:59], v[10:11] op_sel:[0,1] op_sel_hi:[1,1]
  v_pk_mul_f32 v[56:57], v[56:57], v[168:169]
  v_pk_mul_f32 v[58:59], v[58:59], v[170:171]
  v_cvt_pk_bf16_f32 v222, v56, v57
  v_cvt_pk_bf16_f32 v223, v58, v59
  s_nop 0
  v_permlane16_swap_b32 v220, v222
  v_permlane16_swap_b32 v221, v223
  s_mov_b32 s47, 17408
  buffer_store_dwordx4 v[220:223], v8, s[40:43], s47 offen sc1
  s_branch p4_st_done
p4_odd:
  s_nop 8
  v_lshlrev_b32 v124, 16, v68
  v_and_b32 v125, 0xffff0000, v68
  v_lshlrev_b32 v126, 16, v69
  v_and_b32 v127, 0xffff0000, v69
  v_pk_add_f32 v[12:13], v[12:13], v[10:11] op_sel:[0,0] op_sel_hi:[1,0]
  v_pk_add_f32 v[14:15], v[14:15], v[10:11] op_sel:[0,0] op_sel_hi:[1,0]
  v_pk_mul_f32 v[12:13], v[12:13], v[124:125]
  v_pk_mul_f32 v[14:15], v[14:15], v[126:127]
  v_cvt_pk_bf16_f32 v196, v12, v13
  v_cvt_pk_bf16_f32 v197, v14, v15
  v_lshlrev_b32 v128, 16, v70
  v_and_b32 v129, 0xffff0000, v70
  v_lshlrev_b32 v130, 16, v71
  v_and_b32 v131, 0xffff0000, v71
  v_pk_add_f32 v[16:17], v[16:17], v[10:11] op_sel:[0,1] op_sel_hi:[1,1]
  v_pk_add_f32 v[18:19], v[18:19], v[10:11] op_sel:[0,1] op_sel_hi:[1,1]
  v_pk_mul_f32 v[16:17], v[16:17], v[128:129]
  v_pk_mul_f32 v[18:19], v[18:19], v[130:131]
  v_cvt_pk_bf16_f32 v198, v16, v17
  v_cvt_pk_bf16_f32 v199, v18, v19
  s_nop 0
  v_permlane16_swap_b32 v196, v198
  v_permlane16_swap_b32 v197, v199
  s_mov_b32 s47, 32
  buffer_store_dwordx4 v[196:199], v9, s[40:43], s47 offen sc1
  v_lshlrev_b32 v132, 16, v72
  v_and_b32 v133, 0xffff0000, v72
  v_lshlrev_b32 v134, 16, v73
  v_and_b32 v135, 0xffff0000, v73
  v_pk_add_f32 v[20:21], v[20:21], v[10:11] op_sel:[0,0] op_sel_hi:[1,0]
  v_pk_add_f32 v[22:23], v[22:23], v[10:11] op_sel:[0,0] op_sel_hi:[1,0]
  v_pk_mul_f32 v[20:21], v[20:21], v[132:133]
  v_pk_mul_f32 v[22:23], v[22:23], v[134:135]
  v_cvt_pk_bf16_f32 v200, v20, v21
  v_cvt_pk_bf16_f32 v201, v22, v23
  v_lshlrev_b32 v140, 16, v76
  v_and_b32 v141, 0xffff0000, v76
  v_lshlrev_b32 v142, 16, v77
  v_and_b32 v143, 0xffff0000, v77
  v_pk_add_f32 v[28:29], v[28:29], v[10:11] op_sel:[0,0] op_sel_hi:[1,0]
  v_pk_add_f32 v[30:31], v[30:31], v[10:11] op_sel:[0,0] op_sel_hi:[1,0]
  v_pk_mul_f32 v[28:29], v[28:29], v[140:141]
  v_pk_mul_f32 v[30:31], v[30:31], v[142:143]
  v_cvt_pk_bf16_f32 v202, v28, v29
  v_cvt_pk_bf16_f32 v203, v30, v31
  s_nop 0
  v_permlane16_swap_b32 v200, v202
  v_permlane16_swap_b32 v201, v203
  s_mov_b32 s47, 8192
  buffer_store_dwordx4 v[200:203], v8, s[40:43], s47 offen sc1
  v_lshlrev_b32 v148, 16, v80
  v_and_b32 v149, 0xffff0000, v80
  v_lshlrev_b32 v150, 16, v81
  v_and_b32 v151, 0xffff0000, v81
  v_pk_add_f32 v[36:37], v[36:37], v[10:11] op_sel:[0,0] op_sel_hi:[1,0]
  v_pk_add_f32 v[38:39], v[38:39], v[10:11] op_sel:[0,0] op_sel_hi:[1,0]
  v_pk_mul_f32 v[36:37], v[36:37], v[148:149]
  v_pk_mul_f32 v[38:39], v[38:39], v[150:151]
  v_cvt_pk_bf16_f32 v204, v36, v37
  v_cvt_pk_bf16_f32 v205, v38, v39
  v_lshlrev_b32 v156, 16, v84
  v_and_b32 v157, 0xffff0000, v84
  v_lshlrev_b32 v158, 16, v85
  v_and_b32 v159, 0xffff0000, v85
  v_pk_add_f32 v[44:45], v[44:45], v[10:11] op_sel:[0,0] op_sel_hi:[1,0]
  v_pk_add_f32 v[46:47], v[46:47], v[10:11] op_sel:[0,0] op_sel_hi:[1,0]
  v_pk_mul_f32 v[44:45], v[44:45], v[156:157]
  v_pk_mul_f32 v[46:47], v[46:47], v[158:159]
  v_cvt_pk_bf16_f32 v206, v44, v45
  v_cvt_pk_bf16_f32 v207, v46, v47
  s_nop 0
  v_permlane16_swap_b32 v204, v206
  v_permlane16_swap_b32 v205, v207
  s_mov_b32 s47, 16384
  buffer_store_dwordx4 v[204:207], v8, s[40:43], s47 offen sc1
  v_lshlrev_b32 v164, 16, v88
  v_and_b32 v165, 0xffff0000, v88
  v_lshlrev_b32 v166, 16, v89
  v_and_b32 v167, 0xffff0000, v89
  v_pk_add_f32 v[52:53], v[52:53], v[10:11] op_sel:[0,0] op_sel_hi:[1,0]
  v_pk_add_f32 v[54:55], v[54:55], v[10:11] op_sel:[0,0] op_sel_hi:[1,0]
  v_pk_mul_f32 v[52:53], v[52:53], v[164:165]
  v_pk_mul_f32 v[54:55], v[54:55], v[166:167]
  v_cvt_pk_bf16_f32 v208, v52, v53
  v_cvt_pk_bf16_f32 v209, v54, v55
  v_lshlrev_b32 v172, 16, v92
  v_and_b32 v173, 0xffff0000, v92
  v_lshlrev_b32 v174, 16, v93
  v_and_b32 v175, 0xffff0000, v93
  v_pk_add_f32 v[60:61], v[60:61], v[10:11] op_sel:[0,0] op_sel_hi:[1,0]
  v_pk_add_f32 v[62:63], v[62:63], v[10:11] op_sel:[0,0] op_sel_hi:[1,0]
  v_pk_mul_f32 v[60:61], v[60:61], v[172:173]
  v_pk_mul_f32 v[62:63], v[62:63], v[174:175]
  v_cvt_pk_bf16_f32 v210, v60, v61
  v_cvt_pk_bf16_f32 v211, v62, v63
  s_nop 0
  v_permlane16_swap_b32 v208, v210
  v_permlane16_swap_b32 v209, v211
  s_mov_b32 s47, 24576
  buffer_store_dwordx4 v[208:211], v8, s[40:43], s47 offen sc1
  v_lshlrev_b32 v136, 16, v74
  v_and_b32 v137, 0xffff0000, v74
  v_lshlrev_b32 v138, 16, v75
  v_and_b32 v139, 0xffff0000, v75
  v_pk_add_f32 v[24:25], v[24:25], v[10:11] op_sel:[0,1] op_sel_hi:[1,1]
  v_pk_add_f32 v[26:27], v[26:27], v[10:11] op_sel:[0,1] op_sel_hi:[1,1]
  v_pk_mul_f32 v[24:25], v[24:25], v[136:137]
  v_pk_mul_f32 v[26:27], v[26:27], v[138:139]
  v_cvt_pk_bf16_f32 v212, v24, v25
  v_cvt_pk_bf16_f32 v213, v26, v27
  v_lshlrev_b32 v144, 16, v78
  v_and_b32 v145, 0xffff0000, v78
  v_lshlrev_b32 v146, 16, v79
  v_and_b32 v147, 0xffff0000, v79
  v_pk_add_f32 v[32:33], v[32:33], v[10:11] op_sel:[0,1] op_sel_hi:[1,1]
  v_pk_add_f32 v[34:35], v[34:35], v[10:11] op_sel:[0,1] op_sel_hi:[1,1]
  v_pk_mul_f32 v[32:33], v[32:33], v[144:145]
  v_pk_mul_f32 v[34:35], v[34:35], v[146:147]
  v_cvt_pk_bf16_f32 v214, v32, v33
  v_cvt_pk_bf16_f32 v215, v34, v35
  s_nop 0
  v_permlane16_swap_b32 v212, v214
  v_permlane16_swap_b32 v213, v215
  s_mov_b32 s47, 9216
  buffer_store_dwordx4 v[212:215], v8, s[40:43], s47 offen sc1
  v_lshlrev_b32 v152, 16, v82
  v_and_b32 v153, 0xffff0000, v82
  v_lshlrev_b32 v154, 16, v83
  v_and_b32 v155, 0xffff0000, v83
  v_pk_add_f32 v[40:41], v[40:41], v[10:11] op_sel:[0,1] op_sel_hi:[1,1]
  v_pk_add_f32 v[42:43], v[42:43], v[10:11] op_sel:[0,1] op_sel_hi:[1,1]
  v_pk_mul_f32 v[40:41], v[40:41], v[152:153]
  v_pk_mul_f32 v[42:43], v[42:43], v[154:155]
  v_cvt_pk_bf16_f32 v216, v40, v41
  v_cvt_pk_bf16_f32 v217, v42, v43
  v_lshlrev_b32 v160, 16, v86
  v_and_b32 v161, 0xffff0000, v86
  v_lshlrev_b32 v162, 16, v87
  v_and_b32 v163, 0xffff0000, v87
  v_pk_add_f32 v[48:49], v[48:49], v[10:11] op_sel:[0,1] op_sel_hi:[1,1]
  v_pk_add_f32 v[50:51], v[50:51], v[10:11] op_sel:[0,1] op_sel_hi:[1,1]
  v_pk_mul_f32 v[48:49], v[48:49], v[160:161]
  v_pk_mul_f32 v[50:51], v[50:51], v[162:163]
  v_cvt_pk_bf16_f32 v218, v48, v49
  v_cvt_pk_bf16_f32 v219, v50, v51
  s_nop 0
  v_permlane16_swap_b32 v216, v218
  v_permlane16_swap_b32 v217, v219
  s_mov_b32 s47, 17408
  buffer_store_dwordx4 v[216:219], v8, s[40:43], s47 offen sc1
  v_lshlrev_b32 v168, 16, v90
  v_and_b32 v169, 0xffff0000, v90
  v_lshlrev_b32 v170, 16, v91
  v_and_b32 v171, 0xffff0000, v91
  v_pk_add_f32 v[56:57], v[56:57], v[10:11] op_sel:[0,1] op_sel_hi:[1,1]
  v_pk_add_f32 v[58:59], v[58:59], v[10:11] op_sel:[0,1] op_sel_hi:[1,1]
  v_pk_mul_f32 v[56:57], v[56:57], v[168:169]
  v_pk_mul_f32 v[58:59], v[58:59], v[170:171]
  v_cvt_pk_bf16_f32 v220, v56, v57
  v_cvt_pk_bf16_f32 v221, v58, v59
  v_lshlrev_b32 v176, 16, v94
  v_and_b32 v177, 0xffff0000, v94
  v_lshlrev_b32 v178, 16, v95
  v_and_b32 v179, 0xffff0000, v95
  v_pk_add_f32 v[64:65], v[64:65], v[10:11] op_sel:[0,1] op_sel_hi:[1,1]
  v_pk_add_f32 v[66:67], v[66:67], v[10:11] op_sel:[0,1] op_sel_hi:[1,1]
  v_pk_mul_f32 v[64:65], v[64:65], v[176:177]
  v_pk_mul_f32 v[66:67], v[66:67], v[178:179]
  v_cvt_pk_bf16_f32 v222, v64, v65
  v_cvt_pk_bf16_f32 v223, v66, v67
  s_nop 0
  v_permlane16_swap_b32 v220, v222
  v_permlane16_swap_b32 v221, v223
  s_mov_b32 s47, 25600
  buffer_store_dwordx4 v[220:223], v8, s[40:43], s47 offen sc1
p4_st_done:
  s_barrier
  s_waitcnt vmcnt(0)
  s_barrier
  s_cmp_lg_u32 s46, 0
  s_cbranch_scc1 Lw_4
  s_lshl_b32 s47, s44, 10
  s_lshl_b32 s48, s45, 6
  s_add_u32 s47, s47, s48
  s_add_u32 s47, s47, 98304
  v_mov_b32 v5, s22
  v_mov_b32 v6, 0
  s_mov_b64 exec, 1
  buffer_store_dword v5, v6, s[64:67], s47 offen sc1
  s_mov_b64 exec, -1
Lw_4:
  s_branch chain_done
p3s_loop:
  s_waitcnt lgkmcnt(0)
  v_mfma_f32_16x16x32_bf16 v[12:15], v[132:135], v[124:127], v[12:15]
  s_add_u32 s53, s53, 30720
  ds_read_b64_tr_b16 v[168:169], v3 offset:7168
  v_mfma_f32_16x16x32_bf16 v[16:19], v[132:135], v[128:131], v[16:19]
  s_cmp_eq_u32 s53, 153600
  ds_read_b64_tr_b16 v[170:171], v3 offset:8960
  v_mfma_f32_16x16x32_bf16 v[20:23], v[136:139], v[124:127], v[20:23]
  s_cselect_b32 s54, 153600, 0
  ds_read_b128 v[160:163], v2 offset:0
  v_mfma_f32_16x16x32_bf16 v[24:27], v[136:139], v[128:131], v[24:27]
  s_cselect_b32 s53, 0, s53
  ds_read_b128 v[164:167], v2 offset:2048
  v_mfma_f32_16x16x32_bf16 v[28:31], v[140:143], v[124:127], v[28:31]
  s_sub_u32 s54, 30720, s54
  ds_read_b64_tr_b16 v[172:173], v3 offset:7200
  v_mfma_f32_16x16x32_bf16 v[32:35], v[140:143], v[128:131], v[32:35]
  s_sub_u32 s52, s52, 1
  ds_read_b64_tr_b16 v[174:175], v3 offset:8992
  v_mfma_f32_16x16x32_bf16 v[36:39], v[144:147], v[124:127], v[36:39]
  ds_read_b64_tr_b16 v[176:177], v3 offset:7232
  ds_read_b64_tr_b16 v[178:179], v3 offset:9024
  v_mfma_f32_16x16x32_bf16 v[40:43], v[144:147], v[128:131], v[40:43]
  ds_read_b64_tr_b16 v[180:181], v3 offset:7264
  ds_read_b64_tr_b16 v[182:183], v3 offset:9056
  v_mfma_f32_16x16x32_bf16 v[44:47], v[148:151], v[124:127], v[44:47]
  ds_read_b64_tr_b16 v[184:185], v3 offset:7296
  ds_read_b64_tr_b16 v[186:187], v3 offset:9088
  v_mfma_f32_16x16x32_bf16 v[48:51], v[148:151], v[128:131], v[48:51]
  ds_read_b64_tr_b16 v[188:189], v3 offset:7328
  ds_read_b64_tr_b16 v[190:191], v3 offset:9120
  v_mfma_f32_16x16x32_bf16 v[52:55], v[152:155], v[124:127], v[52:55]
  ds_read_b64_tr_b16 v[192:193], v3 offset:7360
  ds_read_b64_tr_b16 v[194:195], v3 offset:9152
  v_mfma_f32_16x16x32_bf16 v[56:59], v[152:155], v[128:131], v[56:59]
  v_mfma_f32_16x16x32_bf16 v[60:63], v[156:159], v[124:127], v[60:63]
  v_mfma_f32_16x16x32_bf16 v[64:67], v[156:159], v[128:131], v[64:67]
  s_waitcnt lgkmcnt(0)
  s_barrier
  v_mfma_f32_16x16x32_bf16 v[12:15], v[168:171], v[160:163], v[12:15]
  v_add_u32 v3, s54, v3
  v_mfma_f32_16x16x32_bf16 v[16:19], v[168:171], v[164:167], v[16:19]
  v_add_u32 v1, s54, v1
  ds_read_b64_tr_b16 v[132:133], v3 offset:0
  v_mfma_f32_16x16x32_bf16 v[20:23], v[172:175], v[160:163], v[20:23]
  v_add_u32 v2, s54, v2
  ds_read_b64_tr_b16 v[134:135], v3 offset:1792
  v_mfma_f32_16x16x32_bf16 v[24:27], v[172:175], v[164:167], v[24:27]
  s_cmp_lg_u32 s52, 0
  ds_read_b128 v[124:127], v1 offset:0
  v_mfma_f32_16x16x32_bf16 v[28:31], v[176:179], v[160:163], v[28:31]
  ds_read_b128 v[128:131], v1 offset:2048
  v_mfma_f32_16x16x32_bf16 v[32:35], v[176:179], v[164:167], v[32:35]
  ds_read_b64_tr_b16 v[136:137], v3 offset:32
  ds_read_b64_tr_b16 v[138:139], v3 offset:1824
  v_mfma_f32_16x16x32_bf16 v[36:39], v[180:183], v[160:163], v[36:39]
  ds_read_b64_tr_b16 v[140:141], v3 offset:64
  ds_read_b64_tr_b16 v[142:143], v3 offset:1856
  v_mfma_f32_16x16x32_bf16 v[40:43], v[180:183], v[164:167], v[40:43]
  ds_read_b64_tr_b16 v[144:145], v3 offset:96
  ds_read_b64_tr_b16 v[146:147], v3 offset:1888
  v_mfma_f32_16x16x32_bf16 v[44:47], v[184:187], v[160:163], v[44:47]
  ds_read_b64_tr_b16 v[148:149], v3 offset:128
  ds_read_b64_tr_b16 v[150:151], v3 offset:1920
  v_mfma_f32_16x16x32_bf16 v[48:51], v[184:187], v[164:167], v[48:51]
  ds_read_b64_tr_b16 v[152:153], v3 offset:160
  ds_read_b64_tr_b16 v[154:155], v3 offset:1952
  v_mfma_f32_16x16x32_bf16 v[52:55], v[188:191], v[160:163], v[52:55]
  ds_read_b64_tr_b16 v[156:157], v3 offset:192
  ds_read_b64_tr_b16 v[158:159], v3 offset:1984
  v_mfma_f32_16x16x32_bf16 v[56:59], v[188:191], v[164:167], v[56:59]
  v_mfma_f32_16x16x32_bf16 v[60:63], v[192:195], v[160:163], v[60:63]
  v_mfma_f32_16x16x32_bf16 v[64:67], v[192:195], v[164:167], v[64:67]
  s_cbranch_scc1 p3s_loop
  s_nop 7
  s_setpc_b64 s[84:85]
chain_done:
  s_mov_b32 s44, s59
  s_mov_b32 s45, s60
  s_lshr_b32 s61, s46, 1
  s_and_b32 s62, s46, 1
  s_add_u32 s32, s4, 0x800000
  s_addc_u32 s33, s5, 0x0
  s_mov_b32 s34, 0x400000
  s_mov_b32 s35, 0x20000
  s_mov_b32 s36, s20
  s_mov_b32 s37, s21
  s_mov_b32 s38, 0x400000
  s_mov_b32 s39, 0x20000
  v_lshrrev_b32 v5, 4, v0
  v_lshrrev_b32 v6, 1, v5
  v_and_b32 v5, 1, v5
  v_lshl_or_b32 v5, v5, 1, v6
  v_lshlrev_b32 v6, 4, v5
  v_and_b32 v5, 15, v0
  s_lshl_b32 s49, s44, 7
  s_lshl_b32 s50, s61, 6
  s_add_u32 s49, s49, s50
  v_add_u32 v7, s49, v5
  v_lshlrev_b32 v7, 11, v7
  v_add_u32 v7, v7, v6
  s_lshl_b32 s49, s45, 7
  s_lshl_b32 s50, s62, 6
  s_add_u32 s49, s49, s50
  v_add_u32 v7, s49, v7
  s_lshl_b32 s49, s44, 4
  s_add_u32 s49, s49, s45
  s_lshl_b32 s49, s49, 14
  s_lshl_b32 s50, s62, 13
  s_add_u32 s49, s49, s50
  s_lshl_b32 s50, s61, 12
  s_add_u32 s49, s49, s50
  v_lshl_add_u32 v8, v5, 6, v6
  v_add_u32 v8, s49, v8
  v_add_u32 v5, 0, v8
  buffer_load_dwordx4 v[92:95], v5, s[32:35], 0 offen sc1
  v_add_u32 v5, 1024, v8
  buffer_load_dwordx4 v[96:99], v5, s[32:35], 0 offen sc1
  v_add_u32 v5, 2048, v8
  buffer_load_dwordx4 v[100:103], v5, s[32:35], 0 offen sc1
  v_add_u32 v5, 3072, v8
  buffer_load_dwordx4 v[104:107], v5, s[32:35], 0 offen sc1
  s_lshl_b32 s49, s61, 13
  v_and_b32 v5, 15, v0
  v_lshlrev_b32 v1, 7, v5
  v_lshrrev_b32 v5, 4, v0
  v_and_b32 v2, 6, v0
  v_xor_b32 v5, v5, v2
  v_lshlrev_b32 v5, 4, v5
  v_add_u32 v1, v1, v5
  v_add_u32 v1, s49, v1
  v_xor_b32 v2, 64, v1
  v_lshrrev_b32 v5, 4, v0
  v_lshlrev_b32 v3, 10, v5
  v_and_b32 v4, 1, v5
  v_lshlrev_b32 v4, 2, v4
  v_bfe_u32 v5, v0, 2, 2
  v_lshl_add_u32 v3, v5, 7, v3
  v_and_b32 v5, 2, v5
  v_or_b32 v4, v4, v5
  v_bfe_u32 v5, v0, 1, 1
  v_xor_b32 v4, v4, v5
  v_and_b32 v5, 1, v0
  v_lshl_add_u32 v3, v5, 3, v3
  s_lshl_b32 s49, s62, 2
  v_xor_b32 v5, s49, v4
  v_xor_b32 v6, 2, v5
  v_lshl_add_u32 v4, v6, 4, v3
  v_lshl_add_u32 v3, v5, 4, v3
  v_add_u32 v3, 16384, v3
  v_add_u32 v4, 16384, v4
  v_mov_b32 v12, 0
  v_mov_b32 v13, 0
  v_mov_b32 v14, 0
  v_mov_b32 v15, 0
  v_mov_b32 v16, 0
  v_mov_b32 v17, 0
  v_mov_b32 v18, 0
  v_mov_b32 v19, 0
  v_mov_b32 v20, 0
  v_mov_b32 v21, 0
  v_mov_b32 v22, 0
  v_mov_b32 v23, 0
  v_mov_b32 v24, 0
  v_mov_b32 v25, 0
  v_mov_b32 v26, 0
  v_mov_b32 v27, 0
  v_mov_b32 v28, 0
  v_mov_b32 v29, 0
  v_mov_b32 v30, 0
  v_mov_b32 v31, 0
  v_mov_b32 v32, 0
  v_mov_b32 v33, 0
  v_mov_b32 v34, 0
  v_mov_b32 v35, 0
  v_mov_b32 v36, 0
  v_mov_b32 v37, 0
  v_mov_b32 v38, 0
  v_mov_b32 v39, 0
  v_mov_b32 v40, 0
  v_mov_b32 v41, 0
  v_mov_b32 v42, 0
  v_mov_b32 v43, 0
  s_barrier
  s_mov_b32 s53, 0
  s_mov_b32 s52, 28
  s_barrier
  ds_read_b64_tr_b16 v[60:61], v3 offset:0
  ds_read_b64_tr_b16 v[62:63], v3 offset:512
  ds_read_b128 v[44:47], v1 offset:0
  ds_read_b128 v[48:51], v1 offset:2048
  ds_read_b128 v[52:55], v1 offset:4096
  ds_read_b128 v[56:59], v1 offset:6144
  ds_read_b64_tr_b16 v[64:65], v4 offset:0
  ds_read_b64_tr_b16 v[66:67], v4 offset:512
p5_loop:
  s_waitcnt lgkmcnt(0)
  v_mfma_f32_16x16x32_bf16 v[12:15], v[60:63], v[44:47], v[12:15]
  s_add_u32 s53, s53, 24576
  ds_read_b64_tr_b16 v[84:85], v3 offset:4096
  v_mfma_f32_16x16x32_bf16 v[16:19], v[60:63], v[48:51], v[16:19]
  s_cmp_eq_u32 s53, 147456
  ds_read_b64_tr_b16 v[86:87], v3 offset:4608
  v_mfma_f32_16x16x32_bf16 v[20:23], v[60:63], v[52:55], v[20:23]
  s_cselect_b32 s54, 147456, 0
  ds_read_b128 v[68:71], v2 offset:0
  v_mfma_f32_16x16x32_bf16 v[24:27], v[60:63], v[56:59], v[24:27]
  s_cselect_b32 s53, 0, s53
  ds_read_b128 v[72:75], v2 offset:2048
  v_mfma_f32_16x16x32_bf16 v[28:31], v[64:67], v[44:47], v[28:31]
  s_sub_u32 s54, 24576, s54
  ds_read_b128 v[76:79], v2 offset:4096
  v_mfma_f32_16x16x32_bf16 v[32:35], v[64:67], v[48:51], v[32:35]
  s_sub_u32 s52, s52, 1
  ds_read_b128 v[80:83], v2 offset:6144
  v_mfma_f32_16x16x32_bf16 v[36:39], v[64:67], v[52:55], v[36:39]
  ds_read_b64_tr_b16 v[88:89], v4 offset:4096
  ds_read_b64_tr_b16 v[90:91], v4 offset:4608
  v_mfma_f32_16x16x32_bf16 v[40:43], v[64:67], v[56:59], v[40:43]
  s_waitcnt lgkmcnt(0)
  s_barrier
  v_mfma_f32_16x16x32_bf16 v[12:15], v[84:87], v[68:71], v[12:15]
  v_add_u32 v3, s54, v3
  v_mfma_f32_16x16x32_bf16 v[16:19], v[84:87], v[72:75], v[16:19]
  v_add_u32 v1, s54, v1
  ds_read_b64_tr_b16 v[60:61], v3 offset:0
  v_mfma_f32_16x16x32_bf16 v[20:23], v[84:87], v[76:79], v[20:23]
  v_add_u32 v4, s54, v4
  ds_read_b64_tr_b16 v[62:63], v3 offset:512
  v_mfma_f32_16x16x32_bf16 v[24:27], v[84:87], v[80:83], v[24:27]
  v_add_u32 v2, s54, v2
  ds_read_b128 v[44:47], v1 offset:0
  v_mfma_f32_16x16x32_bf16 v[28:31], v[88:91], v[68:71], v[28:31]
  s_cmp_lg_u32 s52, 0
  ds_read_b128 v[48:51], v1 offset:2048
  v_mfma_f32_16x16x32_bf16 v[32:35], v[88:91], v[72:75], v[32:35]
  ds_read_b128 v[52:55], v1 offset:4096
  v_mfma_f32_16x16x32_bf16 v[36:39], v[88:91], v[76:79], v[36:39]
  ds_read_b128 v[56:59], v1 offset:6144
  v_mfma_f32_16x16x32_bf16 v[40:43], v[88:91], v[80:83], v[40:43]
  ds_read_b64_tr_b16 v[64:65], v4 offset:0
  ds_read_b64_tr_b16 v[66:67], v4 offset:512
  s_cbranch_scc1 p5_loop
  s_waitcnt lgkmcnt(0)
  s_nop 7
  s_barrier
  s_waitcnt vmcnt(0)
  v_permlane16_swap_b32 v12, v28
  v_permlane16_swap_b32 v13, v29
  v_permlane16_swap_b32 v14, v30
  v_permlane16_swap_b32 v15, v31
  v_lshlrev_b32 v140, 16, v92
  v_and_b32 v141, 0xffff0000, v92
  v_lshlrev_b32 v142, 16, v93
  v_and_b32 v143, 0xffff0000, v93
  v_lshlrev_b32 v144, 16, v94
  v_and_b32 v145, 0xffff0000, v94
  v_lshlrev_b32 v146, 16, v95
  v_and_b32 v147, 0xffff0000, v95
  v_add_f32 v140, v140, v12
  v_add_f32 v141, v141, v13
  v_add_f32 v142, v142, v14
  v_add_f32 v143, v143, v15
  v_add_f32 v144, v144, v28
  v_add_f32 v145, v145, v29
  v_add_f32 v146, v146, v30
  v_add_f32 v147, v147, v31
  v_cvt_pk_bf16_f32 v108, v140, v141
  v_cvt_pk_bf16_f32 v109, v142, v143
  v_cvt_pk_bf16_f32 v110, v144, v145
  v_cvt_pk_bf16_f32 v111, v146, v147
  v_add_u32 v5, 0, v7
  buffer_store_dwordx4 v[108:111], v5, s[36:39], 0 offen
  v_permlane16_swap_b32 v16, v32
  v_permlane16_swap_b32 v17, v33
  v_permlane16_swap_b32 v18, v34
  v_permlane16_swap_b32 v19, v35
  v_lshlrev_b32 v148, 16, v96
  v_and_b32 v149, 0xffff0000, v96
  v_lshlrev_b32 v150, 16, v97
  v_and_b32 v151, 0xffff0000, v97
  v_lshlrev_b32 v152, 16, v98
  v_and_b32 v153, 0xffff0000, v98
  v_lshlrev_b32 v154, 16, v99
  v_and_b32 v155, 0xffff0000, v99
  v_add_f32 v148, v148, v16
  v_add_f32 v149, v149, v17
  v_add_f32 v150, v150, v18
  v_add_f32 v151, v151, v19
  v_add_f32 v152, v152, v32
  v_add_f32 v153, v153, v33
  v_add_f32 v154, v154, v34
  v_add_f32 v155, v155, v35
  v_cvt_pk_bf16_f32 v112, v148, v149
  v_cvt_pk_bf16_f32 v113, v150, v151
  v_cvt_pk_bf16_f32 v114, v152, v153
  v_cvt_pk_bf16_f32 v115, v154, v155
  v_add_u32 v5, 32768, v7
  buffer_store_dwordx4 v[112:115], v5, s[36:39], 0 offen
  v_permlane16_swap_b32 v20, v36
  v_permlane16_swap_b32 v21, v37
  v_permlane16_swap_b32 v22, v38
  v_permlane16_swap_b32 v23, v39
  v_lshlrev_b32 v156, 16, v100
  v_and_b32 v157, 0xffff0000, v100
  v_lshlrev_b32 v158, 16, v101
  v_and_b32 v159, 0xffff0000, v101
  v_lshlrev_b32 v160, 16, v102
  v_and_b32 v161, 0xffff0000, v102
  v_lshlrev_b32 v162, 16, v103
  v_and_b32 v163, 0xffff0000, v103
  v_add_f32 v156, v156, v20
  v_add_f32 v157, v157, v21
  v_add_f32 v158, v158, v22
  v_add_f32 v159, v159, v23
  v_add_f32 v160, v160, v36
  v_add_f32 v161, v161, v37
  v_add_f32 v162, v162, v38
  v_add_f32 v163, v163, v39
  v_cvt_pk_bf16_f32 v116, v156, v157
  v_cvt_pk_bf16_f32 v117, v158, v159
  v_cvt_pk_bf16_f32 v118, v160, v161
  v_cvt_pk_bf16_f32 v119, v162, v163
  v_add_u32 v5, 65536, v7
  buffer_store_dwordx4 v[116:119], v5, s[36:39], 0 offen
  v_permlane16_swap_b32 v24, v40
  v_permlane16_swap_b32 v25, v41
  v_permlane16_swap_b32 v26, v42
  v_permlane16_swap_b32 v27, v43
  v_lshlrev_b32 v164, 16, v104
  v_and_b32 v165, 0xffff0000, v104
  v_lshlrev_b32 v166, 16, v105
  v_and_b32 v167, 0xffff0000, v105
  v_lshlrev_b32 v168, 16, v106
  v_and_b32 v169, 0xffff0000, v106
  v_lshlrev_b32 v170, 16, v107
  v_and_b32 v171, 0xffff0000, v107
  v_add_f32 v164, v164, v24
  v_add_f32 v165, v165, v25
  v_add_f32 v166, v166, v26
  v_add_f32 v167, v167, v27
  v_add_f32 v168, v168, v40
  v_add_f32 v169, v169, v41
  v_add_f32 v170, v170, v42
  v_add_f32 v171, v171, v43
  v_cvt_pk_bf16_f32 v120, v164, v165
  v_cvt_pk_bf16_f32 v121, v166, v167
  v_cvt_pk_bf16_f32 v122, v168, v169
  v_cvt_pk_bf16_f32 v123, v170, v171
  v_add_u32 v5, 98304, v7
  buffer_store_dwordx4 v[120:123], v5, s[36:39], 0 offen
  s_cmp_lg_u32 s2, 0
  s_cbranch_scc1 mk_end
  s_cmp_lg_u32 s46, 0
  s_cbranch_scc1 mk_end
  s_add_u32 s40, s4, 0x2640000
  s_addc_u32 s41, s5, 0x0
  s_mov_b32 s42, 0x40
  s_mov_b32 s43, 0x20000
  v_mov_b32 v1, s22
  v_mov_b32 v2, 0
  s_mov_b64 exec, 1
  buffer_store_dword v1, v2, s[40:43], 0 offen
  s_endpgm
mk_loaders:
  s_waitcnt lgkmcnt(0)
  s_add_u32 s22, s22, 1
  s_mov_b32 s44, s57
  s_mov_b32 s45, s58
  s_barrier
  s_mov_b32 s52, 8
Ls_5:
  s_barrier
  s_sub_u32 s52, s52, 1
  s_cmp_lg_u32 s52, 0
  s_cbranch_scc1 Ls_5
  s_mov_b32 s40, s10
  s_mov_b32 s41, s11
  s_mov_b32 s42, 0x200000
  s_mov_b32 s43, 0x20000
  s_mul_i32 s50, s2, 8192
  s_add_u32 s50, s50, 0
  v_min_u32 v60, 63, v0
  v_lshlrev_b32 v60, 7, v60
  buffer_load_dword v61, v60, s[40:43], s50 offen
  s_barrier
  s_mov_b32 s52, 5
Ls_6:
  s_barrier
  s_sub_u32 s52, s52, 1
  s_cmp_lg_u32 s52, 0
  s_cbranch_scc1 Ls_6
  s_add_u32 s36, s4, 0x2580000
  s_addc_u32 s37, s5, 0x0
  s_mov_b32 s38, 0x9000
  s_mov_b32 s39, 0x20000
  s_mul_i32 s49, s44, 2304
  v_lshlrev_b32 v40, 4, v0
  v_add_u32 v40, s49, v40
  v_min_u32 v41, 15, v0
  v_lshlrev_b32 v41, 4, v41
  v_add_u32 v41, s49, v41
  buffer_load_dwordx4 v[44:47], v40, s[36:39], 0 offen sc1
  buffer_load_dwordx4 v[48:51], v40, s[36:39], 0 offen offset:1024 sc1
  buffer_load_dwordx4 v[52:55], v41, s[36:39], 0 offen offset:2048 sc1
  s_barrier
  s_barrier
  s_mov_b32 s63, 100000
  s_waitcnt vmcnt(0)
p1_gx_poll:
  v_xor_b32 v42, s22, v45
  v_xor_b32 v43, s22, v47
  v_or_b32 v42, v42, v43
  v_xor_b32 v43, s22, v49
  v_or_b32 v42, v42, v43
  v_xor_b32 v43, s22, v51
  v_or_b32 v42, v42, v43
  v_xor_b32 v43, s22, v53
  v_or_b32 v42, v42, v43
  v_xor_b32 v43, s22, v55
  v_or_b32 v42, v42, v43
  v_cmp_ne_u32 vcc, 0, v42
  s_sub_u32 s63, s63, 1
  s_cmp_eq_u32 s63, 0
  s_cbranch_scc1 p1_gx_done
  s_cmp_eq_u64 vcc, 0
  s_cbranch_scc1 p1_gx_done
  buffer_load_dwordx4 v[44:47], v40, s[36:39], 0 offen sc1
  buffer_load_dwordx4 v[48:51], v40, s[36:39], 0 offen offset:1024 sc1
  buffer_load_dwordx4 v[52:55], v41, s[36:39], 0 offen offset:2048 sc1
  s_waitcnt vmcnt(0)
  s_branch p1_gx_poll
p1_gx_done:
  v_mov_b32 v45, v46
  v_mov_b32 v49, v50
  v_mov_b32 v53, v54
  v_lshlrev_b32 v40, 3, v0
  v_add_u32 v40, 153600, v40
  ds_write_b64 v40, v[44:45]
  ds_write_b64 v40, v[48:49] offset:512
  v_min_u32 v41, 15, v0
  v_lshlrev_b32 v41, 3, v41
  v_add_u32 v41, 153600, v41
  ds_write_b64 v41, v[52:53] offset:1024
  s_waitcnt lgkmcnt(0)
  s_barrier
  s_mov_b32 s40, s12
  s_mov_b32 s41, s13
  s_mov_b32 s42, 0x700000
  s_mov_b32 s43, 0x20000
  s_mul_i32 s50, s2, 28672
  s_add_u32 s50, s50, 21504
  v_min_u32 v60, 55, v0
  v_lshlrev_b32 v60, 7, v60
  buffer_load_dword v61, v60, s[40:43], s50 offen
  s_barrier
  s_call_b64 s[84:85], attn_sub
  s_barrier
  s_waitcnt vmcnt(0)
  s_mov_b32 s44, s59
  s_mov_b32 s45, s60
  s_barrier
  s_lshl_b32 s47, s44, 10
  s_add_u32 s47, s47, 65536
  v_min_u32 v12, 15, v0
  v_lshlrev_b32 v12, 6, v12
  v_add_u32 v12, s47, v12
  s_mov_b32 s92, 0
  s_mov_b32 s93, 6
  s_cmp_ge_u32 s92, s93
  s_cbranch_scc1 Lg_7_d
  s_mov_b32 s63, 100000
Lg_7:
  buffer_load_dword v13, v12, s[64:67], 0 offen sc1
  s_waitcnt vmcnt(0)
  v_cmp_eq_u32 vcc, s22, v13
  s_sub_u32 s63, s63, 1
  s_cmp_eq_u32 s63, 0
  s_cbranch_scc1 Lg_7_d
  s_ff0_i32_b64 s92, vcc
  s_cmp_eq_i32 s92, -1
  s_cselect_b32 s92, 64, s92
  s_cmp_ge_u32 s92, s93
  s_cbranch_scc1 Lg_7_d
  s_sleep 8
  s_branch Lg_7
Lg_7_d:
  s_barrier
  s_barrier
  s_mov_b32 s52, 10
  s_mov_b32 s93, 7
Ls_8:
  s_cmp_ge_u32 s92, s93
  s_cbranch_scc1 Lg_9_d
  s_mov_b32 s63, 100000
Lg_9:
  buffer_load_dword v13, v12, s[64:67], 0 offen sc1
  s_waitcnt vmcnt(0)
  v_cmp_eq_u32 vcc, s22, v13
  s_sub_u32 s63, s63, 1
  s_cmp_eq_u32 s63, 0
  s_cbranch_scc1 Lg_9_d
  s_ff0_i32_b64 s92, vcc
  s_cmp_eq_i32 s92, -1
  s_cselect_b32 s92, 64, s92
  s_cmp_ge_u32 s92, s93
  s_cbranch_scc1 Lg_9_d
  s_sleep 8
  s_branch Lg_9
Lg_9_d:
  s_add_u32 s93, s93, 1
  s_barrier
  s_sub_u32 s52, s52, 1
  s_cmp_lg_u32 s52, 0
  s_cbranch_scc1 Ls_8
  s_mov_b32 s52, 4
Ls_10:
  s_barrier
  s_sub_u32 s52, s52, 1
  s_cmp_lg_u32 s52, 0
  s_cbranch_scc1 Ls_10
  s_barrier
  s_barrier
  s_barrier
  s_barrier
  s_barrier
  s_mov_b32 s44, s57
  s_mov_b32 s45, s58
  s_barrier
  s_lshl_b32 s47, s44, 10
  s_add_u32 s47, s47, 81920
  v_min_u32 v12, 15, v0
  v_lshlrev_b32 v12, 6, v12
  v_add_u32 v12, s47, v12
  s_mov_b32 s92, 0
  s_mov_b32 s93, 5
  s_cmp_ge_u32 s92, s93
  s_cbranch_scc1 Lg_11_d
  s_mov_b32 s63, 100000
Lg_11:
  buffer_load_dword v13, v12, s[64:67], 0 offen sc1
  s_waitcnt vmcnt(0)
  v_cmp_eq_u32 vcc, s22, v13
  s_sub_u32 s63, s63, 1
  s_cmp_eq_u32 s63, 0
  s_cbranch_scc1 Lg_11_d
  s_ff0_i32_b64 s92, vcc
  s_cmp_eq_i32 s92, -1
  s_cselect_b32 s92, 64, s92
  s_cmp_ge_u32 s92, s93
  s_cbranch_scc1 Lg_11_d
  s_sleep 8
  s_branch Lg_11
Lg_11_d:
  s_barrier
  s_barrier
  s_mov_b32 s52, 6
  s_mov_b32 s93, 6
Ls_12:
  s_cmp_ge_u32 s92, s93
  s_cbranch_scc1 Lg_13_d
  s_mov_b32 s63, 100000
Lg_13:
  buffer_load_dword v13, v12, s[64:67], 0 offen sc1
  s_waitcnt vmcnt(0)
  v_cmp_eq_u32 vcc, s22, v13
  s_sub_u32 s63, s63, 1
  s_cmp_eq_u32 s63, 0
  s_cbranch_scc1 Lg_13_d
  s_ff0_i32_b64 s92, vcc
  s_cmp_eq_i32 s92, -1
  s_cselect_b32 s92, 64, s92
  s_cmp_ge_u32 s92, s93
  s_cbranch_scc1 Lg_13_d
  s_sleep 8
  s_branch Lg_13
Lg_13_d:
  s_add_u32 s93, s93, 1
  s_barrier
  s_sub_u32 s52, s52, 1
  s_cmp_lg_u32 s52, 0
  s_cbranch_scc1 Ls_12
  s_mov_b32 s93, 12
  s_cmp_ge_u32 s92, s93
  s_cbranch_scc1 Lg_14_d
  s_mov_b32 s63, 100000
Lg_14:
  buffer_load_dword v13, v12, s[64:67], 0 offen sc1
  s_waitcnt vmcnt(0)
  v_cmp_eq_u32 vcc, s22, v13
  s_sub_u32 s63, s63, 1
  s_cmp_eq_u32 s63, 0
  s_cbranch_scc1 Lg_14_d
  s_ff0_i32_b64 s92, vcc
  s_cmp_eq_i32 s92, -1
  s_cselect_b32 s92, 64, s92
  s_cmp_ge_u32 s92, s93
  s_cbranch_scc1 Lg_14_d
  s_sleep 8
  s_branch Lg_14
Lg_14_d:
  s_lshl_b32 s47, s44, 10
  s_lshl_b32 s48, s45, 6
  s_add_u32 s47, s47, s48
  s_add_u32 s47, s47, 114688
  v_mov_b32 v18, s22
  v_mov_b32 v19, 0
  s_mov_b64 exec, 1
  buffer_store_dword v18, v19, s[64:67], s47 offen sc1
  s_mov_b64 exec, -1
  s_barrier
  s_mov_b32 s93, 13
  s_cmp_ge_u32 s92, s93
  s_cbranch_scc1 Lg_15_d
  s_mov_b32 s63, 100000
Lg_15:
  buffer_load_dword v13, v12, s[64:67], 0 offen sc1
  s_waitcnt vmcnt(0)
  v_cmp_eq_u32 vcc, s22, v13
  s_sub_u32 s63, s63, 1
  s_cmp_eq_u32 s63, 0
  s_cbranch_scc1 Lg_15_d
  s_ff0_i32_b64 s92, vcc
  s_cmp_eq_i32 s92, -1
  s_cselect_b32 s92, 64, s92
  s_cmp_ge_u32 s92, s93
  s_cbranch_scc1 Lg_15_d
  s_sleep 8
  s_branch Lg_15
Lg_15_d:
  s_barrier
  s_mov_b32 s93, 14
  s_cmp_ge_u32 s92, s93
  s_cbranch_scc1 Lg_16_d
  s_mov_b32 s63, 100000
Lg_16:
  buffer_load_dword v13, v12, s[64:67], 0 offen sc1
  s_waitcnt vmcnt(0)
  v_cmp_eq_u32 vcc, s22, v13
  s_sub_u32 s63, s63, 1
  s_cmp_eq_u32 s63, 0
  s_cbranch_scc1 Lg_16_d
  s_ff0_i32_b64 s92, vcc
  s_cmp_eq_i32 s92, -1
  s_cselect_b32 s92, 64, s92
  s_cmp_ge_u32 s92, s93
  s_cbranch_scc1 Lg_16_d
  s_sleep 8
  s_branch Lg_16
Lg_16_d:
  s_barrier
  s_mov_b32 s93, 15
  s_cmp_ge_u32 s92, s93
  s_cbranch_scc1 Lg_17_d
  s_mov_b32 s63, 100000
Lg_17:
  buffer_load_dword v13, v12, s[64:67], 0 offen sc1
  s_waitcnt vmcnt(0)
  v_cmp_eq_u32 vcc, s22, v13
  s_sub_u32 s63, s63, 1
  s_cmp_eq_u32 s63, 0
  s_cbranch_scc1 Lg_17_d
  s_ff0_i32_b64 s92, vcc
  s_cmp_eq_i32 s92, -1
  s_cselect_b32 s92, 64, s92
  s_cmp_ge_u32 s92, s93
  s_cbranch_scc1 Lg_17_d
  s_sleep 8
  s_branch Lg_17
Lg_17_d:
  s_lshr_b32 s51, s45, 1
  s_lshl_b32 s47, s51, 10
  s_add_u32 s47, s47, 114688
  v_and_b32 v14, 15, v0
  v_lshlrev_b32 v14, 6, v14
  v_add_u32 v14, s47, v14
  v_add_u32 v15, 8192, v14
  v_cmp_gt_u32 vcc, 16, v0
  s_nop 1
  v_cndmask_b32 v14, v14, v15, vcc
  s_lshl_b32 s47, s44, 8
  s_add_u32 s47, s47, 28672
  v_and_b32 v16, 31, v0
  v_lshlrev_b32 v16, 2, v16
  v_add_u32 v16, s47, v16
  v_cmp_gt_u32 vcc, 32, v0
  s_nop 1
  v_cndmask_b32 v14, v16, v14, vcc
  buffer_load_dword v20, v14, s[64:67], 0 offen sc1
  s_barrier
  s_mov_b32 s93, 16
  s_cmp_ge_u32 s92, s93
  s_cbranch_scc1 Lg_18_d
  s_mov_b32 s63, 100000
Lg_18:
  buffer_load_dword v13, v12, s[64:67], 0 offen sc1
  s_waitcnt vmcnt(0)
  v_cmp_eq_u32 vcc, s22, v13
  s_sub_u32 s63, s63, 1
  s_cmp_eq_u32 s63, 0
  s_cbranch_scc1 Lg_18_d
  s_ff0_i32_b64 s92, vcc
  s_cmp_eq_i32 s92, -1
  s_cselect_b32 s92, 64, s92
  s_cmp_ge_u32 s92, s93
  s_cbranch_scc1 Lg_18_d
  s_sleep 8
  s_branch Lg_18
Lg_18_d:
  s_mov_b32 s63, 100000
Lf6_19:
  s_waitcnt vmcnt(0)
  v_cmp_ne_u32 vcc, s22, v20
  s_sub_u32 s63, s63, 1
  s_cmp_eq_u32 s63, 0
  s_cbranch_scc1 Lf6_19_d
  s_cmp_eq_u64 vcc, 0
  s_cbranch_scc1 Lf6_19_d
  buffer_load_dword v20, v14, s[64:67], 0 offen sc1
  s_branch Lf6_19
Lf6_19_d:
  s_barrier
  s_mov_b32 s52, 5
Ls_20:
  s_barrier
  s_sub_u32 s52, s52, 1
  s_cmp_lg_u32 s52, 0
  s_cbranch_scc1 Ls_20
  s_mov_b32 s40, s14
  s_mov_b32 s41, s15
  s_mov_b32 s42, 0x800000
  s_mov_b32 s43, 0x20000
  s_mul_i32 s50, s2, 32768
  s_add_u32 s50, s50, 24576
  v_min_u32 v60, 63, v0
  v_lshlrev_b32 v60, 7, v60
  buffer_load_dword v61, v60, s[40:43], s50 offen
  s_barrier
  s_mov_b32 s52, 14
Ls_21:
  s_barrier
  s_sub_u32 s52, s52, 1
  s_cmp_lg_u32 s52, 0
  s_cbranch_scc1 Ls_21
  s_lshl_b32 s47, s45, 8
  s_add_u32 s47, s47, 8192
  s_lshl_b32 s48, s44, 2
  v_add_u32 v12, s48, v0
  v_and_b32 v12, 63, v12
  v_lshlrev_b32 v12, 2, v12
  v_add_u32 v12, s47, v12
  s_mov_b32 s92, 0
  s_mov_b32 s93, 10
  s_cmp_ge_u32 s92, s93
  s_cbranch_scc1 Lg_22_d
  s_mov_b32 s63, 100000
Lg_22:
  buffer_load_dword v13, v12, s[64:67], 0 offen sc1
  s_waitcnt vmcnt(0)
  v_cmp_eq_u32 vcc, s22, v13
  s_sub_u32 s63, s63, 1
  s_cmp_eq_u32 s63, 0
  s_cbranch_scc1 Lg_22_d
  s_ff0_i32_b64 s92, vcc
  s_cmp_eq_i32 s92, -1
  s_cselect_b32 s92, 64, s92
  s_cmp_ge_u32 s92, s93
  s_cbranch_scc1 Lg_22_d
  s_sleep 8
  s_branch Lg_22
Lg_22_d:
  s_barrier
  s_barrier
  s_mov_b32 s52, 27
  s_mov_b32 s93, 12
Ls_23:
  s_cmp_ge_u32 s92, s93
  s_cbranch_scc1 Lg_24_d
  s_mov_b32 s63, 100000
Lg_24:
  buffer_load_dword v13, v12, s[64:67], 0 offen sc1
  s_waitcnt vmcnt(0)
  v_cmp_eq_u32 vcc, s22, v13
  s_sub_u32 s63, s63, 1
  s_cmp_eq_u32 s63, 0
  s_cbranch_scc1 Lg_24_d
  s_ff0_i32_b64 s92, vcc
  s_cmp_eq_i32 s92, -1
  s_cselect_b32 s92, 64, s92
  s_cmp_ge_u32 s92, s93
  s_cbranch_scc1 Lg_24_d
  s_sleep 8
  s_branch Lg_24
Lg_24_d:
  s_add_u32 s93, s93, 2
  s_barrier
  s_sub_u32 s52, s52, 1
  s_cmp_lg_u32 s52, 0
  s_cbranch_scc1 Ls_23
  s_mov_b32 s52, 5
Ls_25:
  s_barrier
  s_sub_u32 s52, s52, 1
  s_cmp_lg_u32 s52, 0
  s_cbranch_scc1 Ls_25
  s_barrier
  s_barrier
  s_mov_b32 s44, s59
  s_mov_b32 s45, s60
  s_barrier
  s_lshl_b32 s47, s44, 10
  s_add_u32 s47, s47, 98304
  v_min_u32 v12, 15, v0
  v_lshlrev_b32 v12, 6, v12
  v_add_u32 v12, s47, v12
  s_mov_b32 s92, 0
  s_mov_b32 s93, 4
  s_cmp_ge_u32 s92, s93
  s_cbranch_scc1 Lg_26_d
  s_mov_b32 s63, 100000
Lg_26:
  buffer_load_dword v13, v12, s[64:67], 0 offen sc1
  s_waitcnt vmcnt(0)
  v_cmp_eq_u32 vcc, s22, v13
  s_sub_u32 s63, s63, 1
  s_cmp_eq_u32 s63, 0
  s_cbranch_scc1 Lg_26_d
  s_ff0_i32_b64 s92, vcc
  s_cmp_eq_i32 s92, -1
  s_cselect_b32 s92, 64, s92
  s_cmp_ge_u32 s92, s93
  s_cbranch_scc1 Lg_26_d
  s_sleep 8
  s_branch Lg_26
Lg_26_d:
  s_barrier
  s_barrier
  s_mov_b32 s93, 4
  s_cmp_ge_u32 s92, s93
  s_cbranch_scc1 Lg_27_d
  s_mov_b32 s63, 100000
Lg_27:
  buffer_load_dword v13, v12, s[64:67], 0 offen sc1
  s_waitcnt vmcnt(0)
  v_cmp_eq_u32 vcc, s22, v13
  s_sub_u32 s63, s63, 1
  s_cmp_eq_u32 s63, 0
  s_cbranch_scc1 Lg_27_d
  s_ff0_i32_b64 s92, vcc
  s_cmp_eq_i32 s92, -1
  s_cselect_b32 s92, 64, s92
  s_cmp_ge_u32 s92, s93
  s_cbranch_scc1 Lg_27_d
  s_sleep 8
  s_branch Lg_27
Lg_27_d:
  s_barrier
  s_mov_b32 s93, 5
  s_cmp_ge_u32 s92, s93
  s_cbranch_scc1 Lg_28_d
  s_mov_b32 s63, 100000
Lg_28:
  buffer_load_dword v13, v12, s[64:67], 0 offen sc1
  s_waitcnt vmcnt(0)
  v_cmp_eq_u32 vcc, s22, v13
  s_sub_u32 s63, s63, 1
  s_cmp_eq_u32 s63, 0
  s_cbranch_scc1 Lg_28_d
  s_ff0_i32_b64 s92, vcc
  s_cmp_eq_i32 s92, -1
  s_cselect_b32 s92, 64, s92
  s_cmp_ge_u32 s92, s93
  s_cbranch_scc1 Lg_28_d
  s_sleep 8
  s_branch Lg_28
Lg_28_d:
  s_barrier
  s_mov_b32 s93, 6
  s_cmp_ge_u32 s92, s93
  s_cbranch_scc1 Lg_29_d
  s_mov_b32 s63, 100000
Lg_29:
  buffer_load_dword v13, v12, s[64:67], 0 offen sc1
  s_waitcnt vmcnt(0)
  v_cmp_eq_u32 vcc, s22, v13
  s_sub_u32 s63, s63, 1
  s_cmp_eq_u32 s63, 0
  s_cbranch_scc1 Lg_29_d
  s_ff0_i32_b64 s92, vcc
  s_cmp_eq_i32 s92, -1
  s_cselect_b32 s92, 64, s92
  s_cmp_ge_u32 s92, s93
  s_cbranch_scc1 Lg_29_d
  s_sleep 8
  s_branch Lg_29
Lg_29_d:
  s_barrier
  s_barrier
  s_mov_b32 s93, 7
  s_cmp_ge_u32 s92, s93
  s_cbranch_scc1 Lg_30_d
  s_mov_b32 s63, 100000
Lg_30:
  buffer_load_dword v13, v12, s[64:67], 0 offen sc1
  s_waitcnt vmcnt(0)
  v_cmp_eq_u32 vcc, s22, v13
  s_sub_u32 s63, s63, 1
  s_cmp_eq_u32 s63, 0
  s_cbranch_scc1 Lg_30_d
  s_ff0_i32_b64 s92, vcc
  s_cmp_eq_i32 s92, -1
  s_cselect_b32 s92, 64, s92
  s_cmp_ge_u32 s92, s93
  s_cbranch_scc1 Lg_30_d
  s_sleep 8
  s_branch Lg_30
Lg_30_d:
  s_barrier
  s_barrier
  s_mov_b32 s93, 8
  s_cmp_ge_u32 s92, s93
  s_cbranch_scc1 Lg_31_d
  s_mov_b32 s63, 100000
Lg_31:
  buffer_load_dword v13, v12, s[64:67], 0 offen sc1
  s_waitcnt vmcnt(0)
  v_cmp_eq_u32 vcc, s22, v13
  s_sub_u32 s63, s63, 1
  s_cmp_eq_u32 s63, 0
  s_cbranch_scc1 Lg_31_d
  s_ff0_i32_b64 s92, vcc
  s_cmp_eq_i32 s92, -1
  s_cselect_b32 s92, 64, s92
  s_cmp_ge_u32 s92, s93
  s_cbranch_scc1 Lg_31_d
  s_sleep 8
  s_branch Lg_31
Lg_31_d:
  s_barrier
  s_barrier
  s_mov_b32 s93, 9
  s_cmp_ge_u32 s92, s93
  s_cbranch_scc1 Lg_32_d
  s_mov_b32 s63, 100000
Lg_32:
  buffer_load_dword v13, v12, s[64:67], 0 offen sc1
  s_waitcnt vmcnt(0)
  v_cmp_eq_u32 vcc, s22, v13
  s_sub_u32 s63, s63, 1
  s_cmp_eq_u32 s63, 0
  s_cbranch_scc1 Lg_32_d
  s_ff0_i32_b64 s92, vcc
  s_cmp_eq_i32 s92, -1
  s_cselect_b32 s92, 64, s92
  s_cmp_ge_u32 s92, s93
  s_cbranch_scc1 Lg_32_d
  s_sleep 8
  s_branch Lg_32
Lg_32_d:
  s_barrier
  s_mov_b32 s93, 10
  s_cmp_ge_u32 s92, s93
  s_cbranch_scc1 Lg_33_d
  s_mov_b32 s63, 100000
Lg_33:
  buffer_load_dword v13, v12, s[64:67], 0 offen sc1
  s_waitcnt vmcnt(0)
  v_cmp_eq_u32 vcc, s22, v13
  s_sub_u32 s63, s63, 1
  s_cmp_eq_u32 s63, 0
  s_cbranch_scc1 Lg_33_d
  s_ff0_i32_b64 s92, vcc
  s_cmp_eq_i32 s92, -1
  s_cselect_b32 s92, 64, s92
  s_cmp_ge_u32 s92, s93
  s_cbranch_scc1 Lg_33_d
  s_sleep 8
  s_branch Lg_33
Lg_33_d:
  s_barrier
  s_barrier
  s_mov_b32 s93, 11
  s_cmp_ge_u32 s92, s93
  s_cbranch_scc1 Lg_34_d
  s_mov_b32 s63, 100000
Lg_34:
  buffer_load_dword v13, v12, s[64:67], 0 offen sc1
  s_waitcnt vmcnt(0)
  v_cmp_eq_u32 vcc, s22, v13
  s_sub_u32 s63, s63, 1
  s_cmp_eq_u32 s63, 0
  s_cbranch_scc1 Lg_34_d
  s_ff0_i32_b64 s92, vcc
  s_cmp_eq_i32 s92, -1
  s_cselect_b32 s92, 64, s92
  s_cmp_ge_u32 s92, s93
  s_cbranch_scc1 Lg_34_d
  s_sleep 8
  s_branch Lg_34
Lg_34_d:
  s_barrier
  s_barrier
  s_mov_b32 s93, 12
  s_cmp_ge_u32 s92, s93
  s_cbranch_scc1 Lg_35_d
  s_mov_b32 s63, 100000
Lg_35:
  buffer_load_dword v13, v12, s[64:67], 0 offen sc1
  s_waitcnt vmcnt(0)
  v_cmp_eq_u32 vcc, s22, v13
  s_sub_u32 s63, s63, 1
  s_cmp_eq_u32 s63, 0
  s_cbranch_scc1 Lg_35_d
  s_ff0_i32_b64 s92, vcc
  s_cmp_eq_i32 s92, -1
  s_cselect_b32 s92, 64, s92
  s_cmp_ge_u32 s92, s93
  s_cbranch_scc1 Lg_35_d
  s_sleep 8
  s_branch Lg_35
Lg_35_d:
  s_barrier
  s_barrier
  s_mov_b32 s93, 13
  s_cmp_ge_u32 s92, s93
  s_cbranch_scc1 Lg_36_d
  s_mov_b32 s63, 100000
Lg_36:
  buffer_load_dword v13, v12, s[64:67], 0 offen sc1
  s_waitcnt vmcnt(0)
  v_cmp_eq_u32 vcc, s22, v13
  s_sub_u32 s63, s63, 1
  s_cmp_eq_u32 s63, 0
  s_cbranch_scc1 Lg_36_d
  s_ff0_i32_b64 s92, vcc
  s_cmp_eq_i32 s92, -1
  s_cselect_b32 s92, 64, s92
  s_cmp_ge_u32 s92, s93
  s_cbranch_scc1 Lg_36_d
  s_sleep 8
  s_branch Lg_36
Lg_36_d:
  s_barrier
  s_mov_b32 s93, 14
  s_cmp_ge_u32 s92, s93
  s_cbranch_scc1 Lg_37_d
  s_mov_b32 s63, 100000
Lg_37:
  buffer_load_dword v13, v12, s[64:67], 0 offen sc1
  s_waitcnt vmcnt(0)
  v_cmp_eq_u32 vcc, s22, v13
  s_sub_u32 s63, s63, 1
  s_cmp_eq_u32 s63, 0
  s_cbranch_scc1 Lg_37_d
  s_ff0_i32_b64 s92, vcc
  s_cmp_eq_i32 s92, -1
  s_cselect_b32 s92, 64, s92
  s_cmp_ge_u32 s92, s93
  s_cbranch_scc1 Lg_37_d
  s_sleep 8
  s_branch Lg_37
Lg_37_d:
  s_barrier
  s_barrier
  s_mov_b32 s93, 15
  s_cmp_ge_u32 s92, s93
  s_cbranch_scc1 Lg_38_d
  s_mov_b32 s63, 100000
Lg_38:
  buffer_load_dword v13, v12, s[64:67], 0 offen sc1
  s_waitcnt vmcnt(0)
  v_cmp_eq_u32 vcc, s22, v13
  s_sub_u32 s63, s63, 1
  s_cmp_eq_u32 s63, 0
  s_cbranch_scc1 Lg_38_d
  s_ff0_i32_b64 s92, vcc
  s_cmp_eq_i32 s92, -1
  s_cselect_b32 s92, 64, s92
  s_cmp_ge_u32 s92, s93
  s_cbranch_scc1 Lg_38_d
  s_sleep 8
  s_branch Lg_38
Lg_38_d:
  s_barrier
  s_barrier
  s_mov_b32 s93, 16
  s_cmp_ge_u32 s92, s93
  s_cbranch_scc1 Lg_39_d
  s_mov_b32 s63, 100000
Lg_39:
  buffer_load_dword v13, v12, s[64:67], 0 offen sc1
  s_waitcnt vmcnt(0)
  v_cmp_eq_u32 vcc, s22, v13
  s_sub_u32 s63, s63, 1
  s_cmp_eq_u32 s63, 0
  s_cbranch_scc1 Lg_39_d
  s_ff0_i32_b64 s92, vcc
  s_cmp_eq_i32 s92, -1
  s_cselect_b32 s92, 64, s92
  s_cmp_ge_u32 s92, s93
  s_cbranch_scc1 Lg_39_d
  s_sleep 8
  s_branch Lg_39
Lg_39_d:
  s_barrier
  s_barrier
  s_barrier
  s_barrier
  s_barrier
  s_barrier
  s_barrier
  s_barrier
  s_barrier
  s_endpgm
mk_end:
  s_endpgm
mk_code_end:
.section .rodata,"a"
.p2align 6
.amdhsa_kernel sequential_preLN__sliding_local_dilated__mixer_gmlp__prompt_kernel
  .amdhsa_next_free_vgpr 256
  .amdhsa_next_free_sgpr 102
  .amdhsa_accum_offset 256
  .amdhsa_group_segment_fixed_size 0
  .amdhsa_kernarg_size 88
  .amdhsa_user_sgpr_count 2
  .amdhsa_user_sgpr_kernarg_segment_ptr 1
  .amdhsa_system_sgpr_workgroup_id_x 1
  .amdhsa_float_denorm_mode_32 3
.end_amdhsa_kernel
```
